```python
import torch

def _softmax(x, axis=-1):
    return torch.softmax(x, dim=axis)
def _gelu(x):
    return torch.nn.functional.gelu(x, approximate="tanh")
def _silu(x):
    return torch.nn.functional.silu(x)
def _sigmoid(x):
    return torch.sigmoid(x)
def _layernorm(x, axis=-1, eps=1e-5):
    m = x.mean(dim=axis, keepdim=True)
    v = x.var(dim=axis, keepdim=True, unbiased=False)
    return (x - m) / torch.sqrt(v + eps)
def _scatter_add(tgt, idx, src, axis=0):
    return tgt.clone().index_add_(axis, idx, src)
def _segment_sum(src, seg, n):
    out = torch.zeros((n,) + src.shape[1:], dtype=src.dtype)
    return out.index_add_(0, seg, src)
def _pad(x, pw):
    flat = tuple(v for pair in reversed(pw) for v in pair)
    return torch.nn.functional.pad(x, flat)

kernel_name = 'interleave_layers__grouped_kv_mqa__sliding_block__prompt'

def setup_inputs():

    _w = (lambda a: (lambda t: t.to(torch.bfloat16) if t.is_floating_point() else t)(torch.as_tensor(a)))
    def _A_setup():
        B, S, D, H = 1, 2048, 576, 32
        Dh = D // H
        return {
            "x": _w((lambda *s: torch.randn(*s, dtype=torch.bfloat16) * 0.05)(B, S, D)),
            "wq": _w((lambda *s: torch.randn(*s, dtype=torch.bfloat16) * 0.05)(D, H * Dh)),
            "wk": _w((lambda *s: torch.randn(*s, dtype=torch.bfloat16) * 0.05)(D, Dh)),
            "wv": _w((lambda *s: torch.randn(*s, dtype=torch.bfloat16) * 0.05)(D, Dh)),
            "wo": _w((lambda *s: torch.randn(*s, dtype=torch.bfloat16) * 0.05)(H * Dh, D)),
        }
    _A_in = _A_setup()

    def _B_setup():
        B, S, D = 1, 2048, 576
        return {
            "x": _w((lambda *s: torch.randn(*s, dtype=torch.bfloat16) * 0.05)(B, S, D)),
            "wqkv": _w((lambda *s: torch.randn(*s, dtype=torch.bfloat16) * 0.05)(D, 3 * D)),
            "wo": _w((lambda *s: torch.randn(*s, dtype=torch.bfloat16) * 0.05)(D, D)),
        }
    _B_in = _B_setup()

    return {
        "A_x": _A_in["x"],
        "A_wq": _A_in["wq"],
        "A_wk": _A_in["wk"],
        "A_wv": _A_in["wv"],
        "A_wo": _A_in["wo"],
        "B_x": _B_in["x"],
        "B_wqkv": _B_in["wqkv"],
        "B_wo": _B_in["wo"],
    }

def reference(A_x, A_wq, A_wk, A_wv, A_wo, B_x, B_wqkv, B_wo):
    def _A_ref(x, wq, wk, wv, wo):
        B, S, D = x.shape
        H = 32
        Dh = D // H
        q = (lambda x, *d: x.permute(*d))((x @ wq).reshape(B, S, H, Dh), 0, 2, 1, 3)
        k = x @ wk
        v = x @ wv
        scores = torch.einsum("bhqd,bkd->bhqk", q, k) * (Dh ** -0.5)
        p = _softmax(scores, axis=-1)
        o = torch.einsum("bhqk,bkd->bhqd", p, v)
        return (lambda x, *d: x.permute(*d))(o, 0, 2, 1, 3).reshape(B, S, H * Dh) @ wo

    def _B_ref(x, wqkv, wo):
        B, S, D = x.shape
        H = 32; Dh = D // H; W = 256
        qkv = (lambda x, *d: x.permute(*d))((x @ wqkv).reshape(B, S, 3, H, Dh), 2, 0, 3, 1, 4)
        q, k, v = qkv[0], qkv[1], qkv[2]
        scores = torch.einsum("bhqd,bhkd->bhqk", q, k) * (Dh ** -0.5)
        idx = torch.arange(S)
        mask = (idx[:, None] - idx[None, :] >= 0) & (idx[:, None] - idx[None, :] < W)
        scores = torch.where(mask[None, None], scores, -1e9)
        p = _softmax(scores, axis=-1)
        o = torch.einsum("bhqk,bhkd->bhqd", p, v)
        return (lambda x, *d: x.permute(*d))(o, 0, 2, 1, 3).reshape(B, S, D) @ wo

    x = A_x
    x = x + _A_ref(_layernorm(x, axis=-1), A_wq, A_wk, A_wv, A_wo)
    x = x + _B_ref(_layernorm(x, axis=-1), B_wqkv, B_wo)
    x = x + _A_ref(_layernorm(x, axis=-1), A_wq, A_wk, A_wv, A_wo)
    x = x + _B_ref(_layernorm(x, axis=-1), B_wqkv, B_wo)
    return x
```

```asm
; @launch grid=(256,1,1) block=(512,1,1) lds=163840
.amdgcn_target "amdgcn-amd-amdhsa--gfx950"
.text
.globl interleave_layers__grouped_kv_mqa__sliding_block__prompt_kernel
.p2align 8
.type interleave_layers__grouped_kv_mqa__sliding_block__prompt_kernel,@function
interleave_layers__grouped_kv_mqa__sliding_block__prompt_kernel:
    s_cmp_ge_u32 s2, 256
    s_cbranch_scc1 K1_END
    s_load_dwordx16 s[68:83], s[0:1], 0
    s_load_dwordx2 s[4:5], s[0:1], 80
    s_load_dwordx2 s[8:9], s[0:1], 64
    v_lshrrev_b32 v1, 6, v0
    v_and_b32 v0, 63, v0
    s_mov_b32 s6, 15622144
    s_mov_b32 s7, 0x20000
    v_readfirstlane_b32 s12, v1
    s_mov_b32 s10, 2359296
    s_mov_b32 s11, 0x20000
    s_mov_b32 s3, 0x20000
    s_mov_b32 s63, 0
    v_lshlrev_b32 v1, 4, v0
    v_and_b32 v2, 31, v0
    v_lshrrev_b32 v3, 5, v0
    v_mov_b32 v4, 0
    s_and_b32 s36, s2, 7
    s_lshr_b32 s37, s2, 3
    s_lshl_b32 s20, s36, 5
    s_add_u32 s20, s20, s37
    s_lshl_b32 s49, s20, 2
    s_lshr_b32 s14, s20, 2
    s_and_b32 s15, s20, 3
    s_lshr_b32 s16, s20, 4
    s_and_b32 s17, s20, 15
    s_and_b32 s13, s12, 3
    s_lshr_b32 s19, s12, 2
    s_mul_i32 s48, s14, 36864
    s_mov_b32 s18, 0
    s_mov_b32 s50, 0xffff0000
    s_mov_b32 s51, 0x3eae1a93
    s_mov_b32 s40, 4066304
    s_mov_b32 s41, 14466048
    s_mov_b32 s42, 14728192
    s_mov_b32 s43, 8784896
    s_mov_b32 s44, 9092096
    s_mov_b32 s45, 6425600
    s_mov_b32 s46, 6425600
    s_mov_b32 s47, 9616384
    s_mov_b32 s52, s13
    s_cmp_lt_u32 s12, 4
    s_mov_b32 s54, 1403904
    s_cselect_b32 s54, 740352, s54
    s_mul_i32 s53, s17, 124928
    s_add_u32 s53, s53, 2067456
    s_mov_b32 s97, 0
    s_mov_b32 s55, 0
    s_mov_b32 s98, 0x3f803f80
    s_lshr_b32 s99, 0x13333, s37
    s_and_b32 s99, s99, 1
    s_cmp_eq_u32 s19, 0
    s_cbranch_scc1 PR_F
    s_mul_i32 s21, s14, 36864
    s_mul_i32 s22, s13, 576
    s_mov_b32 s2, 2359296
    s_movk_i32 s23, 7282
    v_add3_u32 v32, v0, s22, 0
    v_mul_u32_u24 v5, s23, v32
    v_bfe_u32 v5, v5, 20, 3
    v_xor_b32 v32, v32, v5
    v_lshlrev_b32 v32, 4, v32
    s_add_u32 s22, s22, 64
    v_add3_u32 v33, v0, s22, 0
    v_mul_u32_u24 v5, s23, v33
    v_bfe_u32 v5, v5, 20, 3
    v_xor_b32 v33, v33, v5
    v_lshlrev_b32 v33, 4, v33
    s_add_u32 s22, s22, 64
    v_add3_u32 v34, v0, s22, 0
    v_mul_u32_u24 v5, s23, v34
    v_bfe_u32 v5, v5, 20, 3
    v_xor_b32 v34, v34, v5
    v_lshlrev_b32 v34, 4, v34
    s_add_u32 s22, s22, 64
    v_add3_u32 v35, v0, s22, 0
    v_mul_u32_u24 v5, s23, v35
    v_bfe_u32 v5, v5, 20, 3
    v_xor_b32 v35, v35, v5
    v_lshlrev_b32 v35, 4, v35
    s_add_u32 s22, s22, 64
    v_add3_u32 v36, v0, s22, 0
    v_mul_u32_u24 v5, s23, v36
    v_bfe_u32 v5, v5, 20, 3
    v_xor_b32 v36, v36, v5
    v_lshlrev_b32 v36, 4, v36
    s_add_u32 s22, s22, 64
    v_add3_u32 v37, v0, s22, 0
    v_mul_u32_u24 v5, s23, v37
    v_bfe_u32 v5, v5, 20, 3
    v_xor_b32 v37, v37, v5
    v_lshlrev_b32 v37, 4, v37
    s_add_u32 s22, s22, 64
    v_add3_u32 v38, v0, s22, 0
    v_mul_u32_u24 v5, s23, v38
    v_bfe_u32 v5, v5, 20, 3
    v_xor_b32 v38, v38, v5
    v_lshlrev_b32 v38, 4, v38
    s_add_u32 s22, s22, 64
    v_add3_u32 v39, v0, s22, 0
    v_mul_u32_u24 v5, s23, v39
    v_bfe_u32 v5, v5, 20, 3
    v_xor_b32 v39, v39, v5
    v_lshlrev_b32 v39, 4, v39
    s_add_u32 s22, s22, 64
    v_add3_u32 v40, v0, s22, 0
    v_mul_u32_u24 v5, s23, v40
    v_bfe_u32 v5, v5, 20, 3
    v_xor_b32 v40, v40, v5
    v_lshlrev_b32 v40, 4, v40
    s_add_u32 s22, s22, 64
    s_lshl_b32 s20, s13, 2
    s_add_u32 s20, s20, 163328
    v_mov_b32 v16, s20
    v_mov_b32 v17, 0
    ds_write_b32 v16, v17
    s_lshl_b32 s20, s13, 2
    s_add_u32 s20, s20, 163360
    v_mov_b32 v16, s20
    v_mov_b32 v17, 0
    ds_write_b32 v16, v17
    s_lshl_b32 s20, s13, 2
    s_add_u32 s20, s20, 163376
    v_mov_b32 v16, s20
    v_mov_b32 v17, 0
    ds_write_b32 v16, v17
    s_lshl_b32 s20, s13, 2
    s_add_u32 s20, s20, 163408
    v_mov_b32 v16, s20
    v_mov_b32 v17, 0
    ds_write_b32 v16, v17
    s_mov_b32 s20, 15023104
    s_waitcnt lgkmcnt(0)
    s_load_dword s96, s[4:5], s20
    s_mov_b32 s0, s68
    s_mov_b32 s1, s69
    s_mul_i32 s27, s13, 9216
    s_add_u32 s27, s27, 120832
    s_cmp_eq_u32 s99, 0
    s_cbranch_scc1 PR_B1
    s_barrier
PR_B1:
    s_mov_b32 m0, s27
    s_add_u32 s27, s27, 1024
    buffer_load_dwordx4 v32, s[0:3], s21 offen lds
    s_mov_b32 m0, s27
    s_add_u32 s27, s27, 1024
    buffer_load_dwordx4 v33, s[0:3], s21 offen lds
    s_mov_b32 m0, s27
    s_add_u32 s27, s27, 1024
    buffer_load_dwordx4 v34, s[0:3], s21 offen lds
    s_mov_b32 m0, s27
    s_add_u32 s27, s27, 1024
    buffer_load_dwordx4 v35, s[0:3], s21 offen lds
    s_mov_b32 m0, s27
    s_add_u32 s27, s27, 1024
    buffer_load_dwordx4 v36, s[0:3], s21 offen lds
    s_mov_b32 m0, s27
    s_add_u32 s27, s27, 1024
    buffer_load_dwordx4 v37, s[0:3], s21 offen lds
    s_mov_b32 m0, s27
    s_add_u32 s27, s27, 1024
    buffer_load_dwordx4 v38, s[0:3], s21 offen lds
    s_mov_b32 m0, s27
    s_add_u32 s27, s27, 1024
    buffer_load_dwordx4 v39, s[0:3], s21 offen lds
    s_mov_b32 m0, s27
    s_add_u32 s27, s27, 1024
    buffer_load_dwordx4 v40, s[0:3], s21 offen lds
    s_setprio 2
    s_cmp_lt_u32 s15, 2
    s_cbranch_scc1 PR_P1
    s_cmp_eq_u32 s15, 2
    s_cselect_b32 s0, s72, s74
    s_cselect_b32 s1, s73, s75
    s_mov_b32 s2, 20736
    v_lshrrev_b32 v5, 2, v0
    v_mul_u32_u24 v5, 36, v5
    v_and_b32 v6, 3, v0
    v_lshl_add_u32 v5, v6, 4, v5
    s_mul_i32 s26, s13, 5184
    s_mul_i32 s27, s13, 9216
    s_add_u32 s27, s27, 81920
    v_bfe_u32 v7, v0, 2, 2
    v_lshl_add_u32 v7, v3, 2, v7
    v_lshlrev_b32 v7, 6, v7
    v_bfe_u32 v8, v0, 4, 1
    v_lshl_add_u32 v7, v8, 5, v7
    v_lshl_add_u32 v7, v6, 3, v7
    v_add_u32 v75, s27, v7
    s_mov_b32 m0, s27
    s_add_u32 s27, s27, 1024
    buffer_load_dwordx4 v5, s[0:3], s26 offen lds
    s_add_u32 s26, s26, 576
    s_mov_b32 m0, s27
    s_add_u32 s27, s27, 1024
    buffer_load_dwordx4 v5, s[0:3], s26 offen lds
    s_add_u32 s26, s26, 576
    s_mov_b32 m0, s27
    s_add_u32 s27, s27, 1024
    buffer_load_dwordx4 v5, s[0:3], s26 offen lds
    s_add_u32 s26, s26, 576
    s_mov_b32 m0, s27
    s_add_u32 s27, s27, 1024
    buffer_load_dwordx4 v5, s[0:3], s26 offen lds
    s_add_u32 s26, s26, 576
    s_mov_b32 m0, s27
    s_add_u32 s27, s27, 1024
    buffer_load_dwordx4 v5, s[0:3], s26 offen lds
    s_add_u32 s26, s26, 576
    s_mov_b32 m0, s27
    s_add_u32 s27, s27, 1024
    buffer_load_dwordx4 v5, s[0:3], s26 offen lds
    s_add_u32 s26, s26, 576
    s_mov_b32 m0, s27
    s_add_u32 s27, s27, 1024
    buffer_load_dwordx4 v5, s[0:3], s26 offen lds
    s_add_u32 s26, s26, 576
    s_mov_b32 m0, s27
    s_add_u32 s27, s27, 1024
    buffer_load_dwordx4 v5, s[0:3], s26 offen lds
    s_add_u32 s26, s26, 576
    s_mov_b32 m0, s27
    s_add_u32 s27, s27, 1024
    buffer_load_dwordx4 v5, s[0:3], s26 offen lds
    s_add_u32 s26, s26, 576
PR_P1:
    s_cmp_eq_u32 s99, 0
    s_cbranch_scc0 PR_B2
    s_barrier
PR_B2:
    v_lshlrev_b32 v5, 7, v0
    s_cmp_eq_u32 s12, 4
    s_cbranch_scc0 PR_T2
    s_mul_i32 s20, s14, 2368
    s_add_u32 s20, s20, 8784896
    s_lshl_b32 s21, s14, 12
    s_and_b32 s22, s15, 1
    s_lshl_b32 s22, s22, 11
    s_add_u32 s21, s21, s22
    s_add_u32 s21, s21, 9092096
    s_cmp_lt_u32 s15, 2
    s_cselect_b32 s20, s21, s20
    s_mov_b64 exec, 0xfffff
    buffer_load_dword v16, v5, s[4:7], s20 offen
    s_and_b32 s20, s49, 0x380
    s_lshl_b32 s20, s20, 3
    s_mul_i32 s21, s15, 8192
    s_add_u32 s22, s21, 49152
    s_cmp_lt_u32 s15, 2
    s_cselect_b32 s21, s21, s22
    s_add_u32 s20, s20, s21
    s_add_u32 s20, s20, 14859264
    s_mov_b64 exec, 0xff
    buffer_load_dword v17, v5, s[4:7], s20 offen
    s_mov_b64 exec, -1
PR_T2:
    v_mul_u32_u24 v9, 1152, v2
    v_add_u32 v9, 120832, v9
    v_bfe_u32 v10, v2, 1, 3
    s_mul_i32 s22, s13, 18
    v_add_u32 v11, s22, v3
    s_mul_i32 s25, s13, 9216
    s_add_u32 s24, s40, s48
    s_add_u32 s24, s24, s25
    s_add_u32 s25, s25, 0
    v_add_u32 v6, s25, v1
    s_mul_i32 s26, s13, 9
    v_mov_b32 v12, 0
    v_mov_b32 v13, 0
    s_lshl_b32 s20, s13, 9
    s_add_u32 s20, s20, 36864
    v_lshlrev_b32 v7, 3, v0
    v_add_u32 v8, s20, v7
    v_add_u32 v7, 36864, v7
    s_waitcnt vmcnt(0) lgkmcnt(0)
    s_add_u32 s96, s96, 0x9e3779b9
    s_lshl_b32 s20, s13, 2
    s_add_u32 s20, s20, 163376
    v_mov_b32 v16, s20
    v_mov_b32 v17, 1
    s_waitcnt lgkmcnt(0)
    ds_write_b32 v16, v17
    v_mov_b32 v16, 163376
PS_1:
    ds_read_b128 v[18:21], v16
    s_waitcnt lgkmcnt(0)
    v_and_b32 v18, v18, v19
    v_and_b32 v20, v20, v21
    v_and_b32 v18, v18, v20
    v_cmp_eq_u32 vcc, 0, v18
    s_cbranch_vccnz PS_1
    s_cmp_eq_u32 s99, 0
    s_cbranch_scc1 PR_W1
    v_mov_b32 v28, 162820
WR_2:
    ds_read_b32 v29, v28
    s_waitcnt lgkmcnt(0)
    v_cmp_eq_u32 vcc, 0, v29
    s_cbranch_vccnz WR_2
    s_and_b32 s56, s15, 3
    s_add_u32 s56, s56, 16
    s_lshl_b32 s56, s56, 2
    s_add_u32 s56, s56, s13
    s_mul_i32 s56, s56, 9216
    s_add_u32 s56, s56, 0
    s_add_u32 s56, s56, s97
    buffer_load_dwordx4 v[76:79], v1, s[4:7], s56 offen offset:0
    buffer_load_dwordx4 v[80:83], v1, s[4:7], s56 offen offset:1024
    buffer_load_dwordx4 v[84:87], v1, s[4:7], s56 offen offset:2048
    buffer_load_dwordx4 v[88:91], v1, s[4:7], s56 offen offset:3072
    s_add_u32 s56, s56, 4096
    buffer_load_dwordx4 v[92:95], v1, s[4:7], s56 offen offset:0
    buffer_load_dwordx4 v[96:99], v1, s[4:7], s56 offen offset:1024
    buffer_load_dwordx4 v[100:103], v1, s[4:7], s56 offen offset:2048
    buffer_load_dwordx4 v[104:107], v1, s[4:7], s56 offen offset:3072
    s_add_u32 s56, s56, 4096
    buffer_load_dwordx4 v[108:111], v1, s[4:7], s56 offen offset:0
PR_W1:
    v_xor_b32 v14, v11, v10
    v_lshl_add_u32 v14, v14, 4, v9
    ds_read_b128 v[32:35], v14
    v_add_u32 v11, 2, v11
    v_xor_b32 v14, v11, v10
    v_lshl_add_u32 v14, v14, 4, v9
    ds_read_b128 v[36:39], v14
    v_add_u32 v11, 2, v11
    v_xor_b32 v14, v11, v10
    v_lshl_add_u32 v14, v14, 4, v9
    ds_read_b128 v[40:43], v14
    v_add_u32 v11, 2, v11
    v_xor_b32 v14, v11, v10
    v_lshl_add_u32 v14, v14, 4, v9
    ds_read_b128 v[44:47], v14
    v_add_u32 v11, 2, v11
    v_xor_b32 v14, v11, v10
    v_lshl_add_u32 v14, v14, 4, v9
    ds_read_b128 v[48:51], v14
    v_add_u32 v11, 2, v11
    v_xor_b32 v14, v11, v10
    v_lshl_add_u32 v14, v14, 4, v9
    ds_read_b128 v[52:55], v14
    v_add_u32 v11, 2, v11
    v_xor_b32 v14, v11, v10
    v_lshl_add_u32 v14, v14, 4, v9
    ds_read_b128 v[56:59], v14
    v_add_u32 v11, 2, v11
    v_xor_b32 v14, v11, v10
    v_lshl_add_u32 v14, v14, 4, v9
    ds_read_b128 v[60:63], v14
    v_add_u32 v11, 2, v11
    v_xor_b32 v14, v11, v10
    v_lshl_add_u32 v14, v14, 4, v9
    ds_read_b128 v[64:67], v14
    v_add_u32 v11, 2, v11
    s_waitcnt lgkmcnt(0)
    s_cmp_lt_u32 s15, 2
    s_cbranch_scc1 PR_P2
    ds_read_b64_tr_b16 v[76:77], v75 offset:0
    ds_read_b64_tr_b16 v[78:79], v75 offset:512
    ds_read_b64_tr_b16 v[80:81], v75 offset:1024
    ds_read_b64_tr_b16 v[82:83], v75 offset:1536
    ds_read_b64_tr_b16 v[84:85], v75 offset:2048
    ds_read_b64_tr_b16 v[86:87], v75 offset:2560
    ds_read_b64_tr_b16 v[88:89], v75 offset:3072
    ds_read_b64_tr_b16 v[90:91], v75 offset:3584
    ds_read_b64_tr_b16 v[92:93], v75 offset:4096
    ds_read_b64_tr_b16 v[94:95], v75 offset:4608
    ds_read_b64_tr_b16 v[96:97], v75 offset:5120
    ds_read_b64_tr_b16 v[98:99], v75 offset:5632
    ds_read_b64_tr_b16 v[100:101], v75 offset:6144
    ds_read_b64_tr_b16 v[102:103], v75 offset:6656
    ds_read_b64_tr_b16 v[104:105], v75 offset:7168
    ds_read_b64_tr_b16 v[106:107], v75 offset:7680
    ds_read_b64_tr_b16 v[108:109], v75 offset:8192
    ds_read_b64_tr_b16 v[110:111], v75 offset:8704
PR_P2:
    v_dot2c_f32_bf16 v12, s98, v32
    v_dot2c_f32_bf16 v13, v32, v32
    v_dot2c_f32_bf16 v12, s98, v33
    v_dot2c_f32_bf16 v13, v33, v33
    v_dot2c_f32_bf16 v12, s98, v34
    v_dot2c_f32_bf16 v13, v34, v34
    v_dot2c_f32_bf16 v12, s98, v35
    v_dot2c_f32_bf16 v13, v35, v35
    v_dot2c_f32_bf16 v12, s98, v36
    v_dot2c_f32_bf16 v13, v36, v36
    v_dot2c_f32_bf16 v12, s98, v37
    v_dot2c_f32_bf16 v13, v37, v37
    v_dot2c_f32_bf16 v12, s98, v38
    v_dot2c_f32_bf16 v13, v38, v38
    v_dot2c_f32_bf16 v12, s98, v39
    v_dot2c_f32_bf16 v13, v39, v39
    v_dot2c_f32_bf16 v12, s98, v40
    v_dot2c_f32_bf16 v13, v40, v40
    v_dot2c_f32_bf16 v12, s98, v41
    v_dot2c_f32_bf16 v13, v41, v41
    v_dot2c_f32_bf16 v12, s98, v42
    v_dot2c_f32_bf16 v13, v42, v42
    v_dot2c_f32_bf16 v12, s98, v43
    v_dot2c_f32_bf16 v13, v43, v43
    v_dot2c_f32_bf16 v12, s98, v44
    v_dot2c_f32_bf16 v13, v44, v44
    v_dot2c_f32_bf16 v12, s98, v45
    v_dot2c_f32_bf16 v13, v45, v45
    v_dot2c_f32_bf16 v12, s98, v46
    v_dot2c_f32_bf16 v13, v46, v46
    v_dot2c_f32_bf16 v12, s98, v47
    v_dot2c_f32_bf16 v13, v47, v47
    v_dot2c_f32_bf16 v12, s98, v48
    v_dot2c_f32_bf16 v13, v48, v48
    v_dot2c_f32_bf16 v12, s98, v49
    v_dot2c_f32_bf16 v13, v49, v49
    v_dot2c_f32_bf16 v12, s98, v50
    v_dot2c_f32_bf16 v13, v50, v50
    v_dot2c_f32_bf16 v12, s98, v51
    v_dot2c_f32_bf16 v13, v51, v51
    v_dot2c_f32_bf16 v12, s98, v52
    v_dot2c_f32_bf16 v13, v52, v52
    v_dot2c_f32_bf16 v12, s98, v53
    v_dot2c_f32_bf16 v13, v53, v53
    v_dot2c_f32_bf16 v12, s98, v54
    v_dot2c_f32_bf16 v13, v54, v54
    v_dot2c_f32_bf16 v12, s98, v55
    v_dot2c_f32_bf16 v13, v55, v55
    v_dot2c_f32_bf16 v12, s98, v56
    v_dot2c_f32_bf16 v13, v56, v56
    v_dot2c_f32_bf16 v12, s98, v57
    v_dot2c_f32_bf16 v13, v57, v57
    v_dot2c_f32_bf16 v12, s98, v58
    v_dot2c_f32_bf16 v13, v58, v58
    v_dot2c_f32_bf16 v12, s98, v59
    v_dot2c_f32_bf16 v13, v59, v59
    v_dot2c_f32_bf16 v12, s98, v60
    v_dot2c_f32_bf16 v13, v60, v60
    v_dot2c_f32_bf16 v12, s98, v61
    v_dot2c_f32_bf16 v13, v61, v61
    v_dot2c_f32_bf16 v12, s98, v62
    v_dot2c_f32_bf16 v13, v62, v62
    v_dot2c_f32_bf16 v12, s98, v63
    v_dot2c_f32_bf16 v13, v63, v63
    v_dot2c_f32_bf16 v12, s98, v64
    v_dot2c_f32_bf16 v13, v64, v64
    v_dot2c_f32_bf16 v12, s98, v65
    v_dot2c_f32_bf16 v13, v65, v65
    v_dot2c_f32_bf16 v12, s98, v66
    v_dot2c_f32_bf16 v13, v66, v66
    v_dot2c_f32_bf16 v12, s98, v67
    v_dot2c_f32_bf16 v13, v67, v67
    s_nop 2
    v_xor_b32 v13, 0x80000000, v13
    ds_write_b64 v8, v[12:13]
    v_permlane32_swap_b32 v32, v34
    v_permlane32_swap_b32 v33, v35
    v_permlane32_swap_b32 v36, v38
    v_permlane32_swap_b32 v37, v39
    v_permlane32_swap_b32 v40, v42
    v_permlane32_swap_b32 v41, v43
    v_permlane32_swap_b32 v44, v46
    v_permlane32_swap_b32 v45, v47
    v_permlane32_swap_b32 v48, v50
    v_permlane32_swap_b32 v49, v51
    v_permlane32_swap_b32 v52, v54
    v_permlane32_swap_b32 v53, v55
    v_permlane32_swap_b32 v56, v58
    v_permlane32_swap_b32 v57, v59
    v_permlane32_swap_b32 v60, v62
    v_permlane32_swap_b32 v61, v63
    v_permlane32_swap_b32 v64, v66
    v_permlane32_swap_b32 v65, v67
    ds_write_b128 v6, v[32:35] offset:0
    ds_write_b128 v6, v[36:39] offset:1024
    ds_write_b128 v6, v[40:43] offset:2048
    ds_write_b128 v6, v[44:47] offset:3072
    ds_write_b128 v6, v[48:51] offset:4096
    ds_write_b128 v6, v[52:55] offset:5120
    ds_write_b128 v6, v[56:59] offset:6144
    ds_write_b128 v6, v[60:63] offset:7168
    ds_write_b128 v6, v[64:67] offset:8192
    s_lshl_b32 s20, s13, 2
    s_add_u32 s20, s20, 163360
    v_mov_b32 v16, s20
    v_mov_b32 v17, 1
    s_waitcnt lgkmcnt(0)
    ds_write_b32 v16, v17
    v_mov_b32 v16, 163360
PS_3:
    ds_read_b128 v[18:21], v16
    s_waitcnt lgkmcnt(0)
    v_and_b32 v18, v18, v19
    v_and_b32 v20, v20, v21
    v_and_b32 v18, v18, v20
    v_cmp_eq_u32 vcc, 0, v18
    s_cbranch_vccnz PS_3
    ds_read_b64 v[16:17], v7 offset:0
    ds_read_b64 v[18:19], v7 offset:512
    ds_read_b64 v[20:21], v7 offset:1024
    ds_read_b64 v[22:23], v7 offset:1536
    s_waitcnt lgkmcnt(0)
    v_pk_add_f32 v[8:9], v[16:17], v[18:19]
    v_pk_add_f32 v[10:11], v[20:21], v[22:23]
    v_add_f32 v8, v8, v10
    v_add_f32 v9, v9, v11
    v_mov_b32 v10, v8
    v_mov_b32 v11, v9
    s_nop 0
    v_permlane32_swap_b32 v8, v10
    v_permlane32_swap_b32 v9, v11
    v_add_f32 v8, v8, v10
    v_add_f32 v9, v9, v11
    v_mul_f32 v8, 0x3ae38e39, v8
    v_mul_f32 v9, 0xbae38e39, v9
    v_fma_f32 v9, -v8, v8, v9
    v_max_f32 v9, 0, v9
    v_cvt_pk_bf16_f32 v7, -v8, -v8
    v_cvt_pk_bf16_f32 v9, v9, v9
    v_lshlrev_b32 v9, 16, v9
    v_add_f32 v9, 0x3727c5ac, v9
    v_cvt_pk_bf16_f32 v9, v9, v9
    v_lshlrev_b32 v9, 16, v9
    v_sqrt_f32 v9, v9
    s_nop 0
    v_cvt_pk_bf16_f32 v9, v9, v9
    v_lshlrev_b32 v9, 16, v9
    v_rcp_f32 v6, v9
    v_lshlrev_b32 v5, 2, v2
    v_add_u32 v5, 161792, v5
    ds_write_b32 v5, v6
    ds_write_b32 v5, v7 offset:128
    s_lshl_b32 s20, s13, 2
    s_add_u32 s20, s20, 163408
    v_mov_b32 v5, s20
    v_mov_b32 v69, 1
    ds_write_b32 v5, v69
    v_mov_b32 v69, 0
    v_mov_b32 v68, v7
    s_cmp_lt_u32 s15, 2
    s_cbranch_scc0 QA_PJ0
    v_mov_b32 v16, 162816
GF_4:
    ds_read_b32 v17, v16
    s_waitcnt lgkmcnt(0)
    v_readfirstlane_b32 s55, v17
    s_nop 0
    s_cmp_eq_u32 s55, 0
    s_cbranch_scc1 GF_4
    s_and_b32 s55, s55, 1
    s_cmp_eq_u32 s99, 0
    s_cbranch_scc0 PR_W2
    v_mov_b32 v28, 162820
WR_5:
    ds_read_b32 v29, v28
    s_waitcnt lgkmcnt(0)
    v_cmp_eq_u32 vcc, 0, v29
    s_cbranch_vccnz WR_5
    s_and_b32 s56, s15, 3
    s_add_u32 s56, s56, 16
    s_lshl_b32 s56, s56, 2
    s_add_u32 s56, s56, s13
    s_mul_i32 s56, s56, 9216
    s_add_u32 s56, s56, 0
    s_add_u32 s56, s56, s97
    buffer_load_dwordx4 v[76:79], v1, s[4:7], s56 offen offset:0
    buffer_load_dwordx4 v[80:83], v1, s[4:7], s56 offen offset:1024
    buffer_load_dwordx4 v[84:87], v1, s[4:7], s56 offen offset:2048
    buffer_load_dwordx4 v[88:91], v1, s[4:7], s56 offen offset:3072
    s_add_u32 s56, s56, 4096
    buffer_load_dwordx4 v[92:95], v1, s[4:7], s56 offen offset:0
    buffer_load_dwordx4 v[96:99], v1, s[4:7], s56 offen offset:1024
    buffer_load_dwordx4 v[100:103], v1, s[4:7], s56 offen offset:2048
    buffer_load_dwordx4 v[104:107], v1, s[4:7], s56 offen offset:3072
    s_add_u32 s56, s56, 4096
    buffer_load_dwordx4 v[108:111], v1, s[4:7], s56 offen offset:0
PR_W2:
    s_waitcnt vmcnt(0)
    s_branch QA_PJ0
PR_F:
    v_mov_b32 v8, 162816
    v_mov_b32 v9, 0
    ds_write_b32 v8, v9
    ds_write_b32 v8, v9 offset:4
    s_lshl_b32 s20, s13, 2
    s_add_u32 s20, s20, 163344
    v_mov_b32 v10, s20
    v_mov_b32 v11, 0
    ds_write_b32 v10, v11
    s_lshr_b32 s21, s37, 2
    s_lshl_b32 s21, s21, 1
    s_and_b32 s22, s37, 1
    s_add_u32 s21, s21, s22
    s_and_b32 s22, s37, 2
    s_lshl_b32 s22, s22, 3
    s_add_u32 s37, s21, s22
    s_mul_i32 s21, s36, 9
    s_add_u32 s21, s21, s37
    s_mov_b32 s92, s21
    s_mov_b32 s84, 1152
    s_mov_b32 s86, 36
    s_mov_b32 s88, 36864
    s_mov_b32 s91, 0
    s_mov_b32 s35, 1
    s_mov_b32 s2, 663552
    s_lshr_b32 s22, s21, 1
    s_and_b32 s23, s21, 1
    s_mul_i32 s85, s23, 576
    s_lshl_b32 s89, s22, 4
    s_lshl_b32 s24, s22, 10
    s_add_u32 s24, s24, s97
    s_mul_i32 s87, s23, 294912
    s_add_u32 s87, s87, s24
    s_mul_i32 s90, s23, 36864
    s_add_u32 s90, s90, 589824
    s_add_u32 s90, s90, s24
    s_mov_b32 s20, 15023104
    s_waitcnt lgkmcnt(0)
    s_load_dword s96, s[4:5], s20
    s_mov_b32 s0, s70
    s_mov_b32 s1, s71
    s_cmp_eq_u32 s12, 2
    s_cbranch_scc0 PR_F0
    s_sub_u32 s22, s37, 9
    s_cmp_lt_u32 s22, 7
    s_cbranch_scc0 PR_F0
    s_getpc_b64 s[32:33]
PR_PC2:
    s_sub_u32 s32, s32, PR_PC2-interleave_layers__grouped_kv_mqa__sliding_block__prompt_kernel
    s_subb_u32 s33, s33, 0
    s_lshl_b32 s22, s22, 13
    v_lshlrev_b32 v5, 7, v0
    v_add_u32 v5, s22, v5
    v_min_u32 v5, K1_END-interleave_layers__grouped_kv_mqa__sliding_block__prompt_kernel, v5
    global_load_dword v16, v5, s[32:33]
PR_F0:
    s_cmp_eq_u32 s12, 3
    s_cbranch_scc0 PR_F1
    s_getreg_b32 s34, hwreg(HW_REG_XCC_ID)
    s_lshl_b32 s22, s49, 5
    s_add_u32 s22, s22, 262144
    v_mov_b32 v13, s34
    v_mov_b32 v14, s22
    s_waitcnt lgkmcnt(0)
    s_add_u32 s22, s96, 0x9e3779b9
    v_mov_b32 v12, s22
    s_mov_b64 exec, 1
    buffer_store_dwordx2 v[12:13], v14, s[4:7], s42 offen sc1
    s_mov_b64 exec, -1
    v_mov_b32 v24, 0
    v_mov_b32 v25, 0
    v_mov_b32 v26, 0
    v_mov_b32 v27, 0
    s_mul_i32 s22, s49, 320
    s_add_u32 s22, s22, 14531584
    buffer_store_dwordx4 v[24:27], v1, s[4:7], s22 offen sc1
    buffer_store_dwordx4 v[24:27], v1, s[4:7], s22 offen offset:256 sc1
PR_F1:
    s_add_u32 s24, s89, 0
    s_add_u32 s25, s89, 2
    s_add_u32 s26, s89, 4
    s_add_u32 s27, s89, 6
    s_add_u32 s28, s89, 8
    s_add_u32 s29, s89, 10
    s_add_u32 s30, s89, 12
    s_add_u32 s31, s89, 14
    s_cmp_ge_u32 s13, 2
    s_cbranch_scc1 PR_IDLE
    s_lshl_b32 s22, s13, 5
    s_add_u32 s22, s22, s37
    s_cmp_lt_u32 s22, 9
    s_cbranch_scc1 PR_GO
    s_mov_b32 s35, 0
    s_mul_i32 s21, s36, 23
    s_add_u32 s21, s21, s37
    s_sub_u32 s21, s21, 9
    s_lshl_b32 s22, s37, 3
    s_add_u32 s22, s22, s36
    s_add_u32 s22, s22, 112
    s_cmp_lt_u32 s37, 9
    s_cselect_b32 s22, 400, s22
    s_cmp_eq_u32 s13, 0
    s_cselect_b32 s21, s21, s22
    s_cmp_lt_u32 s21, 216
    s_cbranch_scc0 PR_D2
    s_mov_b32 s0, s80
    s_mov_b32 s1, s81
    s_mov_b32 s2, 1990656
    s_mov_b32 s84, 3456
    s_mov_b32 s91, 1
    s_mov_b32 s88, 124928
    s_mul_i32 s22, s21, 171
    s_lshr_b32 s22, s22, 10
    s_mul_i32 s23, s22, 6
    s_sub_u32 s23, s21, s23
    s_mul_i32 s85, s23, 576
    s_lshl_b32 s89, s22, 4
    s_and_b32 s21, s23, 1
    s_lshr_b32 s23, s23, 1
    s_mul_i32 s87, s21, 999424
    s_add_u32 s87, s87, 2067456
    s_mul_i32 s90, s22, 384
    s_add_u32 s90, s90, s87
    s_add_u32 s90, s90, 73728
    s_lshl_b32 s21, s23, 6
    s_add_u32 s90, s90, s21
    s_lshl_b32 s22, s22, 10
    s_add_u32 s87, s87, s22
    s_sub_u32 s21, s23, 1
    s_mul_i32 s21, s21, 36864
    s_cmp_eq_u32 s23, 0
    s_cselect_b32 s21, 88064, s21
    s_add_u32 s87, s87, s21
    s_add_u32 s24, s89, 0
    s_add_u32 s25, s89, 2
    s_add_u32 s26, s89, 4
    s_add_u32 s27, s89, 6
    s_add_u32 s28, s89, 8
    s_add_u32 s29, s89, 10
    s_add_u32 s30, s89, 12
    s_add_u32 s31, s89, 14
    s_branch PR_GO
PR_D2:
    s_cmp_lt_u32 s21, 360
    s_cbranch_scc0 PR_IDLE
    s_sub_u32 s21, s21, 216
    s_mov_b32 s91, 2
    s_mov_b32 s86, 32
    s_cmp_lt_u32 s21, 72
    s_cselect_b32 s0, s76, s82
    s_cselect_b32 s1, s77, s83
    s_cselect_b32 s22, 0, 72
    s_mov_b32 s87, 1403904
    s_cselect_b32 s87, 740352, s87
    s_sub_u32 s21, s21, s22
    s_lshr_b32 s22, s21, 1
    s_and_b32 s23, s21, 1
    s_mul_i32 s85, s23, 576
    s_mul_i32 s23, s23, 331776
    s_add_u32 s87, s87, s23
    s_lshl_b32 s23, s22, 10
    s_add_u32 s87, s87, s23
    s_add_u32 s90, s87, 294912
    s_mul_i32 s89, s22, 18
    s_add_u32 s24, s89, 0
    s_add_u32 s25, s89, 2
    s_add_u32 s26, s89, 4
    s_add_u32 s27, s89, 6
    s_add_u32 s28, s89, 8
    s_add_u32 s29, s89, 10
    s_add_u32 s30, s89, 12
    s_add_u32 s31, s89, 14
    s_cmp_lt_u32 s22, 32
    s_cbranch_scc1 PR_GO
    s_sub_u32 s22, s22, 32
    s_mul_i32 s89, s22, 144
    s_add_u32 s24, s89, 16
    s_add_u32 s25, s89, 34
    s_add_u32 s26, s89, 88
    s_add_u32 s27, s89, 106
    s_add_u32 s28, s89, 52
    s_add_u32 s29, s89, 70
    s_add_u32 s30, s89, 124
    s_add_u32 s31, s89, 142
PR_GO:
    s_mul_i32 s68, s24, s84
    s_mul_i32 s69, s25, s84
    s_mul_i32 s70, s26, s84
    s_mul_i32 s71, s27, s84
    s_mul_i32 s72, s28, s84
    s_mul_i32 s73, s29, s84
    s_mul_i32 s74, s30, s84
    s_mul_i32 s75, s31, s84
    s_cmp_eq_u32 s35, 0
    s_cselect_b32 s63, 1, 0
    s_cbranch_scc1 PR_IDLE
    s_mov_b32 s33, 40960
    v_mul_lo_u32 v5, v3, s84
    v_add_u32 v5, s85, v5
    v_bfe_u32 v6, v0, 1, 4
    v_mul_lo_u32 v6, v6, s86
    v_and_b32 v7, 1, v0
    v_lshl_add_u32 v6, v7, 4, v6
    v_add_u32 v5, v5, v6
    s_mov_b32 s32, s33
    s_mov_b32 m0, s32
    s_add_u32 s32, s32, 1024
    buffer_load_dwordx4 v5, s[0:3], s68 offen lds
    s_mov_b32 m0, s32
    s_add_u32 s32, s32, 1024
    buffer_load_dwordx4 v5, s[0:3], s69 offen lds
    s_mov_b32 m0, s32
    s_add_u32 s32, s32, 1024
    buffer_load_dwordx4 v5, s[0:3], s70 offen lds
    s_mov_b32 m0, s32
    s_add_u32 s32, s32, 1024
    buffer_load_dwordx4 v5, s[0:3], s71 offen lds
    s_mov_b32 m0, s32
    s_add_u32 s32, s32, 1024
    buffer_load_dwordx4 v5, s[0:3], s72 offen lds
    s_mov_b32 m0, s32
    s_add_u32 s32, s32, 1024
    buffer_load_dwordx4 v5, s[0:3], s73 offen lds
    s_mov_b32 m0, s32
    s_add_u32 s32, s32, 1024
    buffer_load_dwordx4 v5, s[0:3], s74 offen lds
    s_mov_b32 m0, s32
    s_add_u32 s32, s32, 1024
    buffer_load_dwordx4 v5, s[0:3], s75 offen lds
    v_bfe_u32 v5, v0, 4, 1
    v_mul_lo_u32 v5, v5, s84
    v_add_u32 v5, s85, v5
    s_cmp_eq_u32 s91, 2
    s_cselect_b32 s22, 4, 36
    s_mov_b32 s23, 512
    s_cselect_b32 s23, s23, 32
    v_and_b32 v6, 15, v0
    v_mul_lo_u32 v6, v6, s22
    v_add3_u32 v5, v5, v6, s23
    s_mov_b32 exec_hi, 0
    s_mov_b32 m0, s32
    s_add_u32 s32, s32, 128
    buffer_load_dword v5, s[0:3], s68 offen lds
    s_mov_b32 m0, s32
    s_add_u32 s32, s32, 128
    buffer_load_dword v5, s[0:3], s69 offen lds
    s_mov_b32 m0, s32
    s_add_u32 s32, s32, 128
    buffer_load_dword v5, s[0:3], s70 offen lds
    s_mov_b32 m0, s32
    s_add_u32 s32, s32, 128
    buffer_load_dword v5, s[0:3], s71 offen lds
    s_mov_b32 m0, s32
    s_add_u32 s32, s32, 128
    buffer_load_dword v5, s[0:3], s72 offen lds
    s_mov_b32 m0, s32
    s_add_u32 s32, s32, 128
    buffer_load_dword v5, s[0:3], s73 offen lds
    s_mov_b32 m0, s32
    s_add_u32 s32, s32, 128
    buffer_load_dword v5, s[0:3], s74 offen lds
    s_mov_b32 m0, s32
    s_add_u32 s32, s32, 128
    buffer_load_dword v5, s[0:3], s75 offen lds
    s_mov_b64 exec, -1
    v_bfe_u32 v7, v0, 2, 2
    v_lshl_add_u32 v7, v3, 2, v7
    v_bfe_u32 v8, v0, 4, 1
    v_lshlrev_b32 v8, 5, v8
    v_and_b32 v9, 3, v0
    v_lshl_add_u32 v8, v9, 3, v8
    v_add_u32 v8, s33, v8
    v_lshl_add_u32 v5, v7, 9, v8
    v_lshl_add_u32 v6, v7, 6, v8
    v_lshrrev_b32 v7, 2, v2
    s_mov_b32 s22, 124928
    v_mul_lo_u32 v7, v7, s22
    v_mul_u32_u24 v8, 192, v3
    v_lshlrev_b32 v9, 4, v9
    v_add3_u32 v7, v7, v8, v9
    s_cmp_eq_u32 s91, 1
    s_cselect_b64 vcc, -1, 0
    v_cndmask_b32 v7, v1, v7, vcc
    s_waitcnt vmcnt(0) lgkmcnt(0)
    s_add_u32 s96, s96, 0x9e3779b9
    ds_read_b64_tr_b16 v[20:21], v5 offset:0
    ds_read_b64_tr_b16 v[22:23], v5 offset:4096
    ds_read_b64_tr_b16 v[24:25], v5 offset:64
    ds_read_b64_tr_b16 v[26:27], v5 offset:4160
    ds_read_b64_tr_b16 v[28:29], v5 offset:128
    ds_read_b64_tr_b16 v[30:31], v5 offset:4224
    ds_read_b64_tr_b16 v[32:33], v5 offset:192
    ds_read_b64_tr_b16 v[34:35], v5 offset:4288
    ds_read_b64_tr_b16 v[36:37], v5 offset:256
    ds_read_b64_tr_b16 v[38:39], v5 offset:4352
    ds_read_b64_tr_b16 v[40:41], v5 offset:320
    ds_read_b64_tr_b16 v[42:43], v5 offset:4416
    ds_read_b64_tr_b16 v[44:45], v5 offset:384
    ds_read_b64_tr_b16 v[46:47], v5 offset:4480
    ds_read_b64_tr_b16 v[48:49], v5 offset:448
    ds_read_b64_tr_b16 v[50:51], v5 offset:4544
    ds_read_b64_tr_b16 v[52:53], v6 offset:8192
    ds_read_b64_tr_b16 v[54:55], v6 offset:8704
    s_waitcnt lgkmcnt(0)
    buffer_store_dwordx4 v[20:23], v1, s[4:7], s87 offen sc1
    s_add_u32 s87, s87, s88
    buffer_store_dwordx4 v[24:27], v1, s[4:7], s87 offen sc1
    s_add_u32 s87, s87, s88
    buffer_store_dwordx4 v[28:31], v1, s[4:7], s87 offen sc1
    s_add_u32 s87, s87, s88
    buffer_store_dwordx4 v[32:35], v1, s[4:7], s87 offen sc1
    s_add_u32 s87, s87, s88
    buffer_store_dwordx4 v[36:39], v1, s[4:7], s87 offen sc1
    s_add_u32 s87, s87, s88
    buffer_store_dwordx4 v[40:43], v1, s[4:7], s87 offen sc1
    s_add_u32 s87, s87, s88
    buffer_store_dwordx4 v[44:47], v1, s[4:7], s87 offen sc1
    s_add_u32 s87, s87, s88
    buffer_store_dwordx4 v[48:51], v1, s[4:7], s87 offen sc1
    s_add_u32 s87, s87, s88
    buffer_store_dwordx4 v[52:55], v7, s[4:7], s90 offen sc1
    s_lshl_b32 s20, s92, 7
    s_add_u32 s20, s20, 295936
    v_mul_u32_u24 v8, 9216, v0
    v_add_u32 v8, s20, v8
    v_mov_b32 v9, s96
    s_waitcnt vmcnt(0)
    s_mov_b64 exec, 0xff
    buffer_store_dword v9, v8, s[4:7], s42 offen sc1
    s_mov_b64 exec, -1
    s_barrier
    s_branch PR_G3
PR_IDLE:
    s_barrier
    s_waitcnt lgkmcnt(0)
    s_add_u32 s96, s96, 0x9e3779b9
PR_G3:
    s_cmp_eq_u32 s12, 3
    s_cbranch_scc0 PR_M0
    s_and_b32 s21, s49, 0x380
    s_lshl_b32 s21, s21, 5
    s_add_u32 s21, s21, 262144
    v_lshlrev_b32 v9, 7, v2
    v_add_u32 v9, s21, v9
    s_mov_b32 s38, 0
POLL_6:
    buffer_load_dwordx2 v[10:11], v9, s[4:7], s42 offen sc1
    s_waitcnt vmcnt(0)
    v_cmp_ne_u32 vcc, s96, v10
    s_cbranch_vccz POLLD_7
    s_add_u32 s38, s38, 1
    s_cmp_lt_u32 s38, 200000
    s_cbranch_scc1 POLL_6
POLLD_7:
    v_cmp_eq_u32 vcc, s34, v11
    s_nop 0
    s_cmp_eq_u64 vcc, -1
    s_cselect_b32 s20, 3, 2
    v_mov_b32 v8, s20
    v_mov_b32 v9, 162816
    ds_write_b32 v9, v8
PR_M0:
    v_mov_b32 v10, 162816
GF_8:
    ds_read_b32 v11, v10
    s_waitcnt lgkmcnt(0)
    v_readfirstlane_b32 s55, v11
    s_nop 0
    s_cmp_eq_u32 s55, 0
    s_cbranch_scc1 GF_8
    s_and_b32 s55, s55, 1
    s_lshl_b32 s20, s49, 3
    s_lshl_b32 s21, s13, 2
    s_add_u32 s20, s20, s21
    s_add_u32 s20, s20, 131072
    v_mov_b32 v8, s96
    v_mov_b32 v9, s20
    s_waitcnt vmcnt(0)
    s_mov_b64 exec, 1
    s_cmp_eq_u32 s55, 0
    s_cbranch_scc1 LS_9
    buffer_store_dword v8, v9, s[4:7], s42 offen
    s_branch LD_10
LS_9:
    buffer_store_dword v8, v9, s[4:7], s42 offen sc1
LD_10:
    s_mov_b64 exec, -1
    s_cmp_eq_u32 s12, 2
    s_cbranch_scc0 PR_G5
    s_mul_i32 s20, s36, 9216
    s_add_u32 s20, s20, 295936
    v_lshlrev_b32 v8, 7, v0
    v_add_u32 v8, s20, v8
    s_mov_b32 s38, 0
POLL_11:
    buffer_load_dword v10, v8, s[4:7], s42 offen sc1
    buffer_load_dword v11, v8, s[4:7], s42 offen offset:1024 sc1
    s_waitcnt vmcnt(0)
    v_xor_b32 v10, s96, v10
    v_xor_b32 v11, s96, v11
    v_or_b32 v10, v10, v11
    v_cmp_ne_u32 vcc, 0, v10
    s_cbranch_vccz POLLD_12
    s_sleep 4
    s_add_u32 s38, s38, 1
    s_cmp_lt_u32 s38, 200000
    s_cbranch_scc1 POLL_11
POLLD_12:
    v_mov_b32 v8, 162820
    v_mov_b32 v9, 1
    ds_write_b32 v8, v9
PR_G5:
    s_cmp_eq_u32 s12, 3
    s_cbranch_scc0 PR_G7
    s_xor_b32 s23, s37, 31
    v_lshrrev_b32 v6, 3, v0
    v_mul_u32_u24 v6, 36864, v6
    v_and_b32 v7, 7, v0
    v_lshlrev_b32 v7, 7, v7
    v_add_u32 v6, v6, v7
PR_G6:
    s_mul_i32 s20, s36, 9216
    s_lshl_b32 s21, s23, 7
    s_add_u32 s20, s20, s21
    s_add_u32 s20, s20, 295936
    v_mov_b32 v8, s20
    s_mov_b32 s38, 0
POLL_13:
    buffer_load_dword v10, v8, s[4:7], s42 offen sc1
    s_waitcnt vmcnt(0)
    v_cmp_ne_u32 vcc, s96, v10
    s_cbranch_vccz POLLD_14
    s_sleep 2
    s_add_u32 s38, s38, 1
    s_cmp_lt_u32 s38, 200000
    s_cbranch_scc1 POLL_13
POLLD_14:
    s_lshr_b32 s20, s23, 1
    s_lshl_b32 s20, s20, 10
    s_add_u32 s20, s20, 0
    s_and_b32 s21, s23, 1
    s_mul_i32 s22, s21, 294912
    s_add_u32 s22, s22, s20
    s_mul_i32 s21, s21, 36864
    s_add_u32 s21, s21, s20
    s_add_u32 s21, s21, 589824
    buffer_load_dword v11, v6, s[4:7], s22 offen sc1
    s_mov_b64 exec, 0xff
    buffer_load_dword v12, v7, s[4:7], s21 offen sc1
    s_mov_b64 exec, -1
    s_add_u32 s23, s23, 32
    s_cmp_lt_u32 s23, 72
    s_cbranch_scc1 PR_G6
PR_G7:
    v_mov_b32 v5, 0xdddddddd
    v_mov_b32 v7, 0
    v_mov_b32 v37, 0
    v_mov_b32 v39, 0
    s_movk_i32 s39, 304
    s_mul_i32 s24, s19, 75776
    v_add_u32 v16, s24, v1
    v_lshlrev_b32 v17, 2, v2
    v_add_u32 v17, s24, v17
    v_min_u32 v18, 18, v2
    v_lshlrev_b32 v18, 4, v18
    v_mad_u32_u24 v18, v3, s39, v18
    v_add_u32 v18, s24, v18
    v_mov_b32 v40, 0
    v_mov_b32 v41, 0
    v_mov_b32 v42, 0
    v_mov_b32 v43, 0
    v_mov_b32 v44, 0
    v_mov_b32 v45, 0
    v_mov_b32 v46, 0
    v_mov_b32 v47, 0
    v_mov_b32 v48, 0
    v_mov_b32 v49, 0
    v_mov_b32 v50, 0
    v_mov_b32 v51, 0
    v_mov_b32 v52, 0
    v_mov_b32 v53, 0
    v_mov_b32 v54, 0
    v_mov_b32 v55, 0
    v_mov_b32 v56, 0
    v_mov_b32 v57, 0
    v_mov_b32 v58, 0
    v_mov_b32 v59, 0
    v_mov_b32 v60, 0
    v_mov_b32 v61, 0
    v_mov_b32 v62, 0
    v_mov_b32 v63, 0
    v_mov_b32 v64, 0
    v_mov_b32 v65, 0
    v_mov_b32 v66, 0
    v_mov_b32 v67, 0
    v_mov_b32 v68, 0
    v_mov_b32 v69, 0
    v_mov_b32 v70, 0
    v_mov_b32 v71, 0
    v_mov_b32 v19, 162304
    ds_write_b32 v19, v7
    s_lshl_b32 s20, s14, 4
    s_lshl_b32 s21, s15, 2
    s_add_u32 s20, s20, s21
    s_add_u32 s20, s20, s13
    s_lshl_b32 s20, s20, 8
    s_add_u32 s23, s20, s44
    v_lshlrev_b32 v19, 3, v2
    v_lshl_add_u32 v19, v3, 2, v19
    s_mul_i32 s35, s19, 75776
    s_lshl_b32 s34, s13, 10
    s_add_u32 s35, s35, s34
    s_add_u32 s34, s35, s43
    v_mov_b32 v72, 0
    v_mov_b32 v28, 162820
WR_15:
    ds_read_b32 v29, v28
    s_waitcnt lgkmcnt(0)
    v_cmp_eq_u32 vcc, 0, v29
    s_cbranch_vccnz WR_15
    s_lshl_b32 s57, s15, 2
    s_add_u32 s57, s57, s13
    s_mul_i32 s57, s57, 36864
    s_add_u32 s57, s57, 0
    s_add_u32 s57, s57, s97
    buffer_load_dwordx4 v[252:255], v1, s[4:7], s57 offen offset:0
    buffer_load_dwordx4 v[248:251], v1, s[4:7], s57 offen offset:1024
    buffer_load_dwordx4 v[244:247], v1, s[4:7], s57 offen offset:2048
    buffer_load_dwordx4 v[240:243], v1, s[4:7], s57 offen offset:3072
    s_add_u32 s57, s57, 4096
    buffer_load_dwordx4 v[236:239], v1, s[4:7], s57 offen offset:0
    buffer_load_dwordx4 v[232:235], v1, s[4:7], s57 offen offset:1024
    buffer_load_dwordx4 v[228:231], v1, s[4:7], s57 offen offset:2048
    buffer_load_dwordx4 v[224:227], v1, s[4:7], s57 offen offset:3072
    s_add_u32 s57, s57, 4096
    buffer_load_dwordx4 v[220:223], v1, s[4:7], s57 offen offset:0
    buffer_load_dwordx4 v[216:219], v1, s[4:7], s57 offen offset:1024
    v_mov_b32 v10, 163360
PS_16:
    ds_read_b128 v[12:15], v10
    s_waitcnt lgkmcnt(0)
    v_and_b32 v12, v12, v13
    v_and_b32 v14, v14, v15
    v_and_b32 v12, v12, v14
    v_cmp_eq_u32 vcc, 0, v12
    s_cbranch_vccnz PS_16
    ds_read_b128 v[76:79], v1 offset:0
    ds_read_b128 v[80:83], v1 offset:1024
    ds_read_b128 v[84:87], v1 offset:2048
    ds_read_b128 v[108:111], v1 offset:3072
    ds_read_b128 v[20:23], v1 offset:4096
    buffer_load_dwordx4 v[212:215], v1, s[4:7], s57 offen offset:2048
    ds_read_b128 v[24:27], v1 offset:5120
    s_waitcnt vmcnt(10) lgkmcnt(5)
    v_dot2c_f32_bf16 v72, s98, v252
    v_dot2c_f32_bf16 v72, s98, v253
    v_dot2c_f32_bf16 v72, s98, v254
    v_dot2c_f32_bf16 v72, s98, v255
    v_mfma_f32_32x32x16_bf16 v[88:103], v[252:255], v[76:79], 0
    buffer_load_dwordx4 v[208:211], v1, s[4:7], s57 offen offset:3072
    ds_read_b128 v[76:79], v1 offset:6144
    s_waitcnt vmcnt(10) lgkmcnt(5)
    v_dot2c_f32_bf16 v72, s98, v248
    v_dot2c_f32_bf16 v72, s98, v249
    v_dot2c_f32_bf16 v72, s98, v250
    v_dot2c_f32_bf16 v72, s98, v251
    v_mfma_f32_32x32x16_bf16 v[88:103], v[248:251], v[80:83], v[88:103]
    s_add_u32 s57, s57, 4096
    buffer_load_dwordx4 v[204:207], v1, s[4:7], s57 offen offset:0
    ds_read_b128 v[80:83], v1 offset:7168
    s_waitcnt vmcnt(10) lgkmcnt(5)
    v_dot2c_f32_bf16 v72, s98, v244
    v_dot2c_f32_bf16 v72, s98, v245
    v_dot2c_f32_bf16 v72, s98, v246
    v_dot2c_f32_bf16 v72, s98, v247
    v_mfma_f32_32x32x16_bf16 v[88:103], v[244:247], v[84:87], v[88:103]
    buffer_load_dwordx4 v[200:203], v1, s[4:7], s57 offen offset:1024
    ds_read_b128 v[84:87], v1 offset:8192
    s_waitcnt vmcnt(10) lgkmcnt(5)
    v_dot2c_f32_bf16 v72, s98, v240
    v_dot2c_f32_bf16 v72, s98, v241
    v_dot2c_f32_bf16 v72, s98, v242
    v_dot2c_f32_bf16 v72, s98, v243
    v_mfma_f32_32x32x16_bf16 v[88:103], v[240:243], v[108:111], v[88:103]
    buffer_load_dwordx4 v[196:199], v1, s[4:7], s57 offen offset:2048
    ds_read_b128 v[108:111], v1 offset:9216
    s_waitcnt vmcnt(10) lgkmcnt(5)
    v_dot2c_f32_bf16 v72, s98, v236
    v_dot2c_f32_bf16 v72, s98, v237
    v_dot2c_f32_bf16 v72, s98, v238
    v_dot2c_f32_bf16 v72, s98, v239
    v_mfma_f32_32x32x16_bf16 v[88:103], v[236:239], v[20:23], v[88:103]
    buffer_load_dwordx4 v[192:195], v1, s[4:7], s57 offen offset:3072
    ds_read_b128 v[20:23], v1 offset:10240
    s_waitcnt vmcnt(10) lgkmcnt(5)
    v_dot2c_f32_bf16 v72, s98, v232
    v_dot2c_f32_bf16 v72, s98, v233
    v_dot2c_f32_bf16 v72, s98, v234
    v_dot2c_f32_bf16 v72, s98, v235
    v_mfma_f32_32x32x16_bf16 v[88:103], v[232:235], v[24:27], v[88:103]
    s_add_u32 s57, s57, 4096
    buffer_load_dwordx4 v[188:191], v1, s[4:7], s57 offen offset:0
    ds_read_b128 v[24:27], v1 offset:11264
    s_waitcnt vmcnt(10) lgkmcnt(5)
    v_dot2c_f32_bf16 v72, s98, v228
    v_dot2c_f32_bf16 v72, s98, v229
    v_dot2c_f32_bf16 v72, s98, v230
    v_dot2c_f32_bf16 v72, s98, v231
    v_mfma_f32_32x32x16_bf16 v[88:103], v[228:231], v[76:79], v[88:103]
    buffer_load_dwordx4 v[184:187], v1, s[4:7], s57 offen offset:1024
    ds_read_b128 v[76:79], v1 offset:12288
    s_waitcnt vmcnt(10) lgkmcnt(5)
    v_dot2c_f32_bf16 v72, s98, v224
    v_dot2c_f32_bf16 v72, s98, v225
    v_dot2c_f32_bf16 v72, s98, v226
    v_dot2c_f32_bf16 v72, s98, v227
    v_mfma_f32_32x32x16_bf16 v[88:103], v[224:227], v[80:83], v[88:103]
    buffer_load_dwordx4 v[180:183], v1, s[4:7], s57 offen offset:2048
    ds_read_b128 v[80:83], v1 offset:13312
    s_waitcnt vmcnt(10) lgkmcnt(5)
    v_dot2c_f32_bf16 v72, s98, v220
    v_dot2c_f32_bf16 v72, s98, v221
    v_dot2c_f32_bf16 v72, s98, v222
    v_dot2c_f32_bf16 v72, s98, v223
    v_mfma_f32_32x32x16_bf16 v[88:103], v[220:223], v[84:87], v[88:103]
    buffer_load_dwordx4 v[176:179], v1, s[4:7], s57 offen offset:3072
    ds_read_b128 v[84:87], v1 offset:14336
    s_waitcnt vmcnt(10) lgkmcnt(5)
    v_dot2c_f32_bf16 v72, s98, v216
    v_dot2c_f32_bf16 v72, s98, v217
    v_dot2c_f32_bf16 v72, s98, v218
    v_dot2c_f32_bf16 v72, s98, v219
    v_mfma_f32_32x32x16_bf16 v[88:103], v[216:219], v[108:111], v[88:103]
    s_add_u32 s57, s57, 4096
    buffer_load_dwordx4 v[172:175], v1, s[4:7], s57 offen offset:0
    ds_read_b128 v[108:111], v1 offset:15360
    s_waitcnt vmcnt(10) lgkmcnt(5)
    v_dot2c_f32_bf16 v72, s98, v212
    v_dot2c_f32_bf16 v72, s98, v213
    v_dot2c_f32_bf16 v72, s98, v214
    v_dot2c_f32_bf16 v72, s98, v215
    v_mfma_f32_32x32x16_bf16 v[88:103], v[212:215], v[20:23], v[88:103]
    buffer_load_dwordx4 v[168:171], v1, s[4:7], s57 offen offset:1024
    ds_read_b128 v[20:23], v1 offset:16384
    s_waitcnt vmcnt(10) lgkmcnt(5)
    v_dot2c_f32_bf16 v72, s98, v208
    v_dot2c_f32_bf16 v72, s98, v209
    v_dot2c_f32_bf16 v72, s98, v210
    v_dot2c_f32_bf16 v72, s98, v211
    v_mfma_f32_32x32x16_bf16 v[88:103], v[208:211], v[24:27], v[88:103]
    buffer_load_dwordx4 v[164:167], v1, s[4:7], s57 offen offset:2048
    ds_read_b128 v[24:27], v1 offset:17408
    s_waitcnt vmcnt(10) lgkmcnt(5)
    v_dot2c_f32_bf16 v72, s98, v204
    v_dot2c_f32_bf16 v72, s98, v205
    v_dot2c_f32_bf16 v72, s98, v206
    v_dot2c_f32_bf16 v72, s98, v207
    v_mfma_f32_32x32x16_bf16 v[88:103], v[204:207], v[76:79], v[88:103]
    buffer_load_dwordx4 v[160:163], v1, s[4:7], s57 offen offset:3072
    ds_read_b128 v[76:79], v1 offset:18432
    s_waitcnt vmcnt(10) lgkmcnt(5)
    v_dot2c_f32_bf16 v72, s98, v200
    v_dot2c_f32_bf16 v72, s98, v201
    v_dot2c_f32_bf16 v72, s98, v202
    v_dot2c_f32_bf16 v72, s98, v203
    v_mfma_f32_32x32x16_bf16 v[88:103], v[200:203], v[80:83], v[88:103]
    s_add_u32 s57, s57, 4096
    buffer_load_dwordx4 v[156:159], v1, s[4:7], s57 offen offset:0
    ds_read_b128 v[80:83], v1 offset:19456
    s_waitcnt vmcnt(10) lgkmcnt(5)
    v_dot2c_f32_bf16 v72, s98, v196
    v_dot2c_f32_bf16 v72, s98, v197
    v_dot2c_f32_bf16 v72, s98, v198
    v_dot2c_f32_bf16 v72, s98, v199
    v_mfma_f32_32x32x16_bf16 v[88:103], v[196:199], v[84:87], v[88:103]
    buffer_load_dwordx4 v[152:155], v1, s[4:7], s57 offen offset:1024
    ds_read_b128 v[84:87], v1 offset:20480
    s_waitcnt vmcnt(10) lgkmcnt(5)
    v_dot2c_f32_bf16 v72, s98, v192
    v_dot2c_f32_bf16 v72, s98, v193
    v_dot2c_f32_bf16 v72, s98, v194
    v_dot2c_f32_bf16 v72, s98, v195
    v_mfma_f32_32x32x16_bf16 v[88:103], v[192:195], v[108:111], v[88:103]
    buffer_load_dwordx4 v[148:151], v1, s[4:7], s57 offen offset:2048
    ds_read_b128 v[108:111], v1 offset:21504
    s_waitcnt vmcnt(10) lgkmcnt(5)
    v_dot2c_f32_bf16 v72, s98, v188
    v_dot2c_f32_bf16 v72, s98, v189
    v_dot2c_f32_bf16 v72, s98, v190
    v_dot2c_f32_bf16 v72, s98, v191
    v_mfma_f32_32x32x16_bf16 v[88:103], v[188:191], v[20:23], v[88:103]
    buffer_load_dwordx4 v[144:147], v1, s[4:7], s57 offen offset:3072
    ds_read_b128 v[20:23], v1 offset:22528
    s_waitcnt vmcnt(10) lgkmcnt(5)
    v_dot2c_f32_bf16 v72, s98, v184
    v_dot2c_f32_bf16 v72, s98, v185
    v_dot2c_f32_bf16 v72, s98, v186
    v_dot2c_f32_bf16 v72, s98, v187
    v_mfma_f32_32x32x16_bf16 v[88:103], v[184:187], v[24:27], v[88:103]
    s_add_u32 s57, s57, 4096
    buffer_load_dwordx4 v[140:143], v1, s[4:7], s57 offen offset:0
    ds_read_b128 v[24:27], v1 offset:23552
    s_waitcnt vmcnt(10) lgkmcnt(5)
    v_dot2c_f32_bf16 v72, s98, v180
    v_dot2c_f32_bf16 v72, s98, v181
    v_dot2c_f32_bf16 v72, s98, v182
    v_dot2c_f32_bf16 v72, s98, v183
    v_mfma_f32_32x32x16_bf16 v[88:103], v[180:183], v[76:79], v[88:103]
    buffer_load_dwordx4 v[136:139], v1, s[4:7], s57 offen offset:1024
    ds_read_b128 v[76:79], v1 offset:24576
    s_waitcnt vmcnt(10) lgkmcnt(5)
    v_dot2c_f32_bf16 v72, s98, v176
    v_dot2c_f32_bf16 v72, s98, v177
    v_dot2c_f32_bf16 v72, s98, v178
    v_dot2c_f32_bf16 v72, s98, v179
    v_mfma_f32_32x32x16_bf16 v[88:103], v[176:179], v[80:83], v[88:103]
    buffer_load_dwordx4 v[132:135], v1, s[4:7], s57 offen offset:2048
    ds_read_b128 v[80:83], v1 offset:25600
    s_waitcnt vmcnt(10) lgkmcnt(5)
    v_dot2c_f32_bf16 v72, s98, v172
    v_dot2c_f32_bf16 v72, s98, v173
    v_dot2c_f32_bf16 v72, s98, v174
    v_dot2c_f32_bf16 v72, s98, v175
    v_mfma_f32_32x32x16_bf16 v[88:103], v[172:175], v[84:87], v[88:103]
    buffer_load_dwordx4 v[128:131], v1, s[4:7], s57 offen offset:3072
    ds_read_b128 v[84:87], v1 offset:26624
    s_waitcnt vmcnt(10) lgkmcnt(5)
    v_dot2c_f32_bf16 v72, s98, v168
    v_dot2c_f32_bf16 v72, s98, v169
    v_dot2c_f32_bf16 v72, s98, v170
    v_dot2c_f32_bf16 v72, s98, v171
    v_mfma_f32_32x32x16_bf16 v[88:103], v[168:171], v[108:111], v[88:103]
    s_add_u32 s57, s57, 4096
    buffer_load_dwordx4 v[124:127], v1, s[4:7], s57 offen offset:0
    ds_read_b128 v[108:111], v1 offset:27648
    s_waitcnt vmcnt(10) lgkmcnt(5)
    v_dot2c_f32_bf16 v72, s98, v164
    v_dot2c_f32_bf16 v72, s98, v165
    v_dot2c_f32_bf16 v72, s98, v166
    v_dot2c_f32_bf16 v72, s98, v167
    v_mfma_f32_32x32x16_bf16 v[88:103], v[164:167], v[20:23], v[88:103]
    buffer_load_dwordx4 v[120:123], v1, s[4:7], s57 offen offset:1024
    ds_read_b128 v[20:23], v1 offset:28672
    s_waitcnt vmcnt(10) lgkmcnt(5)
    v_dot2c_f32_bf16 v72, s98, v160
    v_dot2c_f32_bf16 v72, s98, v161
    v_dot2c_f32_bf16 v72, s98, v162
    v_dot2c_f32_bf16 v72, s98, v163
    v_mfma_f32_32x32x16_bf16 v[88:103], v[160:163], v[24:27], v[88:103]
    buffer_load_dwordx4 v[116:119], v1, s[4:7], s57 offen offset:2048
    ds_read_b128 v[24:27], v1 offset:29696
    s_waitcnt vmcnt(10) lgkmcnt(5)
    v_dot2c_f32_bf16 v72, s98, v156
    v_dot2c_f32_bf16 v72, s98, v157
    v_dot2c_f32_bf16 v72, s98, v158
    v_dot2c_f32_bf16 v72, s98, v159
    v_mfma_f32_32x32x16_bf16 v[88:103], v[156:159], v[76:79], v[88:103]
    buffer_load_dwordx4 v[112:115], v1, s[4:7], s57 offen offset:3072
    ds_read_b128 v[76:79], v1 offset:30720
    s_waitcnt vmcnt(10) lgkmcnt(5)
    v_dot2c_f32_bf16 v72, s98, v152
    v_dot2c_f32_bf16 v72, s98, v153
    v_dot2c_f32_bf16 v72, s98, v154
    v_dot2c_f32_bf16 v72, s98, v155
    v_mfma_f32_32x32x16_bf16 v[88:103], v[152:155], v[80:83], v[88:103]
    ds_read_b128 v[80:83], v1 offset:31744
    s_waitcnt vmcnt(9) lgkmcnt(5)
    v_dot2c_f32_bf16 v72, s98, v148
    v_dot2c_f32_bf16 v72, s98, v149
    v_dot2c_f32_bf16 v72, s98, v150
    v_dot2c_f32_bf16 v72, s98, v151
    v_mfma_f32_32x32x16_bf16 v[88:103], v[148:151], v[84:87], v[88:103]
    ds_read_b128 v[84:87], v1 offset:32768
    s_waitcnt vmcnt(8) lgkmcnt(5)
    v_dot2c_f32_bf16 v72, s98, v144
    v_dot2c_f32_bf16 v72, s98, v145
    v_dot2c_f32_bf16 v72, s98, v146
    v_dot2c_f32_bf16 v72, s98, v147
    v_mfma_f32_32x32x16_bf16 v[88:103], v[144:147], v[108:111], v[88:103]
    ds_read_b128 v[108:111], v1 offset:33792
    s_waitcnt vmcnt(7) lgkmcnt(5)
    v_dot2c_f32_bf16 v72, s98, v140
    v_dot2c_f32_bf16 v72, s98, v141
    v_dot2c_f32_bf16 v72, s98, v142
    v_dot2c_f32_bf16 v72, s98, v143
    v_mfma_f32_32x32x16_bf16 v[88:103], v[140:143], v[20:23], v[88:103]
    ds_read_b128 v[20:23], v1 offset:34816
    s_waitcnt vmcnt(6) lgkmcnt(5)
    v_dot2c_f32_bf16 v72, s98, v136
    v_dot2c_f32_bf16 v72, s98, v137
    v_dot2c_f32_bf16 v72, s98, v138
    v_dot2c_f32_bf16 v72, s98, v139
    v_mfma_f32_32x32x16_bf16 v[88:103], v[136:139], v[24:27], v[88:103]
    ds_read_b128 v[24:27], v1 offset:35840
    s_waitcnt vmcnt(5) lgkmcnt(5)
    v_dot2c_f32_bf16 v72, s98, v132
    v_dot2c_f32_bf16 v72, s98, v133
    v_dot2c_f32_bf16 v72, s98, v134
    v_dot2c_f32_bf16 v72, s98, v135
    v_mfma_f32_32x32x16_bf16 v[88:103], v[132:135], v[76:79], v[88:103]
    s_waitcnt vmcnt(4) lgkmcnt(4)
    v_dot2c_f32_bf16 v72, s98, v128
    v_dot2c_f32_bf16 v72, s98, v129
    v_dot2c_f32_bf16 v72, s98, v130
    v_dot2c_f32_bf16 v72, s98, v131
    v_mfma_f32_32x32x16_bf16 v[88:103], v[128:131], v[80:83], v[88:103]
    s_waitcnt vmcnt(3) lgkmcnt(3)
    v_dot2c_f32_bf16 v72, s98, v124
    v_dot2c_f32_bf16 v72, s98, v125
    v_dot2c_f32_bf16 v72, s98, v126
    v_dot2c_f32_bf16 v72, s98, v127
    v_mfma_f32_32x32x16_bf16 v[88:103], v[124:127], v[84:87], v[88:103]
    s_waitcnt vmcnt(2) lgkmcnt(2)
    v_dot2c_f32_bf16 v72, s98, v120
    v_dot2c_f32_bf16 v72, s98, v121
    v_dot2c_f32_bf16 v72, s98, v122
    v_dot2c_f32_bf16 v72, s98, v123
    v_mfma_f32_32x32x16_bf16 v[88:103], v[120:123], v[108:111], v[88:103]
    s_waitcnt vmcnt(1) lgkmcnt(1)
    v_dot2c_f32_bf16 v72, s98, v116
    v_dot2c_f32_bf16 v72, s98, v117
    v_dot2c_f32_bf16 v72, s98, v118
    v_dot2c_f32_bf16 v72, s98, v119
    v_mfma_f32_32x32x16_bf16 v[88:103], v[116:119], v[20:23], v[88:103]
    s_waitcnt vmcnt(0) lgkmcnt(0)
    v_dot2c_f32_bf16 v72, s98, v112
    v_dot2c_f32_bf16 v72, s98, v113
    v_dot2c_f32_bf16 v72, s98, v114
    v_dot2c_f32_bf16 v72, s98, v115
    v_mfma_f32_32x32x16_bf16 v[88:103], v[112:115], v[24:27], v[88:103]
    s_branch QA_FJ
K1_LOOP:
    s_cmp_eq_u32 s19, 0
    s_cbranch_scc1 QA_FULL
    s_setprio 2
    s_lshl_b32 s22, s14, 10
    s_add_u32 s22, s22, s41
    s_mul_i32 s25, s13, 9216
    s_add_u32 s24, s40, s48
    s_add_u32 s24, s24, s25
    s_lshl_b32 s20, s13, 2
    s_add_u32 s20, s20, 163328
    v_mov_b32 v16, s20
    v_mov_b32 v17, 0
    ds_write_b32 v16, v17
    s_lshl_b32 s20, s13, 2
    s_add_u32 s20, s20, 163408
    v_mov_b32 v16, s20
    v_mov_b32 v17, 0
    ds_write_b32 v16, v17
    v_mov_b32 v72, 0
    v_dot2c_f32_bf16 v72, s98, v76
    v_dot2c_f32_bf16 v72, s98, v77
    v_dot2c_f32_bf16 v72, s98, v78
    v_dot2c_f32_bf16 v72, s98, v79
    v_dot2c_f32_bf16 v72, s98, v80
    v_dot2c_f32_bf16 v72, s98, v81
    v_dot2c_f32_bf16 v72, s98, v82
    v_dot2c_f32_bf16 v72, s98, v83
    v_dot2c_f32_bf16 v72, s98, v84
    v_dot2c_f32_bf16 v72, s98, v85
    v_dot2c_f32_bf16 v72, s98, v86
    v_dot2c_f32_bf16 v72, s98, v87
    v_dot2c_f32_bf16 v72, s98, v88
    v_dot2c_f32_bf16 v72, s98, v89
    v_dot2c_f32_bf16 v72, s98, v90
    v_dot2c_f32_bf16 v72, s98, v91
    v_dot2c_f32_bf16 v72, s98, v92
    v_dot2c_f32_bf16 v72, s98, v93
    v_dot2c_f32_bf16 v72, s98, v94
    v_dot2c_f32_bf16 v72, s98, v95
    v_dot2c_f32_bf16 v72, s98, v96
    v_dot2c_f32_bf16 v72, s98, v97
    v_dot2c_f32_bf16 v72, s98, v98
    v_dot2c_f32_bf16 v72, s98, v99
    v_dot2c_f32_bf16 v72, s98, v100
    v_dot2c_f32_bf16 v72, s98, v101
    v_dot2c_f32_bf16 v72, s98, v102
    v_dot2c_f32_bf16 v72, s98, v103
    v_dot2c_f32_bf16 v72, s98, v104
    v_dot2c_f32_bf16 v72, s98, v105
    v_dot2c_f32_bf16 v72, s98, v106
    v_dot2c_f32_bf16 v72, s98, v107
    v_dot2c_f32_bf16 v72, s98, v108
    v_dot2c_f32_bf16 v72, s98, v109
    v_dot2c_f32_bf16 v72, s98, v110
    v_dot2c_f32_bf16 v72, s98, v111
    s_nop 2
    v_cvt_pk_bf16_f32 v73, v72, v72
    v_lshlrev_b32 v73, 16, v73
    v_sub_f32 v73, v72, v73
    v_cvt_pk_bf16_f32 v72, v72, v73
    v_mov_b32 v73, 0
    s_waitcnt lgkmcnt(0)
    v_lshlrev_b32 v16, 5, v2
    v_lshl_add_u32 v16, v3, 4, v16
    s_mov_b32 s38, 0
POLL_17:
    buffer_load_dwordx4 v[8:11], v16, s[4:7], s22 offen sc1
    s_waitcnt vmcnt(0)
    v_and_b32 v17, v9, v11
    v_cmp_le_i32 vcc, 0, v17
    s_cbranch_vccz POLLD_18
    s_add_u32 s38, s38, 1
    s_cmp_lt_u32 s38, 200000
    s_cbranch_scc1 POLL_17
POLLD_18:
    s_mov_b32 s21, s24
    buffer_load_dwordx4 v[32:35], v1, s[4:7], s21 offen offset:0 sc1
    buffer_load_dwordx4 v[36:39], v1, s[4:7], s21 offen offset:1024 sc1
    buffer_load_dwordx4 v[40:43], v1, s[4:7], s21 offen offset:2048 sc1
    buffer_load_dwordx4 v[44:47], v1, s[4:7], s21 offen offset:3072 sc1
    s_add_u32 s21, s21, 4096
    buffer_load_dwordx4 v[48:51], v1, s[4:7], s21 offen offset:0 sc1
    buffer_load_dwordx4 v[52:55], v1, s[4:7], s21 offen offset:1024 sc1
    buffer_load_dwordx4 v[56:59], v1, s[4:7], s21 offen offset:2048 sc1
    buffer_load_dwordx4 v[60:63], v1, s[4:7], s21 offen offset:3072 sc1
    s_add_u32 s21, s21, 4096
    buffer_load_dwordx4 v[64:67], v1, s[4:7], s21 offen offset:0 sc1
    s_barrier
    v_add_f32 v8, v8, v10
    v_add_f32 v9, v9, v11
    v_mov_b32 v10, v8
    v_mov_b32 v11, v9
    s_nop 0
    v_permlane32_swap_b32 v8, v10
    v_permlane32_swap_b32 v9, v11
    v_add_f32 v8, v8, v10
    v_add_f32 v9, v9, v11
    v_mul_f32 v8, 0x3ae38e39, v8
    v_mul_f32 v9, 0xbae38e39, v9
    v_fma_f32 v9, -v8, v8, v9
    v_max_f32 v9, 0, v9
    v_cvt_pk_bf16_f32 v7, -v8, -v8
    v_cvt_pk_bf16_f32 v9, v9, v9
    v_lshlrev_b32 v9, 16, v9
    v_add_f32 v9, 0x3727c5ac, v9
    v_cvt_pk_bf16_f32 v9, v9, v9
    v_lshlrev_b32 v9, 16, v9
    v_sqrt_f32 v9, v9
    s_nop 0
    v_cvt_pk_bf16_f32 v9, v9, v9
    v_lshlrev_b32 v9, 16, v9
    v_rcp_f32 v6, v9
    v_lshlrev_b32 v5, 2, v2
    v_add_u32 v5, 161792, v5
    ds_write_b32 v5, v6
    ds_write_b32 v5, v7 offset:128
    s_lshl_b32 s20, s13, 2
    s_add_u32 s20, s20, 163408
    v_mov_b32 v5, s20
    v_mov_b32 v69, 1
    ds_write_b32 v5, v69
    v_mov_b32 v69, 0
    v_mov_b32 v68, v7
    s_branch QA_PJ
QA_PJ0:
    v_mov_b32 v72, 0
    v_dot2c_f32_bf16 v72, s98, v76
    v_dot2c_f32_bf16 v72, s98, v77
    v_dot2c_f32_bf16 v72, s98, v78
    v_dot2c_f32_bf16 v72, s98, v79
    v_dot2c_f32_bf16 v72, s98, v80
    v_dot2c_f32_bf16 v72, s98, v81
    v_dot2c_f32_bf16 v72, s98, v82
    v_dot2c_f32_bf16 v72, s98, v83
    v_dot2c_f32_bf16 v72, s98, v84
    v_dot2c_f32_bf16 v72, s98, v85
    v_dot2c_f32_bf16 v72, s98, v86
    v_dot2c_f32_bf16 v72, s98, v87
    v_dot2c_f32_bf16 v72, s98, v88
    v_dot2c_f32_bf16 v72, s98, v89
    v_dot2c_f32_bf16 v72, s98, v90
    v_dot2c_f32_bf16 v72, s98, v91
    v_dot2c_f32_bf16 v72, s98, v92
    v_dot2c_f32_bf16 v72, s98, v93
    v_dot2c_f32_bf16 v72, s98, v94
    v_dot2c_f32_bf16 v72, s98, v95
    v_dot2c_f32_bf16 v72, s98, v96
    v_dot2c_f32_bf16 v72, s98, v97
    v_dot2c_f32_bf16 v72, s98, v98
    v_dot2c_f32_bf16 v72, s98, v99
    v_dot2c_f32_bf16 v72, s98, v100
    v_dot2c_f32_bf16 v72, s98, v101
    v_dot2c_f32_bf16 v72, s98, v102
    v_dot2c_f32_bf16 v72, s98, v103
    v_dot2c_f32_bf16 v72, s98, v104
    v_dot2c_f32_bf16 v72, s98, v105
    v_dot2c_f32_bf16 v72, s98, v106
    v_dot2c_f32_bf16 v72, s98, v107
    v_dot2c_f32_bf16 v72, s98, v108
    v_dot2c_f32_bf16 v72, s98, v109
    v_dot2c_f32_bf16 v72, s98, v110
    v_dot2c_f32_bf16 v72, s98, v111
    s_nop 2
    v_cvt_pk_bf16_f32 v73, v72, v72
    v_lshlrev_b32 v73, 16, v73
    v_sub_f32 v73, v72, v73
    v_cvt_pk_bf16_f32 v72, v72, v73
    v_mov_b32 v73, 0
QA_PJ:
    s_cmp_eq_u32 s15, 3
    s_cbranch_scc1 QA_SV
    v_mfma_f32_32x32x8_bf16 v[16:31], v[72:73], v[68:69], 0
    s_cmp_eq_u32 s18, 0
    s_cbranch_scc1 KW_19
    s_waitcnt vmcnt(8)
KW_19:
    v_mfma_f32_32x32x16_bf16 v[16:31], v[76:79], v[32:35], v[16:31]
    s_cbranch_scc1 KW_20
    s_waitcnt vmcnt(7)
KW_20:
    v_mfma_f32_32x32x16_bf16 v[16:31], v[80:83], v[36:39], v[16:31]
    s_cbranch_scc1 KW_21
    s_waitcnt vmcnt(6)
KW_21:
    v_mfma_f32_32x32x16_bf16 v[16:31], v[84:87], v[40:43], v[16:31]
    s_cbranch_scc1 KW_22
    s_waitcnt vmcnt(5)
KW_22:
    v_mfma_f32_32x32x16_bf16 v[16:31], v[88:91], v[44:47], v[16:31]
    s_cbranch_scc1 KW_23
    s_waitcnt vmcnt(4)
KW_23:
    v_mfma_f32_32x32x16_bf16 v[16:31], v[92:95], v[48:51], v[16:31]
    s_cbranch_scc1 KW_24
    s_waitcnt vmcnt(3)
KW_24:
    v_mfma_f32_32x32x16_bf16 v[16:31], v[96:99], v[52:55], v[16:31]
    s_cbranch_scc1 KW_25
    s_waitcnt vmcnt(2)
KW_25:
    v_mfma_f32_32x32x16_bf16 v[16:31], v[100:103], v[56:59], v[16:31]
    s_cbranch_scc1 KW_26
    s_waitcnt vmcnt(1)
KW_26:
    v_mfma_f32_32x32x16_bf16 v[16:31], v[104:107], v[60:63], v[16:31]
    s_cbranch_scc1 KW_27
    s_waitcnt vmcnt(0)
KW_27:
    v_mfma_f32_32x32x16_bf16 v[16:31], v[108:111], v[64:67], v[16:31]
    s_branch QA_S1
QA_SV:
    v_mfma_f32_32x32x8_bf16 v[16:31], v[68:69], v[72:73], 0
    s_cmp_eq_u32 s18, 0
    s_cbranch_scc1 KW_28
    s_waitcnt vmcnt(8)
KW_28:
    v_mfma_f32_32x32x16_bf16 v[16:31], v[32:35], v[76:79], v[16:31]
    s_cbranch_scc1 KW_29
    s_waitcnt vmcnt(7)
KW_29:
    v_mfma_f32_32x32x16_bf16 v[16:31], v[36:39], v[80:83], v[16:31]
    s_cbranch_scc1 KW_30
    s_waitcnt vmcnt(6)
KW_30:
    v_mfma_f32_32x32x16_bf16 v[16:31], v[40:43], v[84:87], v[16:31]
    s_cbranch_scc1 KW_31
    s_waitcnt vmcnt(5)
KW_31:
    v_mfma_f32_32x32x16_bf16 v[16:31], v[44:47], v[88:91], v[16:31]
    s_cbranch_scc1 KW_32
    s_waitcnt vmcnt(4)
KW_32:
    v_mfma_f32_32x32x16_bf16 v[16:31], v[48:51], v[92:95], v[16:31]
    s_cbranch_scc1 KW_33
    s_waitcnt vmcnt(3)
KW_33:
    v_mfma_f32_32x32x16_bf16 v[16:31], v[52:55], v[96:99], v[16:31]
    s_cbranch_scc1 KW_34
    s_waitcnt vmcnt(2)
KW_34:
    v_mfma_f32_32x32x16_bf16 v[16:31], v[56:59], v[100:103], v[16:31]
    s_cbranch_scc1 KW_35
    s_waitcnt vmcnt(1)
KW_35:
    v_mfma_f32_32x32x16_bf16 v[16:31], v[60:63], v[104:107], v[16:31]
    s_cbranch_scc1 KW_36
    s_waitcnt vmcnt(0)
KW_36:
    v_mfma_f32_32x32x16_bf16 v[16:31], v[64:67], v[108:111], v[16:31]
QA_S1:
    s_lshl_b32 s20, s13, 12
    s_add_u32 s20, s20, 108544
    v_add_u32 v5, s20, v1
    s_nop 8
    ds_write_b128 v5, v[16:19] offset:0
    ds_write_b128 v5, v[20:23] offset:1024
    ds_write_b128 v5, v[24:27] offset:2048
    ds_write_b128 v5, v[28:31] offset:3072
    s_lshl_b32 s20, s13, 10
    s_add_u32 s20, s20, 108544
    v_add_u32 v5, s20, v1
    s_lshl_b32 s20, s13, 2
    s_add_u32 s20, s20, 163328
    v_mov_b32 v8, s20
    v_mov_b32 v9, 1
    s_waitcnt lgkmcnt(0)
    ds_write_b32 v8, v9
    v_mov_b32 v8, 163328
PS_37:
    ds_read_b128 v[10:13], v8
    s_waitcnt lgkmcnt(0)
    v_and_b32 v10, v10, v11
    v_and_b32 v12, v12, v13
    v_and_b32 v10, v10, v12
    v_cmp_eq_u32 vcc, 0, v10
    s_cbranch_vccnz PS_37
    ds_read_b128 v[16:19], v5 offset:0
    ds_read_b128 v[20:23], v5 offset:4096
    ds_read_b128 v[24:27], v5 offset:8192
    ds_read_b128 v[28:31], v5 offset:12288
    s_mul_i32 s22, s14, 2368
    s_add_u32 s22, s22, s43
    s_cmp_eq_u32 s15, 3
    s_cbranch_scc1 QA_EV
    s_cmp_eq_u32 s15, 2
    s_cbranch_scc1 QA_EK
    v_mul_f32 v6, s51, v6
    s_lshl_b32 s20, s14, 4
    s_lshl_b32 s21, s15, 3
    s_add_u32 s20, s20, s21
    s_lshl_b32 s21, s13, 1
    s_add_u32 s20, s20, s21
    s_lshl_b32 s20, s20, 8
    s_add_u32 s20, s20, s44
    v_lshlrev_b32 v5, 3, v0
    s_waitcnt lgkmcnt(2)
    v_add_f32 v16, v16, v20
    v_add_f32 v17, v17, v21
    v_add_f32 v18, v18, v22
    v_add_f32 v19, v19, v23
    s_waitcnt lgkmcnt(0)
    v_add_f32 v24, v24, v28
    v_add_f32 v25, v25, v29
    v_add_f32 v26, v26, v30
    v_add_f32 v27, v27, v31
    v_add_f32 v16, v16, v24
    v_add_f32 v17, v17, v25
    v_add_f32 v18, v18, v26
    v_add_f32 v19, v19, v27
    v_mul_f32 v16, v16, v6
    v_mul_f32 v17, v17, v6
    v_mul_f32 v18, v18, v6
    v_mul_f32 v19, v19, v6
    v_cvt_pk_bf16_f32 v16, v16, v17
    v_cvt_pk_bf16_f32 v17, v18, v19
    s_cmp_eq_u32 s55, 0
    s_cbranch_scc1 LS_38
    buffer_store_dwordx2 v[16:17], v5, s[4:7], s20 offen
    s_branch LD_39
LS_38:
    buffer_store_dwordx2 v[16:17], v5, s[4:7], s20 offen sc1
LD_39:
    s_branch QA_S2
QA_EK:
    v_and_b32 v5, 0x13, v2
    v_bfe_u32 v8, v2, 2, 1
    v_lshl_or_b32 v5, v8, 3, v5
    v_bfe_u32 v8, v2, 3, 1
    v_lshl_or_b32 v5, v8, 2, v5
    v_lshl_add_u32 v9, v3, 5, v5
    v_lshlrev_b32 v9, 4, v9
    v_lshlrev_b32 v5, 2, v5
    s_lshl_b32 s21, s13, 3
    s_add_u32 s21, s22, s21
    s_waitcnt lgkmcnt(2)
    v_add_f32 v16, v16, v20
    v_add_f32 v17, v17, v21
    v_add_f32 v18, v18, v22
    v_add_f32 v19, v19, v23
    s_waitcnt lgkmcnt(0)
    v_add_f32 v24, v24, v28
    v_add_f32 v25, v25, v29
    v_add_f32 v26, v26, v30
    v_add_f32 v27, v27, v31
    v_add_f32 v16, v16, v24
    v_add_f32 v17, v17, v25
    v_add_f32 v18, v18, v26
    v_add_f32 v19, v19, v27
    v_mul_f32 v16, v16, v6
    v_mul_f32 v17, v17, v6
    v_mul_f32 v18, v18, v6
    v_mul_f32 v19, v19, v6
    v_cvt_pk_bf16_f32 v16, v16, v17
    v_cvt_pk_bf16_f32 v17, v18, v19
    s_cmp_eq_u32 s13, 3
    s_cbranch_scc1 QA_S2
    s_cmp_eq_u32 s13, 2
    s_cbranch_scc1 QA_EKX
    buffer_store_dwordx2 v[16:17], v9, s[4:7], s21 offen sc1
    s_branch QA_S2
QA_EKX:
    s_mov_b32 exec_hi, 0
    buffer_store_dword v16, v5, s[4:7], s22 offen offset:1024 sc1
    s_mov_b64 exec, -1
    s_branch QA_S2
QA_EV:
    s_lshl_b32 s21, s13, 5
    s_add_u32 s21, s21, 161792
    v_lshlrev_b32 v5, 4, v3
    v_add_u32 v5, s21, v5
    ds_read_b128 v[8:11], v5
    v_mul_u32_u24 v5, 304, v3
    v_lshl_add_u32 v5, v2, 4, v5
    s_lshr_b32 s20, s13, 1
    s_mul_i32 s20, s20, 608
    s_and_b32 s21, s13, 1
    s_lshl_b32 s21, s21, 3
    s_add_u32 s22, s22, s20
    s_add_u32 s22, s22, s21
    v_cmp_eq_u32 vcc, 18, v2
    v_mov_b32 v6, 0x3f803f80
    s_waitcnt lgkmcnt(3)
    v_add_f32 v16, v16, v20
    v_add_f32 v17, v17, v21
    v_add_f32 v18, v18, v22
    v_add_f32 v19, v19, v23
    s_waitcnt lgkmcnt(1)
    v_add_f32 v24, v24, v28
    v_add_f32 v25, v25, v29
    v_add_f32 v26, v26, v30
    v_add_f32 v27, v27, v31
    v_add_f32 v16, v16, v24
    v_add_f32 v17, v17, v25
    v_add_f32 v18, v18, v26
    v_add_f32 v19, v19, v27
    s_waitcnt lgkmcnt(0)
    v_mul_f32 v16, v16, v8
    v_mul_f32 v17, v17, v9
    v_mul_f32 v18, v18, v10
    v_mul_f32 v19, v19, v11
    v_cvt_pk_bf16_f32 v16, v16, v17
    v_cvt_pk_bf16_f32 v17, v18, v19
    v_cndmask_b32 v16, v16, v6, vcc
    v_cndmask_b32 v17, v17, v6, vcc
    s_mov_b32 exec_lo, 0x7ffff
    s_mov_b32 exec_hi, 0x7ffff
    buffer_store_dwordx2 v[16:17], v5, s[4:7], s22 offen offset:1152 sc1
    s_mov_b64 exec, -1
QA_S2:
    s_cmp_eq_u32 s18, 0
    s_cbranch_scc0 QA_S2B
    v_mov_b32 v8, 162816
GF_40:
    ds_read_b32 v9, v8
    s_waitcnt lgkmcnt(0)
    v_readfirstlane_b32 s55, v9
    s_nop 0
    s_cmp_eq_u32 s55, 0
    s_cbranch_scc1 GF_40
    s_and_b32 s55, s55, 1
    s_add_u32 s20, s26, 0
    s_bfe_u32 s21, s20, 0x10001
    s_lshr_b32 s20, s20, 3
    s_cmp_eq_u32 s20, 4
    s_cselect_b32 s20, s21, s20
    s_cmp_eq_u32 s20, s15
    s_cbranch_scc0 XS_41
    s_add_u32 s20, s24, 0
    buffer_store_dwordx4 v[32:35], v1, s[4:7], s20 offen sc1
XS_41:
    s_add_u32 s20, s26, 1
    s_bfe_u32 s21, s20, 0x10001
    s_lshr_b32 s20, s20, 3
    s_cmp_eq_u32 s20, 4
    s_cselect_b32 s20, s21, s20
    s_cmp_eq_u32 s20, s15
    s_cbranch_scc0 XS_42
    s_add_u32 s20, s24, 1024
    buffer_store_dwordx4 v[36:39], v1, s[4:7], s20 offen sc1
XS_42:
    s_add_u32 s20, s26, 2
    s_bfe_u32 s21, s20, 0x10001
    s_lshr_b32 s20, s20, 3
    s_cmp_eq_u32 s20, 4
    s_cselect_b32 s20, s21, s20
    s_cmp_eq_u32 s20, s15
    s_cbranch_scc0 XS_43
    s_add_u32 s20, s24, 2048
    buffer_store_dwordx4 v[40:43], v1, s[4:7], s20 offen sc1
XS_43:
    s_add_u32 s20, s26, 3
    s_bfe_u32 s21, s20, 0x10001
    s_lshr_b32 s20, s20, 3
    s_cmp_eq_u32 s20, 4
    s_cselect_b32 s20, s21, s20
    s_cmp_eq_u32 s20, s15
    s_cbranch_scc0 XS_44
    s_add_u32 s20, s24, 3072
    buffer_store_dwordx4 v[44:47], v1, s[4:7], s20 offen sc1
XS_44:
    s_add_u32 s20, s26, 4
    s_bfe_u32 s21, s20, 0x10001
    s_lshr_b32 s20, s20, 3
    s_cmp_eq_u32 s20, 4
    s_cselect_b32 s20, s21, s20
    s_cmp_eq_u32 s20, s15
    s_cbranch_scc0 XS_45
    s_add_u32 s20, s24, 4096
    buffer_store_dwordx4 v[48:51], v1, s[4:7], s20 offen sc1
XS_45:
    s_add_u32 s20, s26, 5
    s_bfe_u32 s21, s20, 0x10001
    s_lshr_b32 s20, s20, 3
    s_cmp_eq_u32 s20, 4
    s_cselect_b32 s20, s21, s20
    s_cmp_eq_u32 s20, s15
    s_cbranch_scc0 XS_46
    s_add_u32 s20, s24, 5120
    buffer_store_dwordx4 v[52:55], v1, s[4:7], s20 offen sc1
XS_46:
    s_add_u32 s20, s26, 6
    s_bfe_u32 s21, s20, 0x10001
    s_lshr_b32 s20, s20, 3
    s_cmp_eq_u32 s20, 4
    s_cselect_b32 s20, s21, s20
    s_cmp_eq_u32 s20, s15
    s_cbranch_scc0 XS_47
    s_add_u32 s20, s24, 6144
    buffer_store_dwordx4 v[56:59], v1, s[4:7], s20 offen sc1
XS_47:
    s_add_u32 s20, s26, 7
    s_bfe_u32 s21, s20, 0x10001
    s_lshr_b32 s20, s20, 3
    s_cmp_eq_u32 s20, 4
    s_cselect_b32 s20, s21, s20
    s_cmp_eq_u32 s20, s15
    s_cbranch_scc0 XS_48
    s_add_u32 s20, s24, 7168
    buffer_store_dwordx4 v[60:63], v1, s[4:7], s20 offen sc1
XS_48:
    s_add_u32 s20, s26, 8
    s_bfe_u32 s21, s20, 0x10001
    s_lshr_b32 s20, s20, 3
    s_cmp_eq_u32 s20, 4
    s_cselect_b32 s20, s21, s20
    s_cmp_eq_u32 s20, s15
    s_cbranch_scc0 XS_49
    s_add_u32 s20, s24, 8192
    buffer_store_dwordx4 v[64:67], v1, s[4:7], s20 offen sc1
XS_49:
    s_cmp_lt_u32 s15, 2
    s_cbranch_scc1 QA_S2B
    s_cmp_eq_u32 s14, 0
    s_cbranch_scc0 QA_S2B
    s_and_b32 s56, s15, 3
    s_add_u32 s56, s56, 16
    s_lshl_b32 s56, s56, 2
    s_add_u32 s56, s56, s13
    s_mul_i32 s56, s56, 9216
    s_add_u32 s56, s56, 0
    s_add_u32 s56, s56, s97
    buffer_store_dwordx4 v[76:79], v1, s[4:7], s56 offen offset:0 sc1
    buffer_store_dwordx4 v[80:83], v1, s[4:7], s56 offen offset:1024 sc1
    buffer_store_dwordx4 v[84:87], v1, s[4:7], s56 offen offset:2048 sc1
    buffer_store_dwordx4 v[88:91], v1, s[4:7], s56 offen offset:3072 sc1
    s_add_u32 s56, s56, 4096
    buffer_store_dwordx4 v[92:95], v1, s[4:7], s56 offen offset:0 sc1
    buffer_store_dwordx4 v[96:99], v1, s[4:7], s56 offen offset:1024 sc1
    buffer_store_dwordx4 v[100:103], v1, s[4:7], s56 offen offset:2048 sc1
    buffer_store_dwordx4 v[104:107], v1, s[4:7], s56 offen offset:3072 sc1
    s_add_u32 s56, s56, 4096
    buffer_store_dwordx4 v[108:111], v1, s[4:7], s56 offen offset:0 sc1
QA_S2B:
    v_mov_b32 v5, 0xdddddddd
    v_mov_b32 v7, 0
    v_mov_b32 v37, 0
    v_mov_b32 v39, 0
    s_movk_i32 s39, 304
    s_mul_i32 s24, s19, 75776
    v_add_u32 v16, s24, v1
    v_lshlrev_b32 v17, 2, v2
    v_add_u32 v17, s24, v17
    v_min_u32 v18, 18, v2
    v_lshlrev_b32 v18, 4, v18
    v_mad_u32_u24 v18, v3, s39, v18
    v_add_u32 v18, s24, v18
    v_mov_b32 v40, 0
    v_mov_b32 v41, 0
    v_mov_b32 v42, 0
    v_mov_b32 v43, 0
    v_mov_b32 v44, 0
    v_mov_b32 v45, 0
    v_mov_b32 v46, 0
    v_mov_b32 v47, 0
    v_mov_b32 v48, 0
    v_mov_b32 v49, 0
    v_mov_b32 v50, 0
    v_mov_b32 v51, 0
    v_mov_b32 v52, 0
    v_mov_b32 v53, 0
    v_mov_b32 v54, 0
    v_mov_b32 v55, 0
    v_mov_b32 v56, 0
    v_mov_b32 v57, 0
    v_mov_b32 v58, 0
    v_mov_b32 v59, 0
    v_mov_b32 v60, 0
    v_mov_b32 v61, 0
    v_mov_b32 v62, 0
    v_mov_b32 v63, 0
    v_mov_b32 v64, 0
    v_mov_b32 v65, 0
    v_mov_b32 v66, 0
    v_mov_b32 v67, 0
    v_mov_b32 v68, 0
    v_mov_b32 v69, 0
    v_mov_b32 v70, 0
    v_mov_b32 v71, 0
    v_mov_b32 v19, 162304
    ds_write_b32 v19, v7
    s_lshl_b32 s20, s14, 4
    s_lshl_b32 s21, s15, 2
    s_add_u32 s20, s20, s21
    s_add_u32 s20, s20, s13
    s_lshl_b32 s20, s20, 8
    s_add_u32 s23, s20, s44
    v_lshlrev_b32 v19, 3, v2
    v_lshl_add_u32 v19, v3, 2, v19
    s_mul_i32 s35, s19, 75776
    s_lshl_b32 s34, s13, 10
    s_add_u32 s35, s35, s34
    s_add_u32 s34, s35, s43
    s_lshl_b32 s20, s49, 3
    s_lshl_b32 s21, s12, 2
    s_add_u32 s20, s20, s21
    s_add_u32 s20, s20, 131072
    v_mov_b32 v20, s96
    v_mov_b32 v21, s20
    s_waitcnt vmcnt(0)
    s_mov_b64 exec, 1
    s_cmp_eq_u32 s55, 0
    s_cbranch_scc1 LS_50
    buffer_store_dword v20, v21, s[4:7], s42 offen
    s_branch LD_51
LS_50:
    buffer_store_dword v20, v21, s[4:7], s42 offen sc1
LD_51:
    s_mov_b64 exec, -1
    s_setprio 0
    s_cmp_eq_u32 s12, 4
    s_cbranch_scc0 QA_S4
    s_and_b32 s20, s49, 0x7c
    s_cmp_eq_u32 s20, 8
    s_cbranch_scc0 QA_S3
    s_and_b32 s22, s49, 0x380
    s_lshl_b32 s20, s22, 3
    s_add_u32 s20, s20, 131072
    s_lshl_b32 s21, s18, 4
    v_or_b32 v20, s21, v1
    v_lshlrev_b32 v21, 2, v20
    v_and_b32 v21, 64, v21
    v_or_b32 v20, v20, v21
    v_add_u32 v20, s20, v20
    s_mov_b32 s38, 0
POLL_52:
    buffer_load_dwordx4 v[24:27], v20, s[4:7], s42 offen sc1
    s_waitcnt vmcnt(0)
    v_xor_b32 v24, s96, v24
    v_xor_b32 v25, s96, v25
    v_xor_b32 v26, s96, v26
    v_xor_b32 v27, s96, v27
    v_or3_b32 v24, v24, v25, v26
    v_or_b32 v24, v24, v27
    v_cmp_ne_u32 vcc, 0, v24
    s_cbranch_vccz POLLD_53
    s_add_u32 s38, s38, 1
    s_cmp_lt_u32 s38, 200000
    s_cbranch_scc1 POLL_52
POLLD_53:
    s_add_u32 s20, s22, 139264
    v_lshlrev_b32 v20, 10, v0
    v_add_u32 v20, s20, v20
    v_mov_b32 v21, s96
    s_mov_b64 exec, 0xff
    buffer_store_dword v21, v20, s[4:7], s42 offen sc1
    s_mov_b64 exec, -1
QA_S3:
    s_and_b32 s20, s49, 0x380
    s_lshl_b32 s20, s20, 3
    s_add_u32 s20, s20, 139264
    v_and_b32 v20, 7, v0
    v_lshlrev_b32 v20, 7, v20
    v_add_u32 v20, s20, v20
    s_mov_b32 s38, 0
POLL_54:
    buffer_load_dword v21, v20, s[4:7], s42 offen sc1
    s_waitcnt vmcnt(0)
    v_cmp_ne_u32 vcc, s96, v21
    s_cbranch_vccz POLLD_55
    s_add_u32 s38, s38, 1
    s_cmp_lt_u32 s38, 200000
    s_cbranch_scc1 POLL_54
POLLD_55:
QA_S4:
    s_cmp_eq_u32 s12, 5
    s_cbranch_scc0 QA_S5
    s_lshl_b32 s20, s14, 7
    s_lshr_b32 s21, s15, 1
    s_lshl_b32 s21, s21, 5
    s_add_u32 s20, s20, s21
    s_add_u32 s20, s20, 131088
    v_mov_b32 v20, s20
    s_mov_b32 s38, 0
POLL_56:
    buffer_load_dwordx4 v[24:27], v20, s[4:7], s42 offen sc1
    s_waitcnt vmcnt(0)
    v_xor_b32 v24, s96, v24
    v_xor_b32 v25, s96, v25
    v_xor_b32 v26, s96, v26
    v_xor_b32 v27, s96, v27
    v_or3_b32 v24, v24, v25, v26
    v_or_b32 v24, v24, v27
    v_cmp_ne_u32 vcc, 0, v24
    s_cbranch_vccz POLLD_57
    s_add_u32 s38, s38, 1
    s_cmp_lt_u32 s38, 200000
    s_cbranch_scc1 POLL_56
POLLD_57:
QA_S5:
    s_lshl_b32 s20, s13, 11
    s_add_u32 s20, s20, 151552
    v_add_u32 v20, s20, v1
    s_waitcnt lgkmcnt(0)
    s_barrier
    ds_read_b128 v[8:11], v20
    ds_read_b128 v[12:15], v20 offset:1024
    s_branch QA_DONE
QA_FULL:
    s_lshl_b32 s20, s13, 2
    s_add_u32 s20, s20, 163344
    v_mov_b32 v10, s20
    v_mov_b32 v11, 0
    ds_write_b32 v10, v11
    v_mov_b32 v5, 0xdddddddd
    v_mov_b32 v7, 0
    v_mov_b32 v37, 0
    v_mov_b32 v39, 0
    s_movk_i32 s39, 304
    s_mul_i32 s24, s19, 75776
    v_add_u32 v16, s24, v1
    v_lshlrev_b32 v17, 2, v2
    v_add_u32 v17, s24, v17
    v_min_u32 v18, 18, v2
    v_lshlrev_b32 v18, 4, v18
    v_mad_u32_u24 v18, v3, s39, v18
    v_add_u32 v18, s24, v18
    v_mov_b32 v40, 0
    v_mov_b32 v41, 0
    v_mov_b32 v42, 0
    v_mov_b32 v43, 0
    v_mov_b32 v44, 0
    v_mov_b32 v45, 0
    v_mov_b32 v46, 0
    v_mov_b32 v47, 0
    v_mov_b32 v48, 0
    v_mov_b32 v49, 0
    v_mov_b32 v50, 0
    v_mov_b32 v51, 0
    v_mov_b32 v52, 0
    v_mov_b32 v53, 0
    v_mov_b32 v54, 0
    v_mov_b32 v55, 0
    v_mov_b32 v56, 0
    v_mov_b32 v57, 0
    v_mov_b32 v58, 0
    v_mov_b32 v59, 0
    v_mov_b32 v60, 0
    v_mov_b32 v61, 0
    v_mov_b32 v62, 0
    v_mov_b32 v63, 0
    v_mov_b32 v64, 0
    v_mov_b32 v65, 0
    v_mov_b32 v66, 0
    v_mov_b32 v67, 0
    v_mov_b32 v68, 0
    v_mov_b32 v69, 0
    v_mov_b32 v70, 0
    v_mov_b32 v71, 0
    v_mov_b32 v19, 162304
    ds_write_b32 v19, v7
    s_lshl_b32 s20, s14, 4
    s_lshl_b32 s21, s15, 2
    s_add_u32 s20, s20, s21
    s_add_u32 s20, s20, s13
    s_lshl_b32 s20, s20, 8
    s_add_u32 s23, s20, s44
    v_lshlrev_b32 v19, 3, v2
    v_lshl_add_u32 v19, v3, 2, v19
    s_mul_i32 s35, s19, 75776
    s_lshl_b32 s34, s13, 10
    s_add_u32 s35, s35, s34
    s_add_u32 s34, s35, s43
    s_mul_i32 s25, s13, 9216
    s_add_u32 s24, s40, s48
    s_add_u32 s24, s24, s25
    s_add_u32 s25, s25, 0
    v_mov_b32 v72, 0
    v_dot2c_f32_bf16 v72, s98, v252
    v_dot2c_f32_bf16 v72, s98, v253
    v_dot2c_f32_bf16 v72, s98, v254
    v_dot2c_f32_bf16 v72, s98, v255
    v_dot2c_f32_bf16 v72, s98, v248
    v_dot2c_f32_bf16 v72, s98, v249
    v_dot2c_f32_bf16 v72, s98, v250
    v_dot2c_f32_bf16 v72, s98, v251
    v_dot2c_f32_bf16 v72, s98, v244
    v_dot2c_f32_bf16 v72, s98, v245
    v_dot2c_f32_bf16 v72, s98, v246
    v_dot2c_f32_bf16 v72, s98, v247
    v_dot2c_f32_bf16 v72, s98, v240
    v_dot2c_f32_bf16 v72, s98, v241
    v_dot2c_f32_bf16 v72, s98, v242
    v_dot2c_f32_bf16 v72, s98, v243
    v_dot2c_f32_bf16 v72, s98, v236
    v_dot2c_f32_bf16 v72, s98, v237
    v_dot2c_f32_bf16 v72, s98, v238
    v_dot2c_f32_bf16 v72, s98, v239
    v_dot2c_f32_bf16 v72, s98, v232
    v_dot2c_f32_bf16 v72, s98, v233
    v_dot2c_f32_bf16 v72, s98, v234
    v_dot2c_f32_bf16 v72, s98, v235
    v_dot2c_f32_bf16 v72, s98, v228
    v_dot2c_f32_bf16 v72, s98, v229
    v_dot2c_f32_bf16 v72, s98, v230
    v_dot2c_f32_bf16 v72, s98, v231
    v_dot2c_f32_bf16 v72, s98, v224
    v_dot2c_f32_bf16 v72, s98, v225
    v_dot2c_f32_bf16 v72, s98, v226
    v_dot2c_f32_bf16 v72, s98, v227
    v_dot2c_f32_bf16 v72, s98, v220
    v_dot2c_f32_bf16 v72, s98, v221
    v_dot2c_f32_bf16 v72, s98, v222
    v_dot2c_f32_bf16 v72, s98, v223
    v_dot2c_f32_bf16 v72, s98, v216
    v_dot2c_f32_bf16 v72, s98, v217
    v_dot2c_f32_bf16 v72, s98, v218
    v_dot2c_f32_bf16 v72, s98, v219
    v_dot2c_f32_bf16 v72, s98, v212
    v_dot2c_f32_bf16 v72, s98, v213
    v_dot2c_f32_bf16 v72, s98, v214
    v_dot2c_f32_bf16 v72, s98, v215
    v_dot2c_f32_bf16 v72, s98, v208
    v_dot2c_f32_bf16 v72, s98, v209
    v_dot2c_f32_bf16 v72, s98, v210
    v_dot2c_f32_bf16 v72, s98, v211
    v_dot2c_f32_bf16 v72, s98, v204
    v_dot2c_f32_bf16 v72, s98, v205
    v_dot2c_f32_bf16 v72, s98, v206
    v_dot2c_f32_bf16 v72, s98, v207
    v_dot2c_f32_bf16 v72, s98, v200
    v_dot2c_f32_bf16 v72, s98, v201
    v_dot2c_f32_bf16 v72, s98, v202
    v_dot2c_f32_bf16 v72, s98, v203
    v_dot2c_f32_bf16 v72, s98, v196
    v_dot2c_f32_bf16 v72, s98, v197
    v_dot2c_f32_bf16 v72, s98, v198
    v_dot2c_f32_bf16 v72, s98, v199
    v_dot2c_f32_bf16 v72, s98, v192
    v_dot2c_f32_bf16 v72, s98, v193
    v_dot2c_f32_bf16 v72, s98, v194
    v_dot2c_f32_bf16 v72, s98, v195
    v_dot2c_f32_bf16 v72, s98, v188
    v_dot2c_f32_bf16 v72, s98, v189
    v_dot2c_f32_bf16 v72, s98, v190
    v_dot2c_f32_bf16 v72, s98, v191
    v_dot2c_f32_bf16 v72, s98, v184
    v_dot2c_f32_bf16 v72, s98, v185
    v_dot2c_f32_bf16 v72, s98, v186
    v_dot2c_f32_bf16 v72, s98, v187
    v_dot2c_f32_bf16 v72, s98, v180
    v_dot2c_f32_bf16 v72, s98, v181
    v_dot2c_f32_bf16 v72, s98, v182
    v_dot2c_f32_bf16 v72, s98, v183
    v_dot2c_f32_bf16 v72, s98, v140
    v_dot2c_f32_bf16 v72, s98, v141
    v_dot2c_f32_bf16 v72, s98, v142
    v_dot2c_f32_bf16 v72, s98, v143
    v_dot2c_f32_bf16 v72, s98, v136
    v_dot2c_f32_bf16 v72, s98, v137
    v_dot2c_f32_bf16 v72, s98, v138
    v_dot2c_f32_bf16 v72, s98, v139
    v_dot2c_f32_bf16 v72, s98, v132
    v_dot2c_f32_bf16 v72, s98, v133
    v_dot2c_f32_bf16 v72, s98, v134
    v_dot2c_f32_bf16 v72, s98, v135
    v_dot2c_f32_bf16 v72, s98, v128
    v_dot2c_f32_bf16 v72, s98, v129
    v_dot2c_f32_bf16 v72, s98, v130
    v_dot2c_f32_bf16 v72, s98, v131
    v_dot2c_f32_bf16 v72, s98, v124
    v_dot2c_f32_bf16 v72, s98, v125
    v_dot2c_f32_bf16 v72, s98, v126
    v_dot2c_f32_bf16 v72, s98, v127
    v_dot2c_f32_bf16 v72, s98, v120
    v_dot2c_f32_bf16 v72, s98, v121
    v_dot2c_f32_bf16 v72, s98, v122
    v_dot2c_f32_bf16 v72, s98, v123
    v_dot2c_f32_bf16 v72, s98, v116
    v_dot2c_f32_bf16 v72, s98, v117
    v_dot2c_f32_bf16 v72, s98, v118
    v_dot2c_f32_bf16 v72, s98, v119
    v_dot2c_f32_bf16 v72, s98, v112
    v_dot2c_f32_bf16 v72, s98, v113
    v_dot2c_f32_bf16 v72, s98, v114
    v_dot2c_f32_bf16 v72, s98, v115
    s_waitcnt lgkmcnt(0)
    s_barrier
    s_mov_b32 m0, s25
    s_nop 0
    buffer_load_dwordx4 v1, s[4:7], s24 offen offset:0 sc1 lds
    buffer_load_dwordx4 v1, s[4:7], s24 offen offset:1024 sc1 lds
    buffer_load_dwordx4 v1, s[4:7], s24 offen offset:2048 sc1 lds
    buffer_load_dwordx4 v1, s[4:7], s24 offen offset:3072 sc1 lds
    s_add_u32 s24, s24, 4096
    s_add_u32 s25, s25, 4096
    s_mov_b32 m0, s25
    s_nop 0
    buffer_load_dwordx4 v1, s[4:7], s24 offen offset:0 sc1 lds
    buffer_load_dwordx4 v1, s[4:7], s24 offen offset:1024 sc1 lds
    buffer_load_dwordx4 v1, s[4:7], s24 offen offset:2048 sc1 lds
    buffer_load_dwordx4 v1, s[4:7], s24 offen offset:3072 sc1 lds
    s_add_u32 s24, s24, 4096
    s_add_u32 s25, s25, 4096
    s_mov_b32 m0, s25
    s_nop 0
    buffer_load_dwordx4 v1, s[4:7], s24 offen offset:0 sc1 lds
    s_lshl_b32 s20, s15, 2
    s_add_u32 s20, s20, s13
    s_mul_i32 s20, s20, 36864
    s_add_u32 s20, s20, 19456
    s_add_u32 s20, s20, s97
    s_mov_b32 s21, s20
    buffer_load_dwordx4 v[176:179], v1, s[4:7], s21 offen offset:0
    buffer_load_dwordx4 v[172:175], v1, s[4:7], s21 offen offset:1024
    buffer_load_dwordx4 v[168:171], v1, s[4:7], s21 offen offset:2048
    buffer_load_dwordx4 v[164:167], v1, s[4:7], s21 offen offset:3072
    s_add_u32 s21, s21, 4096
    buffer_load_dwordx4 v[160:163], v1, s[4:7], s21 offen offset:0
    buffer_load_dwordx4 v[156:159], v1, s[4:7], s21 offen offset:1024
    buffer_load_dwordx4 v[152:155], v1, s[4:7], s21 offen offset:2048
    buffer_load_dwordx4 v[148:151], v1, s[4:7], s21 offen offset:3072
    s_add_u32 s21, s21, 4096
    buffer_load_dwordx4 v[144:147], v1, s[4:7], s21 offen offset:0
    s_waitcnt vmcnt(9)
    s_lshl_b32 s20, s13, 2
    s_add_u32 s20, s20, 163344
    v_mov_b32 v10, s20
    v_mov_b32 v11, 1
    s_waitcnt lgkmcnt(0)
    ds_write_b32 v10, v11
    v_mov_b32 v10, 163344
PS_58:
    ds_read_b128 v[12:15], v10
    s_waitcnt lgkmcnt(0)
    v_and_b32 v12, v12, v13
    v_and_b32 v14, v14, v15
    v_and_b32 v12, v12, v14
    v_cmp_eq_u32 vcc, 0, v12
    s_cbranch_vccnz PS_58
    ds_read_b128 v[76:79], v1 offset:0
    ds_read_b128 v[80:83], v1 offset:1024
    ds_read_b128 v[84:87], v1 offset:2048
    ds_read_b128 v[108:111], v1 offset:3072
    ds_read_b128 v[20:23], v1 offset:4096
    ds_read_b128 v[24:27], v1 offset:5120
    s_waitcnt lgkmcnt(5)
    v_mfma_f32_32x32x16_bf16 v[88:103], v[252:255], v[76:79], 0
    ds_read_b128 v[76:79], v1 offset:6144
    s_waitcnt lgkmcnt(5)
    v_mfma_f32_32x32x16_bf16 v[88:103], v[248:251], v[80:83], v[88:103]
    ds_read_b128 v[80:83], v1 offset:7168
    s_waitcnt lgkmcnt(5)
    v_mfma_f32_32x32x16_bf16 v[88:103], v[244:247], v[84:87], v[88:103]
    ds_read_b128 v[84:87], v1 offset:8192
    s_waitcnt lgkmcnt(5)
    v_mfma_f32_32x32x16_bf16 v[88:103], v[240:243], v[108:111], v[88:103]
    ds_read_b128 v[108:111], v1 offset:9216
    s_waitcnt lgkmcnt(5)
    v_mfma_f32_32x32x16_bf16 v[88:103], v[236:239], v[20:23], v[88:103]
    ds_read_b128 v[20:23], v1 offset:10240
    s_waitcnt lgkmcnt(5)
    v_mfma_f32_32x32x16_bf16 v[88:103], v[232:235], v[24:27], v[88:103]
    ds_read_b128 v[24:27], v1 offset:11264
    s_waitcnt lgkmcnt(5)
    v_mfma_f32_32x32x16_bf16 v[88:103], v[228:231], v[76:79], v[88:103]
    ds_read_b128 v[76:79], v1 offset:12288
    s_waitcnt lgkmcnt(5)
    v_mfma_f32_32x32x16_bf16 v[88:103], v[224:227], v[80:83], v[88:103]
    ds_read_b128 v[80:83], v1 offset:13312
    s_waitcnt lgkmcnt(5)
    v_mfma_f32_32x32x16_bf16 v[88:103], v[220:223], v[84:87], v[88:103]
    ds_read_b128 v[84:87], v1 offset:14336
    s_waitcnt lgkmcnt(5)
    v_mfma_f32_32x32x16_bf16 v[88:103], v[216:219], v[108:111], v[88:103]
    ds_read_b128 v[108:111], v1 offset:15360
    s_waitcnt lgkmcnt(5)
    v_mfma_f32_32x32x16_bf16 v[88:103], v[212:215], v[20:23], v[88:103]
    ds_read_b128 v[20:23], v1 offset:16384
    s_waitcnt lgkmcnt(5)
    v_mfma_f32_32x32x16_bf16 v[88:103], v[208:211], v[24:27], v[88:103]
    ds_read_b128 v[24:27], v1 offset:17408
    s_waitcnt lgkmcnt(5)
    v_mfma_f32_32x32x16_bf16 v[88:103], v[204:207], v[76:79], v[88:103]
    ds_read_b128 v[76:79], v1 offset:18432
    s_waitcnt lgkmcnt(5)
    v_mfma_f32_32x32x16_bf16 v[88:103], v[200:203], v[80:83], v[88:103]
    ds_read_b128 v[80:83], v1 offset:28672
    s_waitcnt lgkmcnt(5)
    v_mfma_f32_32x32x16_bf16 v[88:103], v[196:199], v[84:87], v[88:103]
    ds_read_b128 v[84:87], v1 offset:29696
    s_waitcnt lgkmcnt(5)
    v_mfma_f32_32x32x16_bf16 v[88:103], v[192:195], v[108:111], v[88:103]
    ds_read_b128 v[108:111], v1 offset:30720
    s_waitcnt lgkmcnt(5)
    v_mfma_f32_32x32x16_bf16 v[88:103], v[188:191], v[20:23], v[88:103]
    ds_read_b128 v[20:23], v1 offset:31744
    s_waitcnt lgkmcnt(5)
    v_mfma_f32_32x32x16_bf16 v[88:103], v[184:187], v[24:27], v[88:103]
    ds_read_b128 v[24:27], v1 offset:32768
    s_waitcnt lgkmcnt(5)
    v_mfma_f32_32x32x16_bf16 v[88:103], v[180:183], v[76:79], v[88:103]
    ds_read_b128 v[76:79], v1 offset:33792
    s_waitcnt lgkmcnt(5)
    v_mfma_f32_32x32x16_bf16 v[88:103], v[140:143], v[80:83], v[88:103]
    ds_read_b128 v[80:83], v1 offset:34816
    s_waitcnt lgkmcnt(5)
    v_mfma_f32_32x32x16_bf16 v[88:103], v[136:139], v[84:87], v[88:103]
    ds_read_b128 v[84:87], v1 offset:35840
    s_waitcnt lgkmcnt(5)
    v_mfma_f32_32x32x16_bf16 v[88:103], v[132:135], v[108:111], v[88:103]
    ds_read_b128 v[108:111], v1 offset:19456
    s_waitcnt lgkmcnt(5)
    v_mfma_f32_32x32x16_bf16 v[88:103], v[128:131], v[20:23], v[88:103]
    ds_read_b128 v[20:23], v1 offset:20480
    s_waitcnt lgkmcnt(5)
    v_mfma_f32_32x32x16_bf16 v[88:103], v[124:127], v[24:27], v[88:103]
    ds_read_b128 v[24:27], v1 offset:21504
    s_waitcnt lgkmcnt(5)
    v_mfma_f32_32x32x16_bf16 v[88:103], v[120:123], v[76:79], v[88:103]
    ds_read_b128 v[76:79], v1 offset:22528
    s_waitcnt lgkmcnt(5)
    v_mfma_f32_32x32x16_bf16 v[88:103], v[116:119], v[80:83], v[88:103]
    ds_read_b128 v[80:83], v1 offset:23552
    s_waitcnt lgkmcnt(5)
    v_mfma_f32_32x32x16_bf16 v[88:103], v[112:115], v[84:87], v[88:103]
    ds_read_b128 v[84:87], v1 offset:24576
    s_waitcnt vmcnt(0) lgkmcnt(5)
    v_mfma_f32_32x32x16_bf16 v[88:103], v[176:179], v[108:111], v[88:103]
    ds_read_b128 v[108:111], v1 offset:25600
    s_waitcnt lgkmcnt(5)
    v_mfma_f32_32x32x16_bf16 v[88:103], v[172:175], v[20:23], v[88:103]
    ds_read_b128 v[20:23], v1 offset:26624
    s_waitcnt lgkmcnt(5)
    v_mfma_f32_32x32x16_bf16 v[88:103], v[168:171], v[24:27], v[88:103]
    ds_read_b128 v[24:27], v1 offset:27648
    s_waitcnt lgkmcnt(5)
    v_mfma_f32_32x32x16_bf16 v[88:103], v[164:167], v[76:79], v[88:103]
    s_waitcnt lgkmcnt(4)
    v_mfma_f32_32x32x16_bf16 v[88:103], v[160:163], v[80:83], v[88:103]
    s_waitcnt lgkmcnt(3)
    v_mfma_f32_32x32x16_bf16 v[88:103], v[156:159], v[84:87], v[88:103]
    s_waitcnt lgkmcnt(2)
    v_mfma_f32_32x32x16_bf16 v[88:103], v[152:155], v[108:111], v[88:103]
    s_waitcnt lgkmcnt(1)
    v_mfma_f32_32x32x16_bf16 v[88:103], v[148:151], v[20:23], v[88:103]
    s_waitcnt lgkmcnt(0)
    v_mfma_f32_32x32x16_bf16 v[88:103], v[144:147], v[24:27], v[88:103]
    v_dot2c_f32_bf16 v72, s98, v176
    v_dot2c_f32_bf16 v72, s98, v177
    v_dot2c_f32_bf16 v72, s98, v178
    v_dot2c_f32_bf16 v72, s98, v179
    v_dot2c_f32_bf16 v72, s98, v172
    v_dot2c_f32_bf16 v72, s98, v173
    v_dot2c_f32_bf16 v72, s98, v174
    v_dot2c_f32_bf16 v72, s98, v175
    v_dot2c_f32_bf16 v72, s98, v168
    v_dot2c_f32_bf16 v72, s98, v169
    v_dot2c_f32_bf16 v72, s98, v170
    v_dot2c_f32_bf16 v72, s98, v171
    v_dot2c_f32_bf16 v72, s98, v164
    v_dot2c_f32_bf16 v72, s98, v165
    v_dot2c_f32_bf16 v72, s98, v166
    v_dot2c_f32_bf16 v72, s98, v167
    v_dot2c_f32_bf16 v72, s98, v160
    v_dot2c_f32_bf16 v72, s98, v161
    v_dot2c_f32_bf16 v72, s98, v162
    v_dot2c_f32_bf16 v72, s98, v163
    v_dot2c_f32_bf16 v72, s98, v156
    v_dot2c_f32_bf16 v72, s98, v157
    v_dot2c_f32_bf16 v72, s98, v158
    v_dot2c_f32_bf16 v72, s98, v159
    v_dot2c_f32_bf16 v72, s98, v152
    v_dot2c_f32_bf16 v72, s98, v153
    v_dot2c_f32_bf16 v72, s98, v154
    v_dot2c_f32_bf16 v72, s98, v155
    v_dot2c_f32_bf16 v72, s98, v148
    v_dot2c_f32_bf16 v72, s98, v149
    v_dot2c_f32_bf16 v72, s98, v150
    v_dot2c_f32_bf16 v72, s98, v151
    v_dot2c_f32_bf16 v72, s98, v144
    v_dot2c_f32_bf16 v72, s98, v145
    v_dot2c_f32_bf16 v72, s98, v146
    v_dot2c_f32_bf16 v72, s98, v147
QA_FJ:
    v_lshlrev_b32 v8, 2, v2
    v_add_u32 v9, 161792, v8
    v_mov_b32 v75, 0
    v_cvt_pk_bf16_f32 v73, v72, v72
    v_lshlrev_b32 v73, 16, v73
    v_sub_f32 v73, v72, v73
    v_cvt_pk_bf16_f32 v72, v72, v73
    v_mov_b32 v73, 0
    v_mov_b32 v10, 163408
PS_59:
    ds_read_b128 v[12:15], v10
    s_waitcnt lgkmcnt(0)
    v_and_b32 v12, v12, v13
    v_and_b32 v14, v14, v15
    v_and_b32 v12, v12, v14
    v_cmp_eq_u32 vcc, 0, v12
    s_cbranch_vccnz PS_59
    ds_read_b32 v104, v9
    ds_read_b32 v74, v9 offset:128
    s_lshl_b32 s20, s13, 11
    s_add_u32 s20, s20, 151552
    v_add_u32 v106, s20, v1
    s_waitcnt lgkmcnt(0)
    v_mul_f32 v104, s51, v104
    v_mfma_f32_32x32x8_bf16 v[88:103], v[72:73], v[74:75], v[88:103]
    s_nop 11
    v_pk_mul_f32 v[88:89], v[88:89], v[104:105] op_sel_hi:[1,0]
    v_pk_mul_f32 v[90:91], v[90:91], v[104:105] op_sel_hi:[1,0]
    v_pk_mul_f32 v[92:93], v[92:93], v[104:105] op_sel_hi:[1,0]
    v_pk_mul_f32 v[94:95], v[94:95], v[104:105] op_sel_hi:[1,0]
    v_pk_mul_f32 v[96:97], v[96:97], v[104:105] op_sel_hi:[1,0]
    v_pk_mul_f32 v[98:99], v[98:99], v[104:105] op_sel_hi:[1,0]
    v_pk_mul_f32 v[100:101], v[100:101], v[104:105] op_sel_hi:[1,0]
    v_pk_mul_f32 v[102:103], v[102:103], v[104:105] op_sel_hi:[1,0]
    v_cvt_pk_bf16_f32 v8, v88, v89
    v_cvt_pk_bf16_f32 v9, v90, v91
    v_cvt_pk_bf16_f32 v10, v92, v93
    v_cvt_pk_bf16_f32 v11, v94, v95
    v_cvt_pk_bf16_f32 v12, v96, v97
    v_cvt_pk_bf16_f32 v13, v98, v99
    v_cvt_pk_bf16_f32 v14, v100, v101
    v_cvt_pk_bf16_f32 v15, v102, v103
    ds_write_b128 v106, v[8:11]
    ds_write_b128 v106, v[12:15] offset:1024
    s_waitcnt lgkmcnt(0)
    s_barrier
QA_DONE:
    buffer_load_dword v6, v19, s[4:7], s23 offen sc1
    s_mov_b32 m0, s35
    s_nop 0
    buffer_load_dwordx4 v1, s[4:7], s34 offen sc1 lds
    s_add_u32 s35, s35, 4096
    s_mov_b32 m0, s35
    s_add_u32 s34, s34, 4096
    buffer_load_dwordx4 v1, s[4:7], s34 offen sc1 lds
    s_add_u32 s35, s35, 4096
    s_mov_b32 m0, s35
    s_add_u32 s34, s34, 4096
    buffer_load_dwordx4 v1, s[4:7], s34 offen sc1 lds
    s_add_u32 s35, s35, 4096
    s_mov_b32 m0, s35
    s_add_u32 s34, s34, 4096
    buffer_load_dwordx4 v1, s[4:7], s34 offen sc1 lds
    s_lshl_b32 s37, s15, 2
    s_add_u32 s37, s37, s13
    s_mul_i32 s37, s37, 36864
    s_add_u32 s37, s37, 0
    s_add_u32 s37, s37, s54
    s_waitcnt vmcnt(2)
    s_barrier
    ds_read_b128 v[108:111], v16
    ds_read_b32 v36, v17 offset:1024
    ds_read_b128 v[104:107], v16 offset:2368
    ds_read_b32 v38, v17 offset:3392
    ds_read_b128 v[20:23], v18 offset:1152
    ds_read_b128 v[24:27], v18 offset:1760
    s_waitcnt lgkmcnt(4)
    v_mfma_f32_32x32x4_2b_bf16 v[112:143], v[36:37], v[6:7], 0
    s_add_u32 s35, s35, 4096
    s_mov_b32 m0, s35
    s_add_u32 s34, s34, 4096
    buffer_load_dwordx4 v1, s[4:7], s34 offen sc1 lds
    s_nop 13
    v_mfma_f32_32x32x16_bf16 v[112:127], v[108:111], v[8:11], v[112:127]
    v_mfma_f32_32x32x16_bf16 v[128:143], v[108:111], v[12:15], v[128:143]
    s_waitcnt lgkmcnt(0)
    s_setprio 3
    s_nop 8
    v_exp_f32 v112, v112
    v_exp_f32 v113, v113
    ds_read_b128 v[32:35], v18 offset:4128
    v_exp_f32 v114, v114
    v_exp_f32 v115, v115
    v_exp_f32 v116, v116
    v_mfma_f32_32x32x4_2b_bf16 v[72:103], v[38:39], v[6:7], 0
    ds_read_b128 v[28:31], v18 offset:3520
    s_add_u32 s35, s35, 4096
    s_mov_b32 m0, s35
    s_add_u32 s34, s34, 4096
    buffer_load_dwordx4 v1, s[4:7], s34 offen sc1 lds
    v_exp_f32 v117, v117
    v_exp_f32 v118, v118
    v_exp_f32 v119, v119
    v_exp_f32 v120, v120
    v_exp_f32 v121, v121
    v_exp_f32 v122, v122
    v_exp_f32 v123, v123
    v_exp_f32 v124, v124
    v_smfmac_f32_32x32x32_bf16 v[40:55], v[20:23], v[112:119], v5
    ds_read_b128 v[108:111], v16 offset:4736
    v_exp_f32 v125, v125
    v_exp_f32 v126, v126
    v_exp_f32 v127, v127
    v_exp_f32 v128, v128
    v_exp_f32 v129, v129
    v_smfmac_f32_32x32x32_bf16 v[40:55], v[24:27], v[120:127], v5
    ds_read_b32 v36, v17 offset:5760
    s_add_u32 s35, s35, 4096
    s_mov_b32 m0, s35
    s_add_u32 s34, s34, 4096
    buffer_load_dwordx4 v1, s[4:7], s34 offen sc1 lds
    v_exp_f32 v130, v130
    v_exp_f32 v131, v131
    v_exp_f32 v132, v132
    v_exp_f32 v133, v133
    v_mfma_f32_32x32x16_bf16 v[72:87], v[104:107], v[8:11], v[72:87]
    v_exp_f32 v134, v134
    v_exp_f32 v135, v135
    v_exp_f32 v136, v136
    v_exp_f32 v137, v137
    v_smfmac_f32_32x32x32_bf16 v[56:71], v[20:23], v[128:135], v5
    s_add_u32 s35, s35, 4096
    s_mov_b32 m0, s35
    s_add_u32 s34, s34, 4096
    buffer_load_dwordx4 v1, s[4:7], s34 offen sc1 lds
    v_exp_f32 v138, v138
    v_exp_f32 v139, v139
    v_exp_f32 v140, v140
    v_mfma_f32_32x32x16_bf16 v[88:103], v[104:107], v[12:15], v[88:103]
    v_exp_f32 v141, v141
    v_exp_f32 v142, v142
    v_exp_f32 v143, v143
    s_waitcnt lgkmcnt(0)
    s_waitcnt vmcnt(4)
    s_barrier
    v_exp_f32 v72, v72
    v_exp_f32 v73, v73
    v_smfmac_f32_32x32x32_bf16 v[56:71], v[24:27], v[136:143], v5
    ds_read_b128 v[24:27], v18 offset:6496
    v_exp_f32 v74, v74
    v_exp_f32 v75, v75
    v_exp_f32 v76, v76
    v_mfma_f32_32x32x4_2b_bf16 v[112:143], v[36:37], v[6:7], 0
    ds_read_b128 v[20:23], v18 offset:5888
    s_add_u32 s35, s35, 4096
    s_mov_b32 m0, s35
    s_add_u32 s34, s34, 4096
    buffer_load_dwordx4 v1, s[4:7], s34 offen sc1 lds
    v_exp_f32 v77, v77
    v_exp_f32 v78, v78
    v_exp_f32 v79, v79
    v_exp_f32 v80, v80
    v_exp_f32 v81, v81
    v_exp_f32 v82, v82
    v_exp_f32 v83, v83
    v_exp_f32 v84, v84
    v_smfmac_f32_32x32x32_bf16 v[40:55], v[28:31], v[72:79], v5
    ds_read_b128 v[104:107], v16 offset:7104
    v_exp_f32 v85, v85
    v_exp_f32 v86, v86
    v_exp_f32 v87, v87
    v_exp_f32 v88, v88
    v_exp_f32 v89, v89
    v_smfmac_f32_32x32x32_bf16 v[40:55], v[32:35], v[80:87], v5
    ds_read_b32 v38, v17 offset:8128
    s_add_u32 s35, s35, 4096
    s_mov_b32 m0, s35
    s_add_u32 s34, s34, 4096
    buffer_load_dwordx4 v1, s[4:7], s34 offen sc1 lds
    v_exp_f32 v90, v90
    v_exp_f32 v91, v91
    v_exp_f32 v92, v92
    v_exp_f32 v93, v93
    v_mfma_f32_32x32x16_bf16 v[112:127], v[108:111], v[8:11], v[112:127]
    v_exp_f32 v94, v94
    v_exp_f32 v95, v95
    v_exp_f32 v96, v96
    v_exp_f32 v97, v97
    v_smfmac_f32_32x32x32_bf16 v[56:71], v[28:31], v[88:95], v5
    s_add_u32 s35, s35, 4096
    s_mov_b32 m0, s35
    s_add_u32 s34, s34, 4096
    buffer_load_dwordx4 v1, s[4:7], s34 offen sc1 lds
    v_exp_f32 v98, v98
    v_exp_f32 v99, v99
    v_exp_f32 v100, v100
    v_mfma_f32_32x32x16_bf16 v[128:143], v[108:111], v[12:15], v[128:143]
    v_exp_f32 v101, v101
    v_exp_f32 v102, v102
    v_exp_f32 v103, v103
    s_waitcnt lgkmcnt(0)
    s_setprio 2
    v_exp_f32 v112, v112
    v_exp_f32 v113, v113
    v_smfmac_f32_32x32x32_bf16 v[56:71], v[32:35], v[96:103], v5
    ds_read_b128 v[32:35], v18 offset:8864
    v_exp_f32 v114, v114
    v_exp_f32 v115, v115
    v_exp_f32 v116, v116
    v_mfma_f32_32x32x4_2b_bf16 v[72:103], v[38:39], v[6:7], 0
    ds_read_b128 v[28:31], v18 offset:8256
    s_add_u32 s35, s35, 4096
    s_mov_b32 m0, s35
    s_add_u32 s34, s34, 4096
    buffer_load_dwordx4 v1, s[4:7], s34 offen sc1 lds
    v_exp_f32 v117, v117
    v_exp_f32 v118, v118
    v_exp_f32 v119, v119
    v_exp_f32 v120, v120
    v_exp_f32 v121, v121
    v_exp_f32 v122, v122
    v_exp_f32 v123, v123
    v_exp_f32 v124, v124
    v_smfmac_f32_32x32x32_bf16 v[40:55], v[20:23], v[112:119], v5
    ds_read_b128 v[108:111], v16 offset:9472
    v_exp_f32 v125, v125
    v_exp_f32 v126, v126
    v_exp_f32 v127, v127
    v_exp_f32 v128, v128
    v_exp_f32 v129, v129
    v_smfmac_f32_32x32x32_bf16 v[40:55], v[24:27], v[120:127], v5
    ds_read_b32 v36, v17 offset:10496
    s_add_u32 s35, s35, 4096
    s_mov_b32 m0, s35
    s_add_u32 s34, s34, 4096
    buffer_load_dwordx4 v1, s[4:7], s34 offen sc1 lds
    v_exp_f32 v130, v130
    v_exp_f32 v131, v131
    v_exp_f32 v132, v132
    v_exp_f32 v133, v133
    v_mfma_f32_32x32x16_bf16 v[72:87], v[104:107], v[8:11], v[72:87]
    v_exp_f32 v134, v134
    v_exp_f32 v135, v135
    v_exp_f32 v136, v136
    v_exp_f32 v137, v137
    v_smfmac_f32_32x32x32_bf16 v[56:71], v[20:23], v[128:135], v5
    v_exp_f32 v138, v138
    v_exp_f32 v139, v139
    v_exp_f32 v140, v140
    v_mfma_f32_32x32x16_bf16 v[88:103], v[104:107], v[12:15], v[88:103]
    v_exp_f32 v141, v141
    v_exp_f32 v142, v142
    v_exp_f32 v143, v143
    s_waitcnt lgkmcnt(0)
    s_setprio 1
    v_exp_f32 v72, v72
    v_exp_f32 v73, v73
    v_smfmac_f32_32x32x32_bf16 v[56:71], v[24:27], v[136:143], v5
    ds_read_b128 v[24:27], v18 offset:11232
    v_exp_f32 v74, v74
    v_exp_f32 v75, v75
    v_exp_f32 v76, v76
    v_mfma_f32_32x32x4_2b_bf16 v[112:143], v[36:37], v[6:7], 0
    ds_read_b128 v[20:23], v18 offset:10624
    s_add_u32 s35, s35, 4096
    s_mov_b32 m0, s35
    s_add_u32 s34, s34, 4096
    buffer_load_dwordx4 v1, s[4:7], s34 offen sc1 lds
    v_exp_f32 v77, v77
    v_exp_f32 v78, v78
    v_exp_f32 v79, v79
    v_exp_f32 v80, v80
    v_exp_f32 v81, v81
    v_exp_f32 v82, v82
    v_exp_f32 v83, v83
    v_exp_f32 v84, v84
    v_smfmac_f32_32x32x32_bf16 v[40:55], v[28:31], v[72:79], v5
    ds_read_b128 v[104:107], v16 offset:11840
    v_exp_f32 v85, v85
    v_exp_f32 v86, v86
    v_exp_f32 v87, v87
    v_exp_f32 v88, v88
    v_exp_f32 v89, v89
    v_smfmac_f32_32x32x32_bf16 v[40:55], v[32:35], v[80:87], v5
    ds_read_b32 v38, v17 offset:12864
    s_add_u32 s35, s35, 4096
    s_mov_b32 m0, s35
    s_add_u32 s34, s34, 4096
    buffer_load_dwordx4 v1, s[4:7], s34 offen sc1 lds
    v_exp_f32 v90, v90
    v_exp_f32 v91, v91
    v_exp_f32 v92, v92
    v_exp_f32 v93, v93
    v_mfma_f32_32x32x16_bf16 v[112:127], v[108:111], v[8:11], v[112:127]
    v_exp_f32 v94, v94
    v_exp_f32 v95, v95
    v_exp_f32 v96, v96
    v_exp_f32 v97, v97
    v_smfmac_f32_32x32x32_bf16 v[56:71], v[28:31], v[88:95], v5
    v_exp_f32 v98, v98
    v_exp_f32 v99, v99
    v_exp_f32 v100, v100
    v_mfma_f32_32x32x16_bf16 v[128:143], v[108:111], v[12:15], v[128:143]
    v_exp_f32 v101, v101
    v_exp_f32 v102, v102
    v_exp_f32 v103, v103
    s_waitcnt lgkmcnt(0)
    s_waitcnt vmcnt(4)
    s_barrier
    s_setprio 3
    v_exp_f32 v112, v112
    v_exp_f32 v113, v113
    v_smfmac_f32_32x32x32_bf16 v[56:71], v[32:35], v[96:103], v5
    ds_read_b128 v[32:35], v18 offset:13600
    v_exp_f32 v114, v114
    v_exp_f32 v115, v115
    v_exp_f32 v116, v116
    v_mfma_f32_32x32x4_2b_bf16 v[72:103], v[38:39], v[6:7], 0
    ds_read_b128 v[28:31], v18 offset:12992
    s_add_u32 s35, s35, 4096
    s_mov_b32 m0, s35
    s_add_u32 s34, s34, 4096
    buffer_load_dwordx4 v1, s[4:7], s34 offen sc1 lds
    v_exp_f32 v117, v117
    v_exp_f32 v118, v118
    v_exp_f32 v119, v119
    v_exp_f32 v120, v120
    v_exp_f32 v121, v121
    v_exp_f32 v122, v122
    v_exp_f32 v123, v123
    v_exp_f32 v124, v124
    v_smfmac_f32_32x32x32_bf16 v[40:55], v[20:23], v[112:119], v5
    ds_read_b128 v[108:111], v16 offset:14208
    v_exp_f32 v125, v125
    v_exp_f32 v126, v126
    v_exp_f32 v127, v127
    v_exp_f32 v128, v128
    v_exp_f32 v129, v129
    v_smfmac_f32_32x32x32_bf16 v[40:55], v[24:27], v[120:127], v5
    ds_read_b32 v36, v17 offset:15232
    s_add_u32 s35, s35, 4096
    s_mov_b32 m0, s35
    s_add_u32 s34, s34, 4096
    buffer_load_dwordx4 v1, s[4:7], s34 offen sc1 lds
    v_exp_f32 v130, v130
    v_exp_f32 v131, v131
    v_exp_f32 v132, v132
    v_exp_f32 v133, v133
    v_mfma_f32_32x32x16_bf16 v[72:87], v[104:107], v[8:11], v[72:87]
    v_exp_f32 v134, v134
    v_exp_f32 v135, v135
    v_exp_f32 v136, v136
    v_exp_f32 v137, v137
    v_smfmac_f32_32x32x32_bf16 v[56:71], v[20:23], v[128:135], v5
    s_cmp_eq_u32 s63, 0
    s_cbranch_scc1 UD_60
    s_mul_i32 s33, s13, 75776
    v_mul_lo_u32 v180, v3, s84
    v_add_u32 v180, s85, v180
    v_bfe_u32 v181, v0, 1, 4
    v_mul_lo_u32 v181, v181, s86
    v_and_b32 v182, 1, v0
    v_lshl_add_u32 v181, v182, 4, v181
    v_add_u32 v180, v180, v181
    s_mov_b32 s32, s33
    s_mov_b32 m0, s32
    s_add_u32 s32, s32, 1024
    buffer_load_dwordx4 v180, s[0:3], s68 offen lds
    s_mov_b32 m0, s32
    s_add_u32 s32, s32, 1024
    buffer_load_dwordx4 v180, s[0:3], s69 offen lds
    s_mov_b32 m0, s32
    s_add_u32 s32, s32, 1024
    buffer_load_dwordx4 v180, s[0:3], s70 offen lds
    s_mov_b32 m0, s32
    s_add_u32 s32, s32, 1024
    buffer_load_dwordx4 v180, s[0:3], s71 offen lds
    s_mov_b32 m0, s32
    s_add_u32 s32, s32, 1024
    buffer_load_dwordx4 v180, s[0:3], s72 offen lds
    s_mov_b32 m0, s32
    s_add_u32 s32, s32, 1024
    buffer_load_dwordx4 v180, s[0:3], s73 offen lds
    s_mov_b32 m0, s32
    s_add_u32 s32, s32, 1024
    buffer_load_dwordx4 v180, s[0:3], s74 offen lds
    s_mov_b32 m0, s32
    s_add_u32 s32, s32, 1024
    buffer_load_dwordx4 v180, s[0:3], s75 offen lds
    v_bfe_u32 v180, v0, 4, 1
    v_mul_lo_u32 v180, v180, s84
    v_add_u32 v180, s85, v180
    s_cmp_eq_u32 s91, 2
    s_cselect_b32 s22, 4, 36
    s_mov_b32 s23, 512
    s_cselect_b32 s23, s23, 32
    v_and_b32 v181, 15, v0
    v_mul_lo_u32 v181, v181, s22
    v_add3_u32 v180, v180, v181, s23
    s_mov_b32 exec_hi, 0
    s_mov_b32 m0, s32
    s_add_u32 s32, s32, 128
    buffer_load_dword v180, s[0:3], s68 offen lds
    s_mov_b32 m0, s32
    s_add_u32 s32, s32, 128
    buffer_load_dword v180, s[0:3], s69 offen lds
    s_mov_b32 m0, s32
    s_add_u32 s32, s32, 128
    buffer_load_dword v180, s[0:3], s70 offen lds
    s_mov_b32 m0, s32
    s_add_u32 s32, s32, 128
    buffer_load_dword v180, s[0:3], s71 offen lds
    s_mov_b32 m0, s32
    s_add_u32 s32, s32, 128
    buffer_load_dword v180, s[0:3], s72 offen lds
    s_mov_b32 m0, s32
    s_add_u32 s32, s32, 128
    buffer_load_dword v180, s[0:3], s73 offen lds
    s_mov_b32 m0, s32
    s_add_u32 s32, s32, 128
    buffer_load_dword v180, s[0:3], s74 offen lds
    s_mov_b32 m0, s32
    s_add_u32 s32, s32, 128
    buffer_load_dword v180, s[0:3], s75 offen lds
    s_mov_b64 exec, -1
UD_60:
    v_exp_f32 v138, v138
    v_exp_f32 v139, v139
    v_exp_f32 v140, v140
    v_mfma_f32_32x32x16_bf16 v[88:103], v[104:107], v[12:15], v[88:103]
    v_exp_f32 v141, v141
    v_exp_f32 v142, v142
    v_exp_f32 v143, v143
    s_waitcnt lgkmcnt(0)
    v_exp_f32 v72, v72
    v_exp_f32 v73, v73
    v_smfmac_f32_32x32x32_bf16 v[56:71], v[24:27], v[136:143], v5
    ds_read_b128 v[24:27], v18 offset:15968
    v_exp_f32 v74, v74
    v_exp_f32 v75, v75
    v_exp_f32 v76, v76
    v_mfma_f32_32x32x4_2b_bf16 v[112:143], v[36:37], v[6:7], 0
    ds_read_b128 v[20:23], v18 offset:15360
    s_add_u32 s35, s35, 4096
    s_mov_b32 m0, s35
    s_add_u32 s34, s34, 4096
    buffer_load_dwordx4 v1, s[4:7], s34 offen sc1 lds
    v_exp_f32 v77, v77
    v_exp_f32 v78, v78
    v_exp_f32 v79, v79
    v_exp_f32 v80, v80
    v_exp_f32 v81, v81
    v_exp_f32 v82, v82
    v_exp_f32 v83, v83
    v_exp_f32 v84, v84
    v_smfmac_f32_32x32x32_bf16 v[40:55], v[28:31], v[72:79], v5
    ds_read_b128 v[104:107], v16 offset:16576
    v_exp_f32 v85, v85
    v_exp_f32 v86, v86
    v_exp_f32 v87, v87
    v_exp_f32 v88, v88
    v_exp_f32 v89, v89
    v_smfmac_f32_32x32x32_bf16 v[40:55], v[32:35], v[80:87], v5
    ds_read_b32 v38, v17 offset:17600
    s_cmp_lt_u32 s13, 2
    s_cselect_b32 s36, 4096, 0
    s_add_u32 s35, s35, s36
    s_mov_b32 m0, s35
    s_add_u32 s34, s34, s36
    buffer_load_dwordx4 v1, s[4:7], s34 offen sc1 lds
    v_exp_f32 v90, v90
    v_exp_f32 v91, v91
    v_exp_f32 v92, v92
    v_exp_f32 v93, v93
    v_mfma_f32_32x32x16_bf16 v[112:127], v[108:111], v[8:11], v[112:127]
    v_exp_f32 v94, v94
    v_exp_f32 v95, v95
    v_exp_f32 v96, v96
    v_exp_f32 v97, v97
    v_smfmac_f32_32x32x32_bf16 v[56:71], v[28:31], v[88:95], v5
    v_exp_f32 v98, v98
    v_exp_f32 v99, v99
    v_exp_f32 v100, v100
    v_mfma_f32_32x32x16_bf16 v[128:143], v[108:111], v[12:15], v[128:143]
    v_exp_f32 v101, v101
    v_exp_f32 v102, v102
    v_exp_f32 v103, v103
    s_waitcnt lgkmcnt(0)
    v_exp_f32 v112, v112
    v_exp_f32 v113, v113
    v_smfmac_f32_32x32x32_bf16 v[56:71], v[32:35], v[96:103], v5
    ds_read_b128 v[32:35], v18 offset:18336
    v_exp_f32 v114, v114
    v_exp_f32 v115, v115
    v_exp_f32 v116, v116
    v_mfma_f32_32x32x4_2b_bf16 v[72:103], v[38:39], v[6:7], 0
    ds_read_b128 v[28:31], v18 offset:17728
    v_exp_f32 v117, v117
    v_exp_f32 v118, v118
    v_exp_f32 v119, v119
    v_exp_f32 v120, v120
    v_exp_f32 v121, v121
    v_exp_f32 v122, v122
    v_exp_f32 v123, v123
    v_exp_f32 v124, v124
    v_smfmac_f32_32x32x32_bf16 v[40:55], v[20:23], v[112:119], v5
    ds_read_b128 v[108:111], v16 offset:18944
    v_exp_f32 v125, v125
    v_exp_f32 v126, v126
    v_exp_f32 v127, v127
    v_exp_f32 v128, v128
    v_exp_f32 v129, v129
    v_smfmac_f32_32x32x32_bf16 v[40:55], v[24:27], v[120:127], v5
    ds_read_b32 v36, v17 offset:19968
    v_exp_f32 v130, v130
    v_exp_f32 v131, v131
    v_exp_f32 v132, v132
    v_exp_f32 v133, v133
    v_mfma_f32_32x32x16_bf16 v[72:87], v[104:107], v[8:11], v[72:87]
    v_exp_f32 v134, v134
    v_exp_f32 v135, v135
    v_exp_f32 v136, v136
    v_exp_f32 v137, v137
    v_smfmac_f32_32x32x32_bf16 v[56:71], v[20:23], v[128:135], v5
    v_exp_f32 v138, v138
    v_exp_f32 v139, v139
    v_exp_f32 v140, v140
    v_mfma_f32_32x32x16_bf16 v[88:103], v[104:107], v[12:15], v[88:103]
    v_exp_f32 v141, v141
    v_exp_f32 v142, v142
    v_exp_f32 v143, v143
    s_waitcnt lgkmcnt(0)
    v_exp_f32 v72, v72
    v_exp_f32 v73, v73
    v_smfmac_f32_32x32x32_bf16 v[56:71], v[24:27], v[136:143], v5
    ds_read_b128 v[24:27], v18 offset:20704
    v_lshlrev_b32 v19, 7, v0
    s_cmp_lt_u32 s12, 4
    s_cbranch_scc0 TC_61
    s_lshl_b32 s20, s17, 1
    s_lshr_b32 s21, s13, 1
    s_add_u32 s20, s20, s21
    s_lshl_b32 s20, s20, 4
    s_add_u32 s20, s20, s16
    s_mul_i32 s20, s20, 9472
    s_and_b32 s21, s13, 1
    s_mul_i32 s21, s21, 1280
    s_add_u32 s20, s20, s21
    s_add_u32 s20, s20, s47
    buffer_load_dword v19, v19, s[4:7], s20 offen
    s_branch TC_63
TC_61:
    s_cmp_lt_u32 s12, 6
    s_cbranch_scc0 TC_62
    s_lshl_b32 s20, s15, 13
    s_cmp_eq_u32 s12, 4
    s_cselect_b32 s20, s20, 28672
    s_add_u32 s20, s20, s45
    s_add_u32 s20, s20, s48
    buffer_load_dword v19, v19, s[4:7], s20 offen
    s_branch TC_63
TC_62:
    s_mul_i32 s20, s14, 2368
    s_add_u32 s20, s20, 8936448
    s_lshl_b32 s21, s14, 12
    s_add_u32 s21, s21, 9354240
    s_cmp_eq_u32 s12, 6
    s_cselect_b32 s20, s20, s21
    s_cmp_eq_u32 s18, 0
    s_cbranch_scc0 TC_62X
    s_mov_b32 exec_hi, 0
    buffer_load_dword v19, v19, s[4:7], s20 offen
    s_mov_b64 exec, -1
    s_branch TC_63
TC_62X:
    s_mul_i32 s20, s14, 36864
    s_mul_i32 s21, s15, 9216
    s_add_u32 s20, s20, s21
    s_and_b32 s21, s12, 1
    s_lshl_b32 s21, s21, 10
    s_add_u32 s20, s20, s21
    buffer_load_dword v19, v19, s[8:11], s20 offen
TC_63:
    v_exp_f32 v74, v74
    v_exp_f32 v75, v75
    v_exp_f32 v76, v76
    v_mfma_f32_32x32x4_2b_bf16 v[112:143], v[36:37], v[6:7], 0
    ds_read_b128 v[20:23], v18 offset:20096
    v_exp_f32 v77, v77
    v_exp_f32 v78, v78
    v_exp_f32 v79, v79
    v_exp_f32 v80, v80
    v_exp_f32 v81, v81
    v_exp_f32 v82, v82
    v_exp_f32 v83, v83
    v_exp_f32 v84, v84
    v_smfmac_f32_32x32x32_bf16 v[40:55], v[28:31], v[72:79], v5
    ds_read_b128 v[104:107], v16 offset:21312
    v_exp_f32 v85, v85
    v_exp_f32 v86, v86
    v_exp_f32 v87, v87
    v_exp_f32 v88, v88
    v_exp_f32 v89, v89
    v_smfmac_f32_32x32x32_bf16 v[40:55], v[32:35], v[80:87], v5
    ds_read_b32 v38, v17 offset:22336
    v_exp_f32 v90, v90
    v_exp_f32 v91, v91
    v_exp_f32 v92, v92
    v_exp_f32 v93, v93
    v_mfma_f32_32x32x16_bf16 v[112:127], v[108:111], v[8:11], v[112:127]
    v_exp_f32 v94, v94
    v_exp_f32 v95, v95
    v_exp_f32 v96, v96
    v_exp_f32 v97, v97
    v_smfmac_f32_32x32x32_bf16 v[56:71], v[28:31], v[88:95], v5
    v_exp_f32 v98, v98
    v_exp_f32 v99, v99
    v_exp_f32 v100, v100
    v_mfma_f32_32x32x16_bf16 v[128:143], v[108:111], v[12:15], v[128:143]
    v_exp_f32 v101, v101
    v_exp_f32 v102, v102
    v_exp_f32 v103, v103
    s_waitcnt lgkmcnt(0)
    v_exp_f32 v112, v112
    v_exp_f32 v113, v113
    v_smfmac_f32_32x32x32_bf16 v[56:71], v[32:35], v[96:103], v5
    ds_read_b128 v[32:35], v18 offset:23072
    v_exp_f32 v114, v114
    v_exp_f32 v115, v115
    v_exp_f32 v116, v116
    v_mfma_f32_32x32x4_2b_bf16 v[72:103], v[38:39], v[6:7], 0
    ds_read_b128 v[28:31], v18 offset:22464
    v_exp_f32 v117, v117
    v_exp_f32 v118, v118
    v_exp_f32 v119, v119
    v_exp_f32 v120, v120
    v_exp_f32 v121, v121
    v_exp_f32 v122, v122
    v_exp_f32 v123, v123
    v_exp_f32 v124, v124
    v_smfmac_f32_32x32x32_bf16 v[40:55], v[20:23], v[112:119], v5
    ds_read_b128 v[108:111], v16 offset:23680
    v_exp_f32 v125, v125
    v_exp_f32 v126, v126
    v_exp_f32 v127, v127
    v_exp_f32 v128, v128
    v_exp_f32 v129, v129
    v_smfmac_f32_32x32x32_bf16 v[40:55], v[24:27], v[120:127], v5
    ds_read_b32 v36, v17 offset:24704
    v_exp_f32 v130, v130
    v_exp_f32 v131, v131
    v_exp_f32 v132, v132
    v_exp_f32 v133, v133
    v_mfma_f32_32x32x16_bf16 v[72:87], v[104:107], v[8:11], v[72:87]
    v_exp_f32 v134, v134
    v_exp_f32 v135, v135
    v_exp_f32 v136, v136
    v_exp_f32 v137, v137
    v_smfmac_f32_32x32x32_bf16 v[56:71], v[20:23], v[128:135], v5
    v_exp_f32 v138, v138
    v_exp_f32 v139, v139
    v_exp_f32 v140, v140
    v_mfma_f32_32x32x16_bf16 v[88:103], v[104:107], v[12:15], v[88:103]
    v_exp_f32 v141, v141
    v_exp_f32 v142, v142
    v_exp_f32 v143, v143
    s_waitcnt lgkmcnt(0)
    s_setprio 2
    v_exp_f32 v72, v72
    v_exp_f32 v73, v73
    v_smfmac_f32_32x32x32_bf16 v[56:71], v[24:27], v[136:143], v5
    ds_read_b128 v[24:27], v18 offset:25440
    v_exp_f32 v74, v74
    v_exp_f32 v75, v75
    v_exp_f32 v76, v76
    v_mfma_f32_32x32x4_2b_bf16 v[112:143], v[36:37], v[6:7], 0
    ds_read_b128 v[20:23], v18 offset:24832
    v_exp_f32 v77, v77
    v_exp_f32 v78, v78
    v_exp_f32 v79, v79
    v_exp_f32 v80, v80
    v_exp_f32 v81, v81
    v_exp_f32 v82, v82
    v_exp_f32 v83, v83
    v_exp_f32 v84, v84
    v_smfmac_f32_32x32x32_bf16 v[40:55], v[28:31], v[72:79], v5
    ds_read_b128 v[104:107], v16 offset:26048
    v_exp_f32 v85, v85
    v_exp_f32 v86, v86
    v_exp_f32 v87, v87
    v_exp_f32 v88, v88
    v_exp_f32 v89, v89
    v_smfmac_f32_32x32x32_bf16 v[40:55], v[32:35], v[80:87], v5
    ds_read_b32 v38, v17 offset:27072
    v_exp_f32 v90, v90
    v_exp_f32 v91, v91
    v_exp_f32 v92, v92
    v_exp_f32 v93, v93
    v_mfma_f32_32x32x16_bf16 v[112:127], v[108:111], v[8:11], v[112:127]
    v_exp_f32 v94, v94
    v_exp_f32 v95, v95
    v_exp_f32 v96, v96
    v_exp_f32 v97, v97
    v_smfmac_f32_32x32x32_bf16 v[56:71], v[28:31], v[88:95], v5
    v_exp_f32 v98, v98
    v_exp_f32 v99, v99
    v_exp_f32 v100, v100
    v_mfma_f32_32x32x16_bf16 v[128:143], v[108:111], v[12:15], v[128:143]
    v_exp_f32 v101, v101
    v_exp_f32 v102, v102
    v_exp_f32 v103, v103
    s_waitcnt lgkmcnt(0)
    s_cmp_eq_u32 s63, 0
    s_cbranch_scc1 UO_64
    v_bfe_u32 v182, v0, 2, 2
    v_lshl_add_u32 v182, v3, 2, v182
    v_bfe_u32 v183, v0, 4, 1
    v_lshlrev_b32 v183, 5, v183
    v_and_b32 v184, 3, v0
    v_lshl_add_u32 v183, v184, 3, v183
    v_add_u32 v183, s33, v183
    v_lshl_add_u32 v180, v182, 9, v183
    v_lshl_add_u32 v181, v182, 6, v183
    v_lshrrev_b32 v182, 2, v2
    s_mov_b32 s22, 124928
    v_mul_lo_u32 v182, v182, s22
    v_mul_u32_u24 v183, 192, v3
    v_lshlrev_b32 v184, 4, v184
    v_add3_u32 v182, v182, v183, v184
    s_cmp_eq_u32 s91, 1
    s_cselect_b64 vcc, -1, 0
    v_cndmask_b32 v182, v1, v182, vcc
    s_waitcnt vmcnt(0)
    ds_read_b64_tr_b16 v[144:145], v180 offset:0
    ds_read_b64_tr_b16 v[146:147], v180 offset:4096
    ds_read_b64_tr_b16 v[148:149], v180 offset:64
    ds_read_b64_tr_b16 v[150:151], v180 offset:4160
    ds_read_b64_tr_b16 v[152:153], v180 offset:128
    ds_read_b64_tr_b16 v[154:155], v180 offset:4224
    ds_read_b64_tr_b16 v[156:157], v180 offset:192
    ds_read_b64_tr_b16 v[158:159], v180 offset:4288
    ds_read_b64_tr_b16 v[160:161], v180 offset:256
    ds_read_b64_tr_b16 v[162:163], v180 offset:4352
    ds_read_b64_tr_b16 v[164:165], v180 offset:320
    ds_read_b64_tr_b16 v[166:167], v180 offset:4416
    ds_read_b64_tr_b16 v[168:169], v180 offset:384
    ds_read_b64_tr_b16 v[170:171], v180 offset:4480
    ds_read_b64_tr_b16 v[172:173], v180 offset:448
    ds_read_b64_tr_b16 v[174:175], v180 offset:4544
    ds_read_b64_tr_b16 v[176:177], v181 offset:8192
    ds_read_b64_tr_b16 v[178:179], v181 offset:8704
    s_waitcnt lgkmcnt(0)
    buffer_store_dwordx4 v[144:147], v1, s[4:7], s87 offen sc1
    s_add_u32 s87, s87, s88
    buffer_store_dwordx4 v[148:151], v1, s[4:7], s87 offen sc1
    s_add_u32 s87, s87, s88
    buffer_store_dwordx4 v[152:155], v1, s[4:7], s87 offen sc1
    s_add_u32 s87, s87, s88
    buffer_store_dwordx4 v[156:159], v1, s[4:7], s87 offen sc1
    s_add_u32 s87, s87, s88
    buffer_store_dwordx4 v[160:163], v1, s[4:7], s87 offen sc1
    s_add_u32 s87, s87, s88
    buffer_store_dwordx4 v[164:167], v1, s[4:7], s87 offen sc1
    s_add_u32 s87, s87, s88
    buffer_store_dwordx4 v[168:171], v1, s[4:7], s87 offen sc1
    s_add_u32 s87, s87, s88
    buffer_store_dwordx4 v[172:175], v1, s[4:7], s87 offen sc1
    s_add_u32 s87, s87, s88
    buffer_store_dwordx4 v[176:179], v182, s[4:7], s90 offen sc1
    s_mov_b32 s63, 0
UO_64:
    v_exp_f32 v112, v112
    v_exp_f32 v113, v113
    v_smfmac_f32_32x32x32_bf16 v[56:71], v[32:35], v[96:103], v5
    ds_read_b128 v[32:35], v18 offset:27808
    v_exp_f32 v114, v114
    v_exp_f32 v115, v115
    v_exp_f32 v116, v116
    v_mfma_f32_32x32x4_2b_bf16 v[72:103], v[38:39], v[6:7], 0
    ds_read_b128 v[28:31], v18 offset:27200
    v_exp_f32 v117, v117
    v_exp_f32 v118, v118
    v_exp_f32 v119, v119
    v_exp_f32 v120, v120
    v_exp_f32 v121, v121
    v_exp_f32 v122, v122
    v_exp_f32 v123, v123
    v_exp_f32 v124, v124
    v_smfmac_f32_32x32x32_bf16 v[40:55], v[20:23], v[112:119], v5
    ds_read_b128 v[108:111], v16 offset:28416
    v_exp_f32 v125, v125
    v_exp_f32 v126, v126
    v_exp_f32 v127, v127
    v_exp_f32 v128, v128
    v_exp_f32 v129, v129
    v_smfmac_f32_32x32x32_bf16 v[40:55], v[24:27], v[120:127], v5
    ds_read_b32 v36, v17 offset:29440
    v_exp_f32 v130, v130
    v_exp_f32 v131, v131
    v_exp_f32 v132, v132
    v_exp_f32 v133, v133
    v_mfma_f32_32x32x16_bf16 v[72:87], v[104:107], v[8:11], v[72:87]
    v_exp_f32 v134, v134
    v_exp_f32 v135, v135
    v_exp_f32 v136, v136
    v_exp_f32 v137, v137
    v_smfmac_f32_32x32x32_bf16 v[56:71], v[20:23], v[128:135], v5
    v_exp_f32 v138, v138
    v_exp_f32 v139, v139
    v_exp_f32 v140, v140
    v_mfma_f32_32x32x16_bf16 v[88:103], v[104:107], v[12:15], v[88:103]
    v_exp_f32 v141, v141
    v_exp_f32 v142, v142
    v_exp_f32 v143, v143
    s_waitcnt lgkmcnt(0)
    v_exp_f32 v72, v72
    v_exp_f32 v73, v73
    v_smfmac_f32_32x32x32_bf16 v[56:71], v[24:27], v[136:143], v5
    ds_read_b128 v[24:27], v18 offset:30176
    v_exp_f32 v74, v74
    v_exp_f32 v75, v75
    v_exp_f32 v76, v76
    v_mfma_f32_32x32x4_2b_bf16 v[112:143], v[36:37], v[6:7], 0
    ds_read_b128 v[20:23], v18 offset:29568
    v_exp_f32 v77, v77
    v_exp_f32 v78, v78
    v_exp_f32 v79, v79
    v_exp_f32 v80, v80
    v_exp_f32 v81, v81
    v_exp_f32 v82, v82
    v_exp_f32 v83, v83
    v_exp_f32 v84, v84
    v_smfmac_f32_32x32x32_bf16 v[40:55], v[28:31], v[72:79], v5
    ds_read_b128 v[104:107], v16 offset:30784
    v_exp_f32 v85, v85
    v_exp_f32 v86, v86
    v_exp_f32 v87, v87
    v_exp_f32 v88, v88
    v_exp_f32 v89, v89
    v_smfmac_f32_32x32x32_bf16 v[40:55], v[32:35], v[80:87], v5
    ds_read_b32 v38, v17 offset:31808
    v_exp_f32 v90, v90
    v_exp_f32 v91, v91
    v_exp_f32 v92, v92
    v_exp_f32 v93, v93
    v_mfma_f32_32x32x16_bf16 v[112:127], v[108:111], v[8:11], v[112:127]
    v_exp_f32 v94, v94
    v_exp_f32 v95, v95
    v_exp_f32 v96, v96
    v_exp_f32 v97, v97
    v_smfmac_f32_32x32x32_bf16 v[56:71], v[28:31], v[88:95], v5
    v_exp_f32 v98, v98
    v_exp_f32 v99, v99
    v_exp_f32 v100, v100
    v_mfma_f32_32x32x16_bf16 v[128:143], v[108:111], v[12:15], v[128:143]
    v_exp_f32 v101, v101
    v_exp_f32 v102, v102
    v_exp_f32 v103, v103
    s_waitcnt lgkmcnt(0)
    s_lshl_b32 s20, s18, 3
    s_add_u32 s20, s20, s12
    s_cmp_lt_u32 s20, 2
    s_cbranch_scc0 UF_65
    s_lshl_b32 s20, s49, 1
    s_lshl_b32 s21, s13, 2
    s_add_u32 s20, s20, s21
    s_add_u32 s20, s20, 147456
    v_mov_b32 v180, s96
    v_mov_b32 v181, s20
    s_waitcnt vmcnt(0)
    s_mov_b64 exec, 1
    s_cmp_eq_u32 s55, 0
    s_cbranch_scc1 LS_66
    buffer_store_dword v180, v181, s[4:7], s42 offen
    s_branch LD_67
LS_66:
    buffer_store_dword v180, v181, s[4:7], s42 offen sc1
LD_67:
    s_mov_b64 exec, -1
UF_65:
    v_exp_f32 v112, v112
    v_exp_f32 v113, v113
    v_smfmac_f32_32x32x32_bf16 v[56:71], v[32:35], v[96:103], v5
    ds_read_b128 v[32:35], v18 offset:32544
    v_exp_f32 v114, v114
    v_exp_f32 v115, v115
    v_exp_f32 v116, v116
    v_mfma_f32_32x32x4_2b_bf16 v[72:103], v[38:39], v[6:7], 0
    ds_read_b128 v[28:31], v18 offset:31936
    v_exp_f32 v117, v117
    v_exp_f32 v118, v118
    v_exp_f32 v119, v119
    v_exp_f32 v120, v120
    v_exp_f32 v121, v121
    v_exp_f32 v122, v122
    v_exp_f32 v123, v123
    v_exp_f32 v124, v124
    v_smfmac_f32_32x32x32_bf16 v[40:55], v[20:23], v[112:119], v5
    ds_read_b128 v[108:111], v16 offset:33152
    v_exp_f32 v125, v125
    v_exp_f32 v126, v126
    v_exp_f32 v127, v127
    v_exp_f32 v128, v128
    v_exp_f32 v129, v129
    v_smfmac_f32_32x32x32_bf16 v[40:55], v[24:27], v[120:127], v5
    ds_read_b32 v36, v17 offset:34176
    v_exp_f32 v130, v130
    v_exp_f32 v131, v131
    v_exp_f32 v132, v132
    v_exp_f32 v133, v133
    v_mfma_f32_32x32x16_bf16 v[72:87], v[104:107], v[8:11], v[72:87]
    v_exp_f32 v134, v134
    v_exp_f32 v135, v135
    v_exp_f32 v136, v136
    v_exp_f32 v137, v137
    v_smfmac_f32_32x32x32_bf16 v[56:71], v[20:23], v[128:135], v5
    v_exp_f32 v138, v138
    v_exp_f32 v139, v139
    v_exp_f32 v140, v140
    v_mfma_f32_32x32x16_bf16 v[88:103], v[104:107], v[12:15], v[88:103]
    v_exp_f32 v141, v141
    v_exp_f32 v142, v142
    v_exp_f32 v143, v143
    s_waitcnt lgkmcnt(0)
    s_setprio 1
    v_exp_f32 v72, v72
    v_exp_f32 v73, v73
    v_smfmac_f32_32x32x32_bf16 v[56:71], v[24:27], v[136:143], v5
    ds_read_b128 v[24:27], v18 offset:34912
    v_exp_f32 v74, v74
    v_exp_f32 v75, v75
    v_exp_f32 v76, v76
    v_mfma_f32_32x32x4_2b_bf16 v[112:143], v[36:37], v[6:7], 0
    ds_read_b128 v[20:23], v18 offset:34304
    v_exp_f32 v77, v77
    v_exp_f32 v78, v78
    v_exp_f32 v79, v79
    v_exp_f32 v80, v80
    v_exp_f32 v81, v81
    v_exp_f32 v82, v82
    v_exp_f32 v83, v83
    v_exp_f32 v84, v84
    v_smfmac_f32_32x32x32_bf16 v[40:55], v[28:31], v[72:79], v5
    ds_read_b128 v[104:107], v16 offset:35520
    v_exp_f32 v85, v85
    v_exp_f32 v86, v86
    v_exp_f32 v87, v87
    v_exp_f32 v88, v88
    v_exp_f32 v89, v89
    v_smfmac_f32_32x32x32_bf16 v[40:55], v[32:35], v[80:87], v5
    ds_read_b32 v38, v17 offset:36544
    v_exp_f32 v90, v90
    v_exp_f32 v91, v91
    v_exp_f32 v92, v92
    v_exp_f32 v93, v93
    v_mfma_f32_32x32x16_bf16 v[112:127], v[108:111], v[8:11], v[112:127]
    v_exp_f32 v94, v94
    v_exp_f32 v95, v95
    v_exp_f32 v96, v96
    v_exp_f32 v97, v97
    v_smfmac_f32_32x32x32_bf16 v[56:71], v[28:31], v[88:95], v5
    v_exp_f32 v98, v98
    v_exp_f32 v99, v99
    v_exp_f32 v100, v100
    v_mfma_f32_32x32x16_bf16 v[128:143], v[108:111], v[12:15], v[128:143]
    v_exp_f32 v101, v101
    v_exp_f32 v102, v102
    v_exp_f32 v103, v103
    s_waitcnt lgkmcnt(0)
    s_lshl_b32 s20, s18, 3
    s_add_u32 s20, s20, s12
    s_lshl_b32 s20, s20, 7
    s_and_b32 s21, s49, 0x7c
    s_add_u32 s20, s20, s21
    s_cmp_eq_u32 s20, 256
    s_cbranch_scc0 UA_68
    s_lshl_b32 s20, s49, 1
    s_add_u32 s20, s20, 147456
    v_lshlrev_b32 v180, 2, v0
    v_add_u32 v180, s20, v180
    s_mov_b32 s38, 0
POLL_69:
    buffer_load_dword v181, v180, s[4:7], s42 offen sc1
    s_waitcnt vmcnt(0)
    v_cmp_ne_u32 vcc, s96, v181
    s_cbranch_vccz POLLD_70
    s_sleep 2
    s_add_u32 s38, s38, 1
    s_cmp_lt_u32 s38, 200000
    s_cbranch_scc1 POLL_69
POLLD_70:
    s_add_u32 s20, s49, 155648
    v_lshlrev_b32 v180, 10, v0
    v_add_u32 v180, s20, v180
    v_mov_b32 v181, s96
    s_mov_b64 exec, 0xff
    buffer_store_dword v181, v180, s[4:7], s42 offen sc1
    s_mov_b64 exec, -1
UA_68:
    v_exp_f32 v112, v112
    v_exp_f32 v113, v113
    v_smfmac_f32_32x32x32_bf16 v[56:71], v[32:35], v[96:103], v5
    ds_read_b128 v[32:35], v18 offset:37280
    v_exp_f32 v114, v114
    v_exp_f32 v115, v115
    v_exp_f32 v116, v116
    v_mfma_f32_32x32x4_2b_bf16 v[72:103], v[38:39], v[6:7], 0
    ds_read_b128 v[28:31], v18 offset:36672
    v_exp_f32 v117, v117
    v_exp_f32 v118, v118
    v_exp_f32 v119, v119
    v_exp_f32 v120, v120
    v_exp_f32 v121, v121
    v_exp_f32 v122, v122
    v_exp_f32 v123, v123
    v_exp_f32 v124, v124
    v_smfmac_f32_32x32x32_bf16 v[40:55], v[20:23], v[112:119], v5
    ds_read_b128 v[108:111], v16 offset:37888
    v_exp_f32 v125, v125
    v_exp_f32 v126, v126
    v_exp_f32 v127, v127
    v_exp_f32 v128, v128
    v_exp_f32 v129, v129
    v_smfmac_f32_32x32x32_bf16 v[40:55], v[24:27], v[120:127], v5
    ds_read_b32 v36, v17 offset:38912
    v_exp_f32 v130, v130
    v_exp_f32 v131, v131
    v_exp_f32 v132, v132
    v_exp_f32 v133, v133
    v_mfma_f32_32x32x16_bf16 v[72:87], v[104:107], v[8:11], v[72:87]
    v_exp_f32 v134, v134
    v_exp_f32 v135, v135
    v_exp_f32 v136, v136
    v_exp_f32 v137, v137
    v_smfmac_f32_32x32x32_bf16 v[56:71], v[20:23], v[128:135], v5
    v_exp_f32 v138, v138
    v_exp_f32 v139, v139
    v_exp_f32 v140, v140
    v_mfma_f32_32x32x16_bf16 v[88:103], v[104:107], v[12:15], v[88:103]
    v_exp_f32 v141, v141
    v_exp_f32 v142, v142
    v_exp_f32 v143, v143
    s_waitcnt lgkmcnt(0)
    s_setprio 0
    v_exp_f32 v72, v72
    v_exp_f32 v73, v73
    v_smfmac_f32_32x32x32_bf16 v[56:71], v[24:27], v[136:143], v5
    ds_read_b128 v[24:27], v18 offset:39648
    v_exp_f32 v74, v74
    v_exp_f32 v75, v75
    v_exp_f32 v76, v76
    v_mfma_f32_32x32x4_2b_bf16 v[112:143], v[36:37], v[6:7], 0
    ds_read_b128 v[20:23], v18 offset:39040
    v_exp_f32 v77, v77
    v_exp_f32 v78, v78
    v_exp_f32 v79, v79
    v_exp_f32 v80, v80
    v_exp_f32 v81, v81
    v_exp_f32 v82, v82
    v_exp_f32 v83, v83
    v_exp_f32 v84, v84
    v_smfmac_f32_32x32x32_bf16 v[40:55], v[28:31], v[72:79], v5
    ds_read_b128 v[104:107], v16 offset:40256
    v_exp_f32 v85, v85
    v_exp_f32 v86, v86
    v_exp_f32 v87, v87
    v_exp_f32 v88, v88
    v_exp_f32 v89, v89
    v_smfmac_f32_32x32x32_bf16 v[40:55], v[32:35], v[80:87], v5
    ds_read_b32 v38, v17 offset:41280
    v_exp_f32 v90, v90
    v_exp_f32 v91, v91
    v_exp_f32 v92, v92
    v_exp_f32 v93, v93
    v_mfma_f32_32x32x16_bf16 v[112:127], v[108:111], v[8:11], v[112:127]
    v_exp_f32 v94, v94
    v_exp_f32 v95, v95
    v_exp_f32 v96, v96
    v_exp_f32 v97, v97
    v_smfmac_f32_32x32x32_bf16 v[56:71], v[28:31], v[88:95], v5
    v_exp_f32 v98, v98
    v_exp_f32 v99, v99
    v_exp_f32 v100, v100
    v_mfma_f32_32x32x16_bf16 v[128:143], v[108:111], v[12:15], v[128:143]
    v_exp_f32 v101, v101
    v_exp_f32 v102, v102
    v_exp_f32 v103, v103
    s_waitcnt lgkmcnt(0)
    s_lshl_b32 s20, s18, 3
    s_add_u32 s20, s20, s12
    s_cmp_eq_u32 s20, 3
    s_cbranch_scc0 UW_71
    s_and_b32 s20, s49, 0x380
    s_lshl_b32 s20, s20, 3
    s_add_u32 s20, s20, 155648
    v_and_b32 v180, 7, v0
    v_lshlrev_b32 v180, 7, v180
    v_add_u32 v180, s20, v180
    s_mov_b32 s38, 0
POLL_72:
    buffer_load_dword v181, v180, s[4:7], s42 offen sc1
    s_waitcnt vmcnt(0)
    v_cmp_ne_u32 vcc, s96, v181
    s_cbranch_vccz POLLD_73
    s_sleep 2
    s_add_u32 s38, s38, 1
    s_cmp_lt_u32 s38, 200000
    s_cbranch_scc1 POLL_72
POLLD_73:
UW_71:
    s_waitcnt vmcnt(0)
    s_barrier
    v_add_u32 v16, 37888, v16
    v_add_u32 v17, 37888, v17
    v_add_u32 v18, 37888, v18
    s_setprio 3
    v_exp_f32 v112, v112
    v_exp_f32 v113, v113
    v_smfmac_f32_32x32x32_bf16 v[56:71], v[32:35], v[96:103], v5
    ds_read_b128 v[32:35], v18 offset:4128
    s_mul_i32 s35, s13, 9
    s_mul_i32 s34, s13, 10
    s_min_u32 s34, s34, 22
    s_add_u32 s34, s34, 74
    s_cmp_eq_u32 s19, 0
    s_cselect_b32 s35, s35, s34
    s_lshl_b32 s35, s35, 10
    s_add_u32 s34, s35, s53
    v_exp_f32 v114, v114
    v_exp_f32 v115, v115
    v_exp_f32 v116, v116
    v_mfma_f32_32x32x4_2b_bf16 v[72:103], v[38:39], v[6:7], 0
    ds_read_b128 v[28:31], v18 offset:3520
    s_mov_b32 m0, s35
    s_nop 0
    buffer_load_dwordx4 v1, s[4:7], s34 offen offset:0 lds
    v_exp_f32 v117, v117
    v_exp_f32 v118, v118
    v_exp_f32 v119, v119
    v_exp_f32 v120, v120
    v_exp_f32 v121, v121
    v_exp_f32 v122, v122
    v_exp_f32 v123, v123
    v_exp_f32 v124, v124
    v_smfmac_f32_32x32x32_bf16 v[40:55], v[20:23], v[112:119], v5
    ds_read_b128 v[108:111], v16 offset:4736
    v_exp_f32 v125, v125
    v_exp_f32 v126, v126
    v_exp_f32 v127, v127
    v_exp_f32 v128, v128
    v_exp_f32 v129, v129
    v_smfmac_f32_32x32x32_bf16 v[40:55], v[24:27], v[120:127], v5
    ds_read_b32 v36, v17 offset:5760
    buffer_load_dwordx4 v[252:255], v1, s[4:7], s37 offen offset:0
    v_exp_f32 v130, v130
    v_exp_f32 v131, v131
    v_exp_f32 v132, v132
    v_exp_f32 v133, v133
    v_mfma_f32_32x32x16_bf16 v[72:87], v[104:107], v[8:11], v[72:87]
    buffer_load_dwordx4 v[248:251], v1, s[4:7], s37 offen offset:1024
    v_exp_f32 v134, v134
    v_exp_f32 v135, v135
    v_exp_f32 v136, v136
    v_exp_f32 v137, v137
    v_smfmac_f32_32x32x32_bf16 v[56:71], v[20:23], v[128:135], v5
    v_exp_f32 v138, v138
    v_exp_f32 v139, v139
    v_exp_f32 v140, v140
    v_mfma_f32_32x32x16_bf16 v[88:103], v[104:107], v[12:15], v[88:103]
    buffer_load_dwordx4 v[244:247], v1, s[4:7], s37 offen offset:2048
    v_exp_f32 v141, v141
    v_exp_f32 v142, v142
    v_exp_f32 v143, v143
    s_waitcnt lgkmcnt(0)
    v_exp_f32 v72, v72
    v_exp_f32 v73, v73
    v_smfmac_f32_32x32x32_bf16 v[56:71], v[24:27], v[136:143], v5
    ds_read_b128 v[24:27], v18 offset:6496
    v_exp_f32 v74, v74
    v_exp_f32 v75, v75
    v_exp_f32 v76, v76
    v_mfma_f32_32x32x4_2b_bf16 v[112:143], v[36:37], v[6:7], 0
    ds_read_b128 v[20:23], v18 offset:5888
    buffer_load_dwordx4 v1, s[4:7], s34 offen offset:1024 lds
    v_exp_f32 v77, v77
    v_exp_f32 v78, v78
    v_exp_f32 v79, v79
    v_exp_f32 v80, v80
    v_exp_f32 v81, v81
    v_exp_f32 v82, v82
    v_exp_f32 v83, v83
    v_exp_f32 v84, v84
    v_smfmac_f32_32x32x32_bf16 v[40:55], v[28:31], v[72:79], v5
    ds_read_b128 v[104:107], v16 offset:7104
    v_exp_f32 v85, v85
    v_exp_f32 v86, v86
    v_exp_f32 v87, v87
    v_exp_f32 v88, v88
    v_exp_f32 v89, v89
    v_smfmac_f32_32x32x32_bf16 v[40:55], v[32:35], v[80:87], v5
    ds_read_b32 v38, v17 offset:8128
    buffer_load_dwordx4 v[240:243], v1, s[4:7], s37 offen offset:3072
    s_add_u32 s37, s37, 4096
    v_exp_f32 v90, v90
    v_exp_f32 v91, v91
    v_exp_f32 v92, v92
    v_exp_f32 v93, v93
    v_mfma_f32_32x32x16_bf16 v[112:127], v[108:111], v[8:11], v[112:127]
    buffer_load_dwordx4 v[236:239], v1, s[4:7], s37 offen offset:0
    v_exp_f32 v94, v94
    v_exp_f32 v95, v95
    v_exp_f32 v96, v96
    v_exp_f32 v97, v97
    v_smfmac_f32_32x32x32_bf16 v[56:71], v[28:31], v[88:95], v5
    v_exp_f32 v98, v98
    v_exp_f32 v99, v99
    v_exp_f32 v100, v100
    v_mfma_f32_32x32x16_bf16 v[128:143], v[108:111], v[12:15], v[128:143]
    s_mov_b32 s64, 0xffffffff
    s_mov_b32 s65, 0xffffff00
    s_mov_b32 s66, 0xfffffffe
    s_mov_b32 s67, 0xfffffe00
    s_mov_b32 s68, 0xfffffffc
    s_mov_b32 s69, 0xfffffc00
    s_mov_b32 s70, 0xfffffff8
    s_mov_b32 s71, 0xfffff800
    s_mov_b32 s72, 0xfffffff0
    s_mov_b32 s73, 0xfffff000
    s_mov_b32 s74, 0xffffffe0
    s_mov_b32 s75, 0xffffe000
    s_mov_b32 s76, 0xffffffc0
    s_mov_b32 s77, 0xffffc000
    s_mov_b32 s78, 0xffffff80
    s_mov_b32 s79, 0xffff8000
    s_mov_b32 s80, 0xffff0000
    s_mov_b32 s81, 0xff000000
    s_mov_b32 s82, 0xfffe0000
    s_mov_b32 s83, 0xfe000000
    s_mov_b32 s84, 0xfffc0000
    s_mov_b32 s85, 0xfc000000
    s_mov_b32 s86, 0xfff80000
    s_mov_b32 s87, 0xf8000000
    s_mov_b32 s88, 0xfff00000
    s_mov_b32 s89, 0xf0000000
    s_mov_b32 s90, 0xffe00000
    s_mov_b32 s91, 0xe0000000
    s_mov_b32 s92, 0xffc00000
    s_mov_b32 s93, 0xc0000000
    s_mov_b32 s94, 0xff800000
    s_mov_b32 s95, 0x80000000
    buffer_load_dwordx4 v[232:235], v1, s[4:7], s37 offen offset:1024
    v_exp_f32 v101, v101
    v_exp_f32 v102, v102
    v_exp_f32 v103, v103
    s_waitcnt lgkmcnt(0)
    v_exp_f32 v112, v112
    v_exp_f32 v113, v113
    v_smfmac_f32_32x32x32_bf16 v[56:71], v[32:35], v[96:103], v5
    ds_read_b128 v[32:35], v18 offset:8864
    v_exp_f32 v114, v114
    v_exp_f32 v115, v115
    v_exp_f32 v116, v116
    v_mfma_f32_32x32x4_2b_bf16 v[72:103], v[38:39], v[6:7], 0
    ds_read_b128 v[28:31], v18 offset:8256
    buffer_load_dwordx4 v1, s[4:7], s34 offen offset:2048 lds
    v_exp_f32 v117, v117
    v_exp_f32 v118, v118
    v_exp_f32 v119, v119
    v_exp_f32 v120, v120
    v_exp_f32 v121, v121
    v_exp_f32 v122, v122
    v_exp_f32 v123, v123
    v_exp_f32 v124, v124
    v_smfmac_f32_32x32x32_bf16 v[40:55], v[20:23], v[112:119], v5
    ds_read_b128 v[108:111], v16 offset:9472
    v_lshlrev_b32 v19, 7, v0
    s_and_b32 s22, s14, 7
    s_cmp_gt_u32 s22, 2
    s_cbranch_scc1 TC_74
    s_lshl_b32 s20, s15, 2
    s_add_u32 s20, s20, s13
    s_mul_i32 s20, s20, 36864
    s_add_u32 s20, s20, 28672
    s_and_b32 s23, s15, 1
    s_add_u32 s23, s23, 16
    s_lshl_b32 s23, s23, 2
    s_add_u32 s23, s23, s13
    s_mul_i32 s23, s23, 9216
    s_add_u32 s23, s23, 0
    s_cmp_eq_u32 s22, 0
    s_cselect_b32 s20, s20, s23
    s_add_u32 s23, s23, 1024
    s_cmp_eq_u32 s22, 2
    s_cselect_b32 s20, s23, s20
    s_add_u32 s20, s20, s54
    buffer_load_dword v144, v19, s[4:7], s20 offen
TC_74:
    v_exp_f32 v125, v125
    v_exp_f32 v126, v126
    v_exp_f32 v127, v127
    v_exp_f32 v128, v128
    v_exp_f32 v129, v129
    v_smfmac_f32_32x32x32_bf16 v[40:55], v[24:27], v[120:127], v5
    ds_read_b32 v36, v17 offset:10496
    buffer_load_dwordx4 v[228:231], v1, s[4:7], s37 offen offset:2048
    v_exp_f32 v130, v130
    v_exp_f32 v131, v131
    v_exp_f32 v132, v132
    v_exp_f32 v133, v133
    v_mfma_f32_32x32x16_bf16 v[72:87], v[104:107], v[8:11], v[72:87]
    buffer_load_dwordx4 v[224:227], v1, s[4:7], s37 offen offset:3072
    s_add_u32 s37, s37, 4096
    v_exp_f32 v134, v134
    v_exp_f32 v135, v135
    v_exp_f32 v136, v136
    v_exp_f32 v137, v137
    v_smfmac_f32_32x32x32_bf16 v[56:71], v[20:23], v[128:135], v5
    v_exp_f32 v138, v138
    v_exp_f32 v139, v139
    v_exp_f32 v140, v140
    v_mfma_f32_32x32x16_bf16 v[88:103], v[104:107], v[12:15], v[88:103]
    buffer_load_dwordx4 v[220:223], v1, s[4:7], s37 offen offset:0
    v_exp_f32 v141, v141
    v_exp_f32 v142, v142
    v_exp_f32 v143, v143
    s_waitcnt lgkmcnt(0)
    v_exp_f32 v72, v72
    v_exp_f32 v73, v73
    v_smfmac_f32_32x32x32_bf16 v[56:71], v[24:27], v[136:143], v5
    ds_read_b128 v[24:27], v18 offset:11232
    v_exp_f32 v74, v74
    v_exp_f32 v75, v75
    v_exp_f32 v76, v76
    v_mfma_f32_32x32x4_2b_bf16 v[112:143], v[36:37], v[6:7], 0
    ds_read_b128 v[20:23], v18 offset:10624
    buffer_load_dwordx4 v1, s[4:7], s34 offen offset:3072 lds
    v_exp_f32 v77, v77
    v_exp_f32 v78, v78
    v_exp_f32 v79, v79
    v_exp_f32 v80, v80
    v_exp_f32 v81, v81
    v_exp_f32 v82, v82
    v_exp_f32 v83, v83
    v_exp_f32 v84, v84
    v_smfmac_f32_32x32x32_bf16 v[40:55], v[28:31], v[72:79], v5
    ds_read_b128 v[104:107], v16 offset:11840
    v_exp_f32 v85, v85
    v_exp_f32 v86, v86
    v_exp_f32 v87, v87
    v_exp_f32 v88, v88
    v_exp_f32 v89, v89
    v_smfmac_f32_32x32x32_bf16 v[40:55], v[32:35], v[80:87], v5
    ds_read_b32 v38, v17 offset:12864
    buffer_load_dwordx4 v[216:219], v1, s[4:7], s37 offen offset:1024
    v_exp_f32 v90, v90
    v_exp_f32 v91, v91
    v_exp_f32 v92, v92
    v_exp_f32 v93, v93
    v_mfma_f32_32x32x16_bf16 v[112:127], v[108:111], v[8:11], v[112:127]
    buffer_load_dwordx4 v[212:215], v1, s[4:7], s37 offen offset:2048
    v_exp_f32 v94, v94
    v_exp_f32 v95, v95
    v_exp_f32 v96, v96
    v_exp_f32 v97, v97
    v_smfmac_f32_32x32x32_bf16 v[56:71], v[28:31], v[88:95], v5
    v_exp_f32 v98, v98
    v_exp_f32 v99, v99
    v_exp_f32 v100, v100
    v_mfma_f32_32x32x16_bf16 v[128:143], v[108:111], v[12:15], v[128:143]
    buffer_load_dwordx4 v[208:211], v1, s[4:7], s37 offen offset:3072
    s_add_u32 s37, s37, 4096
    v_exp_f32 v101, v101
    v_exp_f32 v102, v102
    v_exp_f32 v103, v103
    s_waitcnt lgkmcnt(0)
    v_exp_f32 v112, v112
    v_exp_f32 v113, v113
    v_smfmac_f32_32x32x32_bf16 v[56:71], v[32:35], v[96:103], v5
    ds_read_b128 v[32:35], v18 offset:13600
    v_exp_f32 v114, v114
    v_exp_f32 v115, v115
    v_exp_f32 v116, v116
    v_mfma_f32_32x32x4_2b_bf16 v[72:103], v[38:39], v[6:7], 0
    ds_read_b128 v[28:31], v18 offset:12992
    s_add_u32 s35, s35, 4096
    s_add_u32 s34, s34, 4096
    s_mov_b32 m0, s35
    s_nop 0
    buffer_load_dwordx4 v1, s[4:7], s34 offen offset:0 lds
    v_exp_f32 v117, v117
    v_exp_f32 v118, v118
    v_exp_f32 v119, v119
    v_exp_f32 v120, v120
    v_exp_f32 v121, v121
    v_exp_f32 v122, v122
    v_exp_f32 v123, v123
    v_exp_f32 v124, v124
    v_smfmac_f32_32x32x32_bf16 v[40:55], v[20:23], v[112:119], v5
    ds_read_b128 v[108:111], v16 offset:14208
    v_exp_f32 v125, v125
    v_exp_f32 v126, v126
    v_exp_f32 v127, v127
    v_exp_f32 v128, v128
    v_exp_f32 v129, v129
    v_smfmac_f32_32x32x32_bf16 v[40:55], v[24:27], v[120:127], v5
    ds_read_b32 v36, v17 offset:15232
    buffer_load_dwordx4 v[204:207], v1, s[4:7], s37 offen offset:0
    v_exp_f32 v130, v130
    v_exp_f32 v131, v131
    v_exp_f32 v132, v132
    v_exp_f32 v133, v133
    v_mfma_f32_32x32x16_bf16 v[72:87], v[104:107], v[8:11], v[72:87]
    buffer_load_dwordx4 v[200:203], v1, s[4:7], s37 offen offset:1024
    v_exp_f32 v134, v134
    v_exp_f32 v135, v135
    v_exp_f32 v136, v136
    v_exp_f32 v137, v137
    v_smfmac_f32_32x32x32_bf16 v[56:71], v[20:23], v[128:135], v5
    v_exp_f32 v138, v138
    v_exp_f32 v139, v139
    v_exp_f32 v140, v140
    v_mfma_f32_32x32x16_bf16 v[88:103], v[104:107], v[12:15], v[88:103]
    buffer_load_dwordx4 v[196:199], v1, s[4:7], s37 offen offset:2048
    v_exp_f32 v141, v141
    v_exp_f32 v142, v142
    v_exp_f32 v143, v143
    s_waitcnt lgkmcnt(0)
    s_setprio 2
    v_exp_f32 v72, v72
    v_exp_f32 v73, v73
    v_smfmac_f32_32x32x32_bf16 v[56:71], v[24:27], v[136:143], v5
    ds_read_b128 v[24:27], v18 offset:15968
    v_exp_f32 v74, v74
    v_exp_f32 v75, v75
    v_exp_f32 v76, v76
    v_mfma_f32_32x32x4_2b_bf16 v[112:143], v[36:37], v[6:7], 0
    ds_read_b128 v[20:23], v18 offset:15360
    buffer_load_dwordx4 v1, s[4:7], s34 offen offset:1024 lds
    v_exp_f32 v77, v77
    v_exp_f32 v78, v78
    v_exp_f32 v79, v79
    v_exp_f32 v80, v80
    v_exp_f32 v81, v81
    v_exp_f32 v82, v82
    v_exp_f32 v83, v83
    v_exp_f32 v84, v84
    v_smfmac_f32_32x32x32_bf16 v[40:55], v[28:31], v[72:79], v5
    ds_read_b128 v[104:107], v16 offset:16576
    s_and_b32 s22, s16, 1
    s_lshr_b32 s23, s12, 1
    s_cmp_eq_u32 s22, s23
    s_cbranch_scc0 TC_76
    s_lshl_b32 s20, s13, 13
    s_add_u32 s21, s20, 92160
    s_add_u32 s20, s20, 65536
    s_cmp_lt_u32 s13, 2
    s_cselect_b32 s20, s20, s21
    s_add_u32 s20, s20, s53
    buffer_load_dword v144, v19, s[4:7], s20 offen
TC_76:
    v_exp_f32 v85, v85
    v_exp_f32 v86, v86
    v_exp_f32 v87, v87
    v_exp_f32 v88, v88
    v_exp_f32 v89, v89
    v_smfmac_f32_32x32x32_bf16 v[40:55], v[32:35], v[80:87], v5
    ds_read_b32 v38, v17 offset:17600
    buffer_load_dwordx4 v[192:195], v1, s[4:7], s37 offen offset:3072
    s_add_u32 s37, s37, 4096
    v_exp_f32 v90, v90
    v_exp_f32 v91, v91
    v_exp_f32 v92, v92
    v_exp_f32 v93, v93
    v_mfma_f32_32x32x16_bf16 v[112:127], v[108:111], v[8:11], v[112:127]
    buffer_load_dwordx4 v[188:191], v1, s[4:7], s37 offen offset:0
    v_exp_f32 v94, v94
    v_exp_f32 v95, v95
    v_exp_f32 v96, v96
    v_exp_f32 v97, v97
    v_smfmac_f32_32x32x32_bf16 v[56:71], v[28:31], v[88:95], v5
    v_exp_f32 v98, v98
    v_exp_f32 v99, v99
    v_exp_f32 v100, v100
    v_mfma_f32_32x32x16_bf16 v[128:143], v[108:111], v[12:15], v[128:143]
    buffer_load_dwordx4 v[184:187], v1, s[4:7], s37 offen offset:1024
    v_exp_f32 v101, v101
    v_exp_f32 v102, v102
    v_exp_f32 v103, v103
    s_waitcnt lgkmcnt(0)
    v_exp_f32 v112, v112
    v_exp_f32 v113, v113
    v_smfmac_f32_32x32x32_bf16 v[56:71], v[32:35], v[96:103], v5
    ds_read_b128 v[32:35], v18 offset:18336
    v_exp_f32 v114, v114
    v_exp_f32 v115, v115
    v_exp_f32 v116, v116
    v_mfma_f32_32x32x4_2b_bf16 v[72:103], v[38:39], v[6:7], 0
    ds_read_b128 v[28:31], v18 offset:17728
    buffer_load_dwordx4 v1, s[4:7], s34 offen offset:2048 lds
    v_exp_f32 v117, v117
    v_exp_f32 v118, v118
    v_exp_f32 v119, v119
    v_exp_f32 v120, v120
    v_exp_f32 v121, v121
    v_exp_f32 v122, v122
    v_exp_f32 v123, v123
    v_exp_f32 v124, v124
    v_smfmac_f32_32x32x32_bf16 v[40:55], v[20:23], v[112:119], v5
    ds_read_b128 v[108:111], v16 offset:18944
    v_exp_f32 v125, v125
    v_exp_f32 v126, v126
    v_exp_f32 v127, v127
    v_exp_f32 v128, v128
    v_exp_f32 v129, v129
    v_smfmac_f32_32x32x32_bf16 v[40:55], v[24:27], v[120:127], v5
    ds_read_b32 v36, v17 offset:19968
    buffer_load_dwordx4 v[180:183], v1, s[4:7], s37 offen offset:2048
    v_exp_f32 v130, v130
    v_exp_f32 v131, v131
    v_exp_f32 v132, v132
    v_exp_f32 v133, v133
    v_mfma_f32_32x32x16_bf16 v[72:87], v[104:107], v[8:11], v[72:87]
    buffer_load_dwordx4 v[176:179], v1, s[4:7], s37 offen offset:3072
    s_add_u32 s37, s37, 4096
    v_exp_f32 v134, v134
    v_exp_f32 v135, v135
    v_exp_f32 v136, v136
    v_exp_f32 v137, v137
    v_smfmac_f32_32x32x32_bf16 v[56:71], v[20:23], v[128:135], v5
    v_exp_f32 v138, v138
    v_exp_f32 v139, v139
    v_exp_f32 v140, v140
    v_mfma_f32_32x32x16_bf16 v[88:103], v[104:107], v[12:15], v[88:103]
    buffer_load_dwordx4 v[172:175], v1, s[4:7], s37 offen offset:0
    v_exp_f32 v141, v141
    v_exp_f32 v142, v142
    v_exp_f32 v143, v143
    s_waitcnt lgkmcnt(0)
    v_exp_f32 v72, v72
    v_exp_f32 v73, v73
    v_smfmac_f32_32x32x32_bf16 v[56:71], v[24:27], v[136:143], v5
    ds_read_b128 v[24:27], v18 offset:20704
    v_exp_f32 v74, v74
    v_exp_f32 v75, v75
    v_exp_f32 v76, v76
    v_mfma_f32_32x32x4_2b_bf16 v[112:143], v[36:37], v[6:7], 0
    ds_read_b128 v[20:23], v18 offset:20096
    buffer_load_dwordx4 v1, s[4:7], s34 offen offset:3072 lds
    v_exp_f32 v77, v77
    v_exp_f32 v78, v78
    v_exp_f32 v79, v79
    v_exp_f32 v80, v80
    v_exp_f32 v81, v81
    v_exp_f32 v82, v82
    v_exp_f32 v83, v83
    v_exp_f32 v84, v84
    v_smfmac_f32_32x32x32_bf16 v[40:55], v[28:31], v[72:79], v5
    ds_read_b128 v[104:107], v16 offset:21312
    v_exp_f32 v85, v85
    v_exp_f32 v86, v86
    v_exp_f32 v87, v87
    v_exp_f32 v88, v88
    v_exp_f32 v89, v89
    v_smfmac_f32_32x32x32_bf16 v[40:55], v[32:35], v[80:87], v5
    ds_read_b32 v38, v17 offset:22336
    buffer_load_dwordx4 v[168:171], v1, s[4:7], s37 offen offset:1024
    v_exp_f32 v90, v90
    v_exp_f32 v91, v91
    v_exp_f32 v92, v92
    v_exp_f32 v93, v93
    v_mfma_f32_32x32x16_bf16 v[112:127], v[108:111], v[8:11], v[112:127]
    buffer_load_dwordx4 v[164:167], v1, s[4:7], s37 offen offset:2048
    v_exp_f32 v94, v94
    v_exp_f32 v95, v95
    v_exp_f32 v96, v96
    v_exp_f32 v97, v97
    v_smfmac_f32_32x32x32_bf16 v[56:71], v[28:31], v[88:95], v5
    v_exp_f32 v98, v98
    v_exp_f32 v99, v99
    v_exp_f32 v100, v100
    v_mfma_f32_32x32x16_bf16 v[128:143], v[108:111], v[12:15], v[128:143]
    buffer_load_dwordx4 v[160:163], v1, s[4:7], s37 offen offset:3072
    s_add_u32 s37, s37, 4096
    v_exp_f32 v101, v101
    v_exp_f32 v102, v102
    v_exp_f32 v103, v103
    s_waitcnt lgkmcnt(0)
    v_exp_f32 v112, v112
    v_exp_f32 v113, v113
    v_smfmac_f32_32x32x32_bf16 v[56:71], v[32:35], v[96:103], v5
    ds_read_b128 v[32:35], v18 offset:23072
    v_exp_f32 v114, v114
    v_exp_f32 v115, v115
    v_exp_f32 v116, v116
    v_mfma_f32_32x32x4_2b_bf16 v[72:103], v[38:39], v[6:7], 0
    ds_read_b128 v[28:31], v18 offset:22464
    s_add_u32 s35, s35, 4096
    s_add_u32 s34, s34, 4096
    s_mov_b32 m0, s35
    s_nop 0
    buffer_load_dwordx4 v1, s[4:7], s34 offen offset:0 lds
    v_exp_f32 v117, v117
    v_exp_f32 v118, v118
    v_exp_f32 v119, v119
    v_exp_f32 v120, v120
    v_exp_f32 v121, v121
    v_exp_f32 v122, v122
    v_exp_f32 v123, v123
    v_exp_f32 v124, v124
    v_smfmac_f32_32x32x32_bf16 v[40:55], v[20:23], v[112:119], v5
    ds_read_b128 v[108:111], v16 offset:23680
    v_exp_f32 v125, v125
    v_exp_f32 v126, v126
    v_exp_f32 v127, v127
    v_exp_f32 v128, v128
    v_exp_f32 v129, v129
    v_smfmac_f32_32x32x32_bf16 v[40:55], v[24:27], v[120:127], v5
    ds_read_b32 v36, v17 offset:24704
    buffer_load_dwordx4 v[156:159], v1, s[4:7], s37 offen offset:0
    v_exp_f32 v130, v130
    v_exp_f32 v131, v131
    v_exp_f32 v132, v132
    v_exp_f32 v133, v133
    v_mfma_f32_32x32x16_bf16 v[72:87], v[104:107], v[8:11], v[72:87]
    buffer_load_dwordx4 v[152:155], v1, s[4:7], s37 offen offset:1024
    v_exp_f32 v134, v134
    v_exp_f32 v135, v135
    v_exp_f32 v136, v136
    v_exp_f32 v137, v137
    v_smfmac_f32_32x32x32_bf16 v[56:71], v[20:23], v[128:135], v5
    v_exp_f32 v138, v138
    v_exp_f32 v139, v139
    v_exp_f32 v140, v140
    v_mfma_f32_32x32x16_bf16 v[88:103], v[104:107], v[12:15], v[88:103]
    buffer_load_dwordx4 v[148:151], v1, s[4:7], s37 offen offset:2048
    v_exp_f32 v141, v141
    v_exp_f32 v142, v142
    v_exp_f32 v143, v143
    s_waitcnt lgkmcnt(0)
    s_setprio 1
    v_exp_f32 v72, v72
    v_exp_f32 v73, v73
    v_smfmac_f32_32x32x32_bf16 v[56:71], v[24:27], v[136:143], v5
    ds_read_b128 v[24:27], v18 offset:25440
    v_exp_f32 v74, v74
    v_exp_f32 v75, v75
    v_exp_f32 v76, v76
    v_mfma_f32_32x32x4_2b_bf16 v[112:143], v[36:37], v[6:7], 0
    ds_read_b128 v[20:23], v18 offset:24832
    buffer_load_dwordx4 v1, s[4:7], s34 offen offset:1024 lds
    v_exp_f32 v77, v77
    v_exp_f32 v78, v78
    v_exp_f32 v79, v79
    v_exp_f32 v80, v80
    v_exp_f32 v81, v81
    v_exp_f32 v82, v82
    v_exp_f32 v83, v83
    v_exp_f32 v84, v84
    v_smfmac_f32_32x32x32_bf16 v[40:55], v[28:31], v[72:79], v5
    ds_read_b128 v[104:107], v16 offset:26048
    v_exp_f32 v85, v85
    v_exp_f32 v86, v86
    v_exp_f32 v87, v87
    v_exp_f32 v88, v88
    v_exp_f32 v89, v89
    v_smfmac_f32_32x32x32_bf16 v[40:55], v[32:35], v[80:87], v5
    ds_read_b32 v38, v17 offset:27072
    buffer_load_dwordx4 v[144:147], v1, s[4:7], s37 offen offset:3072
    s_add_u32 s37, s37, 4096
    v_exp_f32 v90, v90
    v_exp_f32 v91, v91
    v_exp_f32 v92, v92
    v_exp_f32 v93, v93
    v_mfma_f32_32x32x16_bf16 v[112:127], v[108:111], v[8:11], v[112:127]
    v_exp_f32 v94, v94
    v_exp_f32 v95, v95
    v_exp_f32 v96, v96
    v_exp_f32 v97, v97
    v_smfmac_f32_32x32x32_bf16 v[56:71], v[28:31], v[88:95], v5
    v_exp_f32 v98, v98
    v_exp_f32 v99, v99
    v_exp_f32 v100, v100
    v_mfma_f32_32x32x16_bf16 v[128:143], v[108:111], v[12:15], v[128:143]
    v_exp_f32 v101, v101
    v_exp_f32 v102, v102
    v_exp_f32 v103, v103
    s_waitcnt lgkmcnt(0)
    v_exp_f32 v112, v112
    v_exp_f32 v113, v113
    v_smfmac_f32_32x32x32_bf16 v[56:71], v[32:35], v[96:103], v5
    ds_read_b128 v[32:35], v18 offset:27808
    v_exp_f32 v114, v114
    v_exp_f32 v115, v115
    v_exp_f32 v116, v116
    v_mfma_f32_32x32x4_2b_bf16 v[72:103], v[38:39], v[6:7], 0
    ds_read_b128 v[28:31], v18 offset:27200
    v_exp_f32 v117, v117
    v_exp_f32 v118, v118
    v_exp_f32 v119, v119
    v_exp_f32 v120, v120
    v_exp_f32 v121, v121
    v_exp_f32 v122, v122
    v_exp_f32 v123, v123
    v_exp_f32 v124, v124
    v_smfmac_f32_32x32x32_bf16 v[40:55], v[20:23], v[112:119], v5
    ds_read_b128 v[108:111], v16 offset:28416
    v_exp_f32 v125, v125
    v_exp_f32 v126, v126
    v_exp_f32 v127, v127
    v_exp_f32 v128, v128
    v_exp_f32 v129, v129
    v_smfmac_f32_32x32x32_bf16 v[40:55], v[24:27], v[120:127], v5
    ds_read_b32 v36, v17 offset:29440
    v_exp_f32 v130, v130
    v_exp_f32 v131, v131
    v_exp_f32 v132, v132
    v_exp_f32 v133, v133
    v_mfma_f32_32x32x16_bf16 v[72:87], v[104:107], v[8:11], v[72:87]
    v_exp_f32 v134, v134
    v_exp_f32 v135, v135
    v_exp_f32 v136, v136
    v_exp_f32 v137, v137
    v_smfmac_f32_32x32x32_bf16 v[56:71], v[20:23], v[128:135], v5
    v_exp_f32 v138, v138
    v_exp_f32 v139, v139
    v_exp_f32 v140, v140
    v_mfma_f32_32x32x16_bf16 v[88:103], v[104:107], v[12:15], v[88:103]
    s_lshl_b32 s56, s15, 2
    s_add_u32 s56, s56, s13
    s_mul_i32 s56, s56, 36864
    s_add_u32 s56, s56, 776192
    s_and_b32 s57, s15, 1
    s_add_u32 s57, s57, 16
    s_lshl_b32 s57, s57, 2
    s_add_u32 s57, s57, s13
    s_mul_i32 s57, s57, 9216
    s_add_u32 s57, s57, 741376
    s_lshl_b32 s58, s15, 2
    s_add_u32 s58, s58, s13
    s_lshl_b32 s58, s58, 11
    s_add_u32 s58, s58, s48
    s_add_u32 s58, s58, s40
    s_add_u32 s58, s58, 0
    s_and_b32 s59, s15, 1
    s_add_u32 s59, s59, 16
    s_lshl_b32 s59, s59, 1
    s_lshr_b32 s21, s13, 1
    s_add_u32 s59, s59, s21
    s_lshl_b32 s59, s59, 10
    s_and_b32 s21, s13, 1
    s_lshl_b32 s21, s21, 3
    s_add_u32 s59, s59, s21
    s_add_u32 s59, s59, s48
    s_add_u32 s59, s59, s40
    s_add_u32 s59, s59, 0
    s_cmp_eq_u32 s19, 0
    s_cselect_b32 s56, s56, s57
    s_cselect_b32 s30, s58, s59
    s_add_u32 s58, s58, 1024
    s_sub_u32 s57, s57, 1024
    s_cmp_eq_u32 s19, 0
    s_cselect_b32 s58, s58, s57
    s_mov_b32 s57, 1024
    s_cselect_b32 s57, -1024, s57
    v_exp_f32 v141, v141
    v_exp_f32 v142, v142
    v_exp_f32 v143, v143
    s_waitcnt lgkmcnt(0)
    s_setprio 0
    v_exp_f32 v72, v72
    v_exp_f32 v73, v73
    v_smfmac_f32_32x32x32_bf16 v[56:71], v[24:27], v[136:143], v5
    ds_read_b128 v[24:27], v18 offset:30176
    v_exp_f32 v74, v74
    v_exp_f32 v75, v75
    v_exp_f32 v76, v76
    v_mfma_f32_32x32x4_2b_bf16 v[112:143], v[36:37], v[6:7], 0
    ds_read_b128 v[20:23], v18 offset:29568
    v_exp_f32 v77, v77
    v_exp_f32 v78, v78
    v_exp_f32 v79, v79
    v_exp_f32 v80, v80
    v_exp_f32 v81, v81
    v_exp_f32 v82, v82
    v_exp_f32 v83, v83
    v_exp_f32 v84, v84
    v_smfmac_f32_32x32x32_bf16 v[40:55], v[28:31], v[72:79], v5
    ds_read_b128 v[104:107], v16 offset:30784
    v_exp_f32 v85, v85
    v_exp_f32 v86, v86
    v_exp_f32 v87, v87
    v_exp_f32 v88, v88
    v_exp_f32 v89, v89
    v_smfmac_f32_32x32x32_bf16 v[40:55], v[32:35], v[80:87], v5
    ds_read_b32 v38, v17 offset:31808
    v_exp_f32 v90, v90
    v_exp_f32 v91, v91
    v_exp_f32 v92, v92
    v_exp_f32 v93, v93
    v_mfma_f32_32x32x16_bf16 v[112:127], v[108:111], v[8:11], v[112:127]
    v_exp_f32 v94, v94
    v_exp_f32 v95, v95
    v_exp_f32 v96, v96
    v_exp_f32 v97, v97
    v_smfmac_f32_32x32x32_bf16 v[56:71], v[28:31], v[88:95], v5
    v_exp_f32 v98, v98
    v_exp_f32 v99, v99
    v_exp_f32 v100, v100
    v_mfma_f32_32x32x16_bf16 v[128:143], v[108:111], v[12:15], v[128:143]
    s_mov_b32 s23, 136192
    s_mov_b32 s21, s12
    s_mul_i32 s22, s21, 3072
    s_cmp_lt_u32 s21, 5
    s_cselect_b32 s21, 108544, s23
    s_add_u32 s24, s21, s22
    s_xor_b32 s21, s12, 4
    s_mul_i32 s22, s21, 3072
    s_cmp_lt_u32 s21, 5
    s_cselect_b32 s21, 108544, s23
    s_add_u32 s25, s21, s22
    s_lshl_b32 s27, s15, 3
    s_lshl_b32 s20, s13, 1
    s_add_u32 s27, s27, s20
    s_add_u32 s27, s27, s19
    s_add_u32 s28, s45, s48
    s_lshl_b32 s33, s14, 7
    s_add_u32 s33, s33, 4096
    s_lshl_b32 s29, s15, 3
    s_add_u32 s29, s29, s12
    s_add_u32 s29, s29, s33
    s_lshl_b32 s20, s27, 10
    s_add_u32 s20, s20, s28
    s_lshr_b32 s21, s27, 3
    s_add_u32 s21, s21, 32
    s_lshl_b32 s21, s21, 10
    s_add_u32 s21, s21, s28
    s_bfe_u32 s22, s27, 0x10002
    s_lshl_b32 s22, s22, 9
    s_add_u32 s21, s21, s22
    s_and_b32 s22, s27, 3
    s_lshl_b32 s22, s22, 2
    s_add_u32 s28, s21, s22
    s_mov_b32 s27, s20
    v_exp_f32 v101, v101
    v_exp_f32 v102, v102
    v_exp_f32 v103, v103
    s_waitcnt lgkmcnt(0)
    s_barrier
    s_setprio 3
    v_exp_f32 v112, v112
    v_exp_f32 v113, v113
    v_smfmac_f32_32x32x32_bf16 v[56:71], v[32:35], v[96:103], v5
    ds_read_b128 v[32:35], v18 offset:32544
    s_lshl_b32 s35, s12, 2
    s_min_u32 s35, s35, 23
    s_add_u32 s35, s35, 37
    s_lshl_b32 s35, s35, 10
    s_add_u32 s34, s35, s53
    v_exp_f32 v114, v114
    v_exp_f32 v115, v115
    v_exp_f32 v116, v116
    v_mfma_f32_32x32x4_2b_bf16 v[72:103], v[38:39], v[6:7], 0
    ds_read_b128 v[28:31], v18 offset:31936
    s_mov_b32 m0, s35
    s_nop 0
    buffer_load_dwordx4 v1, s[4:7], s34 offen offset:0 lds
    v_exp_f32 v117, v117
    v_exp_f32 v118, v118
    v_exp_f32 v119, v119
    v_exp_f32 v120, v120
    v_exp_f32 v121, v121
    v_exp_f32 v122, v122
    v_exp_f32 v123, v123
    v_exp_f32 v124, v124
    v_smfmac_f32_32x32x32_bf16 v[40:55], v[20:23], v[112:119], v5
    ds_read_b128 v[108:111], v16 offset:33152
    v_exp_f32 v125, v125
    v_exp_f32 v126, v126
    v_exp_f32 v127, v127
    v_exp_f32 v128, v128
    v_exp_f32 v129, v129
    v_smfmac_f32_32x32x32_bf16 v[40:55], v[24:27], v[120:127], v5
    ds_read_b32 v36, v17 offset:34176
    buffer_load_dwordx4 v1, s[4:7], s34 offen offset:1024 lds
    v_exp_f32 v130, v130
    v_exp_f32 v131, v131
    v_exp_f32 v132, v132
    v_exp_f32 v133, v133
    v_mfma_f32_32x32x16_bf16 v[72:87], v[104:107], v[8:11], v[72:87]
    v_exp_f32 v134, v134
    v_exp_f32 v135, v135
    v_exp_f32 v136, v136
    v_exp_f32 v137, v137
    v_smfmac_f32_32x32x32_bf16 v[56:71], v[20:23], v[128:135], v5
    v_exp_f32 v138, v138
    v_exp_f32 v139, v139
    v_exp_f32 v140, v140
    v_mfma_f32_32x32x16_bf16 v[88:103], v[104:107], v[12:15], v[88:103]
    v_exp_f32 v141, v141
    v_exp_f32 v142, v142
    v_exp_f32 v143, v143
    s_waitcnt lgkmcnt(0)
    s_setprio 2
    v_exp_f32 v72, v72
    v_exp_f32 v73, v73
    v_smfmac_f32_32x32x32_bf16 v[56:71], v[24:27], v[136:143], v5
    ds_read_b128 v[24:27], v18 offset:34912
    v_exp_f32 v74, v74
    v_exp_f32 v75, v75
    v_exp_f32 v76, v76
    v_mfma_f32_32x32x4_2b_bf16 v[112:143], v[36:37], v[6:7], 0
    ds_read_b128 v[20:23], v18 offset:34304
    buffer_load_dwordx4 v1, s[4:7], s34 offen offset:2048 lds
    v_exp_f32 v77, v77
    v_exp_f32 v78, v78
    v_exp_f32 v79, v79
    v_exp_f32 v80, v80
    v_exp_f32 v81, v81
    v_exp_f32 v82, v82
    v_exp_f32 v83, v83
    v_exp_f32 v84, v84
    v_smfmac_f32_32x32x32_bf16 v[40:55], v[28:31], v[72:79], v5
    ds_read_b128 v[104:107], v16 offset:35520
    v_exp_f32 v85, v85
    v_exp_f32 v86, v86
    v_exp_f32 v87, v87
    v_exp_f32 v88, v88
    v_exp_f32 v89, v89
    v_smfmac_f32_32x32x32_bf16 v[40:55], v[32:35], v[80:87], v5
    ds_read_b32 v38, v17 offset:36544
    buffer_load_dwordx4 v1, s[4:7], s34 offen offset:3072 lds
    v_exp_f32 v90, v90
    v_exp_f32 v91, v91
    v_exp_f32 v92, v92
    v_exp_f32 v93, v93
    v_mfma_f32_32x32x16_bf16 v[112:127], v[108:111], v[8:11], v[112:127]
    v_exp_f32 v94, v94
    v_exp_f32 v95, v95
    v_exp_f32 v96, v96
    v_exp_f32 v97, v97
    v_smfmac_f32_32x32x32_bf16 v[56:71], v[28:31], v[88:95], v5
    v_exp_f32 v98, v98
    v_exp_f32 v99, v99
    v_exp_f32 v100, v100
    v_mfma_f32_32x32x16_bf16 v[128:143], v[108:111], v[12:15], v[128:143]
    v_exp_f32 v101, v101
    v_exp_f32 v102, v102
    v_exp_f32 v103, v103
    s_waitcnt lgkmcnt(0)
    s_setprio 1
    v_exp_f32 v112, v112
    v_exp_f32 v113, v113
    v_smfmac_f32_32x32x32_bf16 v[56:71], v[32:35], v[96:103], v5
    ds_read_b128 v[32:35], v18 offset:37280
    v_exp_f32 v114, v114
    v_exp_f32 v115, v115
    v_exp_f32 v116, v116
    v_mfma_f32_32x32x4_2b_bf16 v[72:103], v[38:39], v[6:7], 0
    ds_read_b128 v[28:31], v18 offset:36672
    buffer_load_dwordx4 v[108:111], v1, s[4:7], s58 offen sc1
    v_exp_f32 v117, v117
    v_exp_f32 v118, v118
    v_exp_f32 v119, v119
    v_exp_f32 v120, v120
    v_exp_f32 v121, v121
    v_exp_f32 v122, v122
    v_exp_f32 v123, v123
    v_exp_f32 v124, v124
    v_smfmac_f32_32x32x32_bf16 v[40:55], v[20:23], v[112:119], v5
    buffer_load_dwordx4 v[112:115], v1, s[4:7], s56 offen
    s_add_u32 s56, s56, s57
    buffer_load_dwordx4 v[116:119], v1, s[4:7], s56 offen
    s_add_u32 s56, s56, s57
    v_exp_f32 v125, v125
    v_exp_f32 v126, v126
    v_exp_f32 v127, v127
    v_exp_f32 v128, v128
    v_exp_f32 v129, v129
    v_smfmac_f32_32x32x32_bf16 v[40:55], v[24:27], v[120:127], v5
    buffer_load_dwordx4 v[120:123], v1, s[4:7], s56 offen
    s_add_u32 s56, s56, s57
    buffer_load_dwordx4 v[124:127], v1, s[4:7], s56 offen
    s_add_u32 s56, s56, s57
    v_exp_f32 v130, v130
    v_exp_f32 v131, v131
    v_exp_f32 v132, v132
    v_exp_f32 v133, v133
    v_mfma_f32_32x32x16_bf16 v[72:87], v[104:107], v[8:11], v[72:87]
    v_exp_f32 v134, v134
    v_exp_f32 v135, v135
    v_exp_f32 v136, v136
    v_exp_f32 v137, v137
    v_smfmac_f32_32x32x32_bf16 v[56:71], v[20:23], v[128:135], v5
    buffer_load_dwordx4 v[128:131], v1, s[4:7], s56 offen
    s_add_u32 s56, s56, s57
    buffer_load_dwordx4 v[132:135], v1, s[4:7], s56 offen
    s_add_u32 s56, s56, s57
    v_exp_f32 v138, v138
    v_exp_f32 v139, v139
    v_exp_f32 v140, v140
    v_mfma_f32_32x32x16_bf16 v[88:103], v[104:107], v[12:15], v[88:103]
    v_exp_f32 v141, v141
    v_exp_f32 v142, v142
    v_exp_f32 v143, v143
    s_waitcnt lgkmcnt(0)
    s_setprio 0
    v_exp_f32 v72, v72
    v_exp_f32 v73, v73
    v_smfmac_f32_32x32x32_bf16 v[56:71], v[24:27], v[136:143], v5
    buffer_load_dwordx4 v[136:139], v1, s[4:7], s56 offen
    s_add_u32 s56, s56, s57
    buffer_load_dwordx4 v[140:143], v1, s[4:7], s56 offen
    s_add_u32 s56, s56, s57
    v_exp_f32 v74, v74
    v_exp_f32 v75, v75
    v_exp_f32 v76, v76
    buffer_load_dwordx4 v[104:107], v1, s[4:7], s30 offen sc1
    v_exp_f32 v77, v77
    v_exp_f32 v78, v78
    v_exp_f32 v79, v79
    v_exp_f32 v80, v80
    v_exp_f32 v81, v81
    v_exp_f32 v82, v82
    v_exp_f32 v83, v83
    v_exp_f32 v84, v84
    v_smfmac_f32_32x32x32_bf16 v[40:55], v[28:31], v[72:79], v5
    v_exp_f32 v85, v85
    v_exp_f32 v86, v86
    v_exp_f32 v87, v87
    v_exp_f32 v88, v88
    v_exp_f32 v89, v89
    v_smfmac_f32_32x32x32_bf16 v[40:55], v[32:35], v[80:87], v5
    v_exp_f32 v90, v90
    v_exp_f32 v91, v91
    v_exp_f32 v92, v92
    v_exp_f32 v93, v93
    v_exp_f32 v94, v94
    v_exp_f32 v95, v95
    v_exp_f32 v96, v96
    v_exp_f32 v97, v97
    v_smfmac_f32_32x32x32_bf16 v[56:71], v[28:31], v[88:95], v5
    v_exp_f32 v98, v98
    v_exp_f32 v99, v99
    v_exp_f32 v100, v100
    v_exp_f32 v101, v101
    v_exp_f32 v102, v102
    v_exp_f32 v103, v103
    s_nop 1
    v_smfmac_f32_32x32x32_bf16 v[56:71], v[32:35], v[96:103], v5
    v_add_u32 v16, s24, v1
    v_add_u32 v17, s25, v1
    s_cmp_eq_u32 s19, 0
    s_cbranch_scc1 AA_R0
    ds_write_b128 v16, v[40:43] offset:0
    ds_write_b128 v16, v[44:47] offset:1024
    ds_write_b128 v16, v[48:51] offset:2048
    s_waitcnt lgkmcnt(0)
    s_barrier
    ds_read_b128 v[72:75], v17 offset:0
    ds_read_b128 v[76:79], v17 offset:1024
    ds_read_b128 v[80:83], v17 offset:2048
    s_waitcnt lgkmcnt(2)
    v_add_f32 v84, v56, v72
    v_add_f32 v85, v57, v73
    v_add_f32 v86, v58, v74
    v_add_f32 v87, v59, v75
    s_waitcnt lgkmcnt(1)
    v_add_f32 v88, v60, v76
    v_add_f32 v89, v61, v77
    v_add_f32 v90, v62, v78
    v_add_f32 v91, v63, v79
    s_waitcnt lgkmcnt(0)
    v_add_f32 v92, v64, v80
    v_add_f32 v93, v65, v81
    v_add_f32 v94, v66, v82
    s_branch AA_R1
AA_R0:
    s_nop 7
    ds_write_b128 v16, v[56:59] offset:0
    ds_write_b128 v16, v[60:63] offset:1024
    ds_write_b128 v16, v[64:67] offset:2048
    s_waitcnt lgkmcnt(0)
    s_barrier
    ds_read_b128 v[72:75], v17 offset:0
    ds_read_b128 v[76:79], v17 offset:1024
    ds_read_b128 v[80:83], v17 offset:2048
    s_waitcnt lgkmcnt(2)
    v_add_f32 v84, v40, v72
    v_add_f32 v85, v41, v73
    v_add_f32 v86, v42, v74
    v_add_f32 v87, v43, v75
    s_waitcnt lgkmcnt(1)
    v_add_f32 v88, v44, v76
    v_add_f32 v89, v45, v77
    v_add_f32 v90, v46, v78
    v_add_f32 v91, v47, v79
    s_waitcnt lgkmcnt(0)
    v_add_f32 v92, v48, v80
    v_add_f32 v93, v49, v81
    v_add_f32 v94, v50, v82
AA_R1:
    v_rcp_f32 v82, v94
    s_nop 0
    v_pk_mul_f32 v[72:73], v[84:85], v[82:83] op_sel_hi:[1,0]
    v_pk_mul_f32 v[74:75], v[86:87], v[82:83] op_sel_hi:[1,0]
    v_pk_mul_f32 v[76:77], v[88:89], v[82:83] op_sel_hi:[1,0]
    v_pk_mul_f32 v[78:79], v[90:91], v[82:83] op_sel_hi:[1,0]
    v_pk_mul_f32 v[80:81], v[92:93], v[82:83] op_sel_hi:[1,0]
    v_cvt_pk_bf16_f32 v72, v72, v73
    v_cvt_pk_bf16_f32 v73, v74, v75
    v_cvt_pk_bf16_f32 v74, v76, v77
    v_cvt_pk_bf16_f32 v75, v78, v79
    v_cvt_pk_bf16_f32 v76, v80, v81
    s_cmp_eq_u32 s55, 0
    s_cbranch_scc1 LS_77
    buffer_store_dwordx4 v[72:75], v1, s[4:7], s27 offen
    s_mov_b32 exec_hi, 0
    buffer_store_dword v76, v1, s[4:7], s28 offen
    s_mov_b64 exec, -1
    s_branch LD_78
LS_77:
    buffer_store_dwordx4 v[72:75], v1, s[4:7], s27 offen sc1
    s_mov_b32 exec_hi, 0
    buffer_store_dword v76, v1, s[4:7], s28 offen sc1
    s_mov_b64 exec, -1
LD_78:
    v_max3_f32 v20, |v84|, |v85|, |v86|
    v_max3_f32 v21, |v87|, |v88|, |v89|
    v_max3_f32 v22, |v90|, |v91|, |v92|
    v_add_f32 v23, v84, v85
    v_add_f32 v24, v86, v87
    v_add_f32 v23, v23, v88
    v_add_f32 v24, v24, v89
    v_add_f32 v23, v23, v90
    v_add_f32 v24, v24, v91
    v_add_f32 v23, v23, v92
    v_add_f32 v24, v24, v93
    v_max3_f32 v20, v20, v21, v22
    v_max_f32 v20, v20, |v93|
    v_mov_b32 v21, 0x7f000000
    v_mov_b32 v22, 0x5f800000
    v_cmp_lt_f32 s[20:21], v20, v21
    v_cmp_o_f32 s[22:23], v23, v24
    v_cmp_le_f32 s[24:25], v94, v22
    v_cmp_le_f32 vcc, 0x21800000, v94
    s_and_b64 s[20:21], s[20:21], s[22:23]
    s_and_b64 s[24:25], s[24:25], vcc
    s_and_b64 s[20:21], s[20:21], s[24:25]
    s_cmp_eq_u64 s[20:21], -1
    s_cbranch_scc0 AA_BAD
AA_ST:
    v_mov_b32 v18, 162304
    s_waitcnt lgkmcnt(0)
    s_barrier
    ds_read_b32 v20, v18
    s_waitcnt lgkmcnt(0)
    v_readfirstlane_b32 s20, v20
    s_nop 0
    s_cmp_eq_u32 s20, 0
    s_cbranch_scc0 AA_SLOW
AA_DONE:
    v_mov_b32 v20, 1
    v_mov_b32 v21, s29
    s_waitcnt vmcnt(0)
    s_mov_b64 exec, 1
    s_cmp_eq_u32 s55, 0
    s_cbranch_scc1 LS_79
    buffer_store_byte v20, v21, s[4:7], s42 offen
    s_branch LD_80
LS_79:
    buffer_store_byte v20, v21, s[4:7], s42 offen sc1
LD_80:
    s_mov_b64 exec, -1
    s_cmp_eq_u32 s19, 0
    s_cbranch_scc1 OA_FULL
    s_setprio 2
    v_and_b32 v20, 7, v0
    v_lshlrev_b32 v20, 2, v20
    v_add_u32 v20, s33, v20
    s_mul_i32 s25, s13, 9216
    s_add_u32 s24, s45, s48
    s_add_u32 s24, s24, s25
    s_add_u32 s25, s25, 124928
    v_add_u32 v19, s25, v1
    v_mov_b32 v8, 0
    s_lshl_b32 s20, s13, 2
    s_add_u32 s20, s20, 163328
    v_mov_b32 v22, s20
    v_mov_b32 v23, 0
    ds_write_b32 v22, v23
    s_lshl_b32 s20, s13, 2
    s_add_u32 s20, s20, 163376
    v_mov_b32 v22, s20
    v_mov_b32 v23, 0
    ds_write_b32 v22, v23
    s_lshl_b32 s20, s13, 2
    s_add_u32 s20, s20, 163392
    v_mov_b32 v22, s20
    v_mov_b32 v23, 0
    ds_write_b32 v22, v23
    s_mov_b32 s38, 0
POLL_81:
    buffer_load_dword v21, v20, s[4:7], s42 offen sc1
    s_waitcnt vmcnt(0)
    v_cmp_ne_u32 vcc, 0x01010101, v21
    s_cbranch_vccz POLLD_82
    s_add_u32 s38, s38, 1
    s_cmp_lt_u32 s38, 200000
    s_cbranch_scc1 POLL_81
POLLD_82:
    s_mov_b32 m0, s25
    s_nop 0
    buffer_load_dwordx4 v1, s[4:7], s24 offen offset:0 sc1 lds
    buffer_load_dwordx4 v1, s[4:7], s24 offen offset:1024 sc1 lds
    buffer_load_dwordx4 v1, s[4:7], s24 offen offset:2048 sc1 lds
    buffer_load_dwordx4 v1, s[4:7], s24 offen offset:3072 sc1 lds
    s_add_u32 s24, s24, 4096
    s_add_u32 s25, s25, 4096
    s_mov_b32 m0, s25
    s_nop 0
    buffer_load_dwordx4 v1, s[4:7], s24 offen offset:0 sc1 lds
    buffer_load_dwordx4 v1, s[4:7], s24 offen offset:1024 sc1 lds
    buffer_load_dwordx4 v1, s[4:7], s24 offen offset:2048 sc1 lds
    buffer_load_dwordx4 v1, s[4:7], s24 offen offset:3072 sc1 lds
    s_add_u32 s24, s24, 4096
    s_add_u32 s25, s25, 4096
    s_mov_b32 m0, s25
    s_nop 0
    buffer_load_dwordx4 v1, s[4:7], s24 offen offset:0 sc1 lds
    s_waitcnt vmcnt(6) lgkmcnt(0)
    s_barrier
    s_cmp_lt_u32 s15, 2
    s_cbranch_scc1 OA_S2
    s_waitcnt vmcnt(0)
    s_barrier
    s_branch OA_S3
OA_S2:
    ds_read_b128 v[40:43], v19 offset:0
    ds_read_b128 v[44:47], v19 offset:1024
    ds_read_b128 v[48:51], v19 offset:2048
    s_waitcnt lgkmcnt(2)
    v_mfma_f32_32x32x16_bf16 v[24:39], v[108:111], v[40:43], 0
    s_waitcnt lgkmcnt(1)
    v_mfma_f32_32x32x16_bf16 v[24:39], v[112:115], v[44:47], v[24:39]
    s_waitcnt lgkmcnt(0)
    v_mfma_f32_32x32x16_bf16 v[24:39], v[116:119], v[48:51], v[24:39]
    s_waitcnt vmcnt(0)
    s_barrier
    ds_read_b128 v[52:55], v19 offset:3072
    ds_read_b128 v[56:59], v19 offset:4096
    ds_read_b128 v[60:63], v19 offset:5120
    ds_read_b128 v[64:67], v19 offset:6144
    ds_read_b128 v[68:71], v19 offset:7168
    ds_read_b128 v[72:75], v19 offset:8192
    s_waitcnt lgkmcnt(5)
    v_mfma_f32_32x32x16_bf16 v[24:39], v[120:123], v[52:55], v[24:39]
    s_waitcnt lgkmcnt(4)
    v_mfma_f32_32x32x16_bf16 v[24:39], v[124:127], v[56:59], v[24:39]
    s_waitcnt lgkmcnt(3)
    v_mfma_f32_32x32x16_bf16 v[24:39], v[128:131], v[60:63], v[24:39]
    s_waitcnt lgkmcnt(2)
    v_mfma_f32_32x32x16_bf16 v[24:39], v[132:135], v[64:67], v[24:39]
    s_waitcnt lgkmcnt(1)
    v_mfma_f32_32x32x16_bf16 v[24:39], v[136:139], v[68:71], v[24:39]
    s_waitcnt lgkmcnt(0)
    v_mfma_f32_32x32x16_bf16 v[24:39], v[140:143], v[72:75], v[24:39]
    v_lshlrev_b32 v8, 16, v104
    v_and_b32 v9, s50, v104
    v_lshlrev_b32 v10, 16, v105
    v_and_b32 v11, s50, v105
    s_lshl_b32 s20, s13, 12
    s_add_u32 s20, s20, 108544
    v_add_u32 v19, s20, v1
    s_nop 4
    ds_write_b128 v19, v[24:27] offset:0
    ds_write_b128 v19, v[28:31] offset:1024
    ds_write_b128 v19, v[32:35] offset:2048
    ds_write_b128 v19, v[36:39] offset:3072
    s_lshl_b32 s20, s13, 10
    s_add_u32 s20, s20, 108544
    v_add_u32 v19, s20, v1
    s_lshl_b32 s20, s13, 2
    s_add_u32 s20, s20, 163328
    v_mov_b32 v12, s20
    v_mov_b32 v13, 1
    s_waitcnt lgkmcnt(0)
    ds_write_b32 v12, v13
    v_mov_b32 v12, 163328
PS_83:
    ds_read_b128 v[14:17], v12
    s_waitcnt lgkmcnt(0)
    v_and_b32 v14, v14, v15
    v_and_b32 v16, v16, v17
    v_and_b32 v14, v14, v16
    v_cmp_eq_u32 vcc, 0, v14
    s_cbranch_vccnz PS_83
    ds_read_b128 v[24:27], v19 offset:0
    ds_read_b128 v[28:31], v19 offset:4096
    ds_read_b128 v[32:35], v19 offset:8192
    ds_read_b128 v[36:39], v19 offset:12288
    s_waitcnt lgkmcnt(2)
    v_add_f32 v24, v24, v28
    v_add_f32 v25, v25, v29
    v_add_f32 v26, v26, v30
    v_add_f32 v27, v27, v31
    s_waitcnt lgkmcnt(0)
    v_add_f32 v32, v32, v36
    v_add_f32 v33, v33, v37
    v_add_f32 v34, v34, v38
    v_add_f32 v35, v35, v39
    v_add_f32 v24, v24, v32
    v_add_f32 v25, v25, v33
    v_add_f32 v26, v26, v34
    v_add_f32 v27, v27, v35
    v_add_f32 v24, v24, v8
    v_add_f32 v25, v25, v9
    v_add_f32 v26, v26, v10
    v_add_f32 v27, v27, v11
    v_cvt_pk_bf16_f32 v12, v24, v25
    v_cvt_pk_bf16_f32 v13, v26, v27
    s_add_u32 s30, s30, 0
    s_cmp_eq_u32 s55, 0
    s_cbranch_scc1 LS_84
    buffer_store_dwordx2 v[12:13], v1, s[4:7], s30 offen
    s_branch LD_85
LS_84:
    buffer_store_dwordx2 v[12:13], v1, s[4:7], s30 offen sc1
LD_85:
    v_add_f32 v8, v24, v25
    v_add_f32 v10, v26, v27
    v_mul_f32 v9, v24, v24
    v_add_f32 v8, v8, v10
    v_fmac_f32 v9, v25, v25
    v_fmac_f32 v9, v26, v26
    v_fmac_f32 v9, v27, v27
    s_nop 1
    v_permlane32_swap_b32 v8, v9
    v_add_f32 v8, v8, v9
OA_S3:
    s_lshl_b32 s20, s15, 2
    s_add_u32 s20, s20, s13
    s_mul_i32 s20, s20, 36864
    s_add_u32 s20, s20, 1432576
    s_mov_b32 s21, s20
    buffer_load_dwordx4 v[140:143], v1, s[4:7], s21 offen offset:0
    buffer_load_dwordx4 v[136:139], v1, s[4:7], s21 offen offset:1024
    buffer_load_dwordx4 v[132:135], v1, s[4:7], s21 offen offset:2048
    buffer_load_dwordx4 v[128:131], v1, s[4:7], s21 offen offset:3072
    s_add_u32 s21, s21, 4096
    buffer_load_dwordx4 v[124:127], v1, s[4:7], s21 offen offset:0
    buffer_load_dwordx4 v[120:123], v1, s[4:7], s21 offen offset:1024
    buffer_load_dwordx4 v[116:119], v1, s[4:7], s21 offen offset:2048
    buffer_load_dwordx4 v[112:115], v1, s[4:7], s21 offen offset:3072
    s_setprio 0
    s_branch OA_PUB
OA_FULL:
    v_add_u32 v67, 124928, v1
    v_lshlrev_b32 v24, 16, v104
    v_and_b32 v25, s50, v104
    v_lshlrev_b32 v26, 16, v105
    v_and_b32 v27, s50, v105
    v_lshlrev_b32 v28, 16, v106
    v_and_b32 v29, s50, v106
    v_lshlrev_b32 v30, 16, v107
    v_and_b32 v31, s50, v107
    v_lshlrev_b32 v32, 16, v108
    v_and_b32 v33, s50, v108
    v_lshlrev_b32 v34, 16, v109
    v_and_b32 v35, s50, v109
    v_lshlrev_b32 v36, 16, v110
    v_and_b32 v37, s50, v110
    v_lshlrev_b32 v38, 16, v111
    v_and_b32 v39, s50, v111
    s_barrier
    ds_read_b128 v[40:43], v67 offset:0
    ds_read_b128 v[44:47], v67 offset:9216
    ds_read_b128 v[48:51], v67 offset:18432
    ds_read_b128 v[52:55], v67 offset:27648
    ds_read_b128 v[56:59], v67 offset:1024
    ds_read_b128 v[60:63], v67 offset:10240
    s_waitcnt lgkmcnt(5)
    v_mfma_f32_32x32x16_bf16 v[24:39], v[252:255], v[40:43], v[24:39]
    ds_read_b128 v[40:43], v67 offset:19456
    s_waitcnt lgkmcnt(5)
    v_mfma_f32_32x32x16_bf16 v[24:39], v[216:219], v[44:47], v[24:39]
    ds_read_b128 v[44:47], v67 offset:28672
    s_waitcnt lgkmcnt(5)
    v_mfma_f32_32x32x16_bf16 v[24:39], v[180:183], v[48:51], v[24:39]
    ds_read_b128 v[48:51], v67 offset:2048
    s_waitcnt lgkmcnt(5)
    v_mfma_f32_32x32x16_bf16 v[24:39], v[144:147], v[52:55], v[24:39]
    ds_read_b128 v[52:55], v67 offset:11264
    s_waitcnt lgkmcnt(5)
    v_mfma_f32_32x32x16_bf16 v[24:39], v[248:251], v[56:59], v[24:39]
    ds_read_b128 v[56:59], v67 offset:20480
    s_waitcnt lgkmcnt(5)
    v_mfma_f32_32x32x16_bf16 v[24:39], v[212:215], v[60:63], v[24:39]
    ds_read_b128 v[60:63], v67 offset:29696
    s_waitcnt lgkmcnt(5)
    v_mfma_f32_32x32x16_bf16 v[24:39], v[176:179], v[40:43], v[24:39]
    s_waitcnt lgkmcnt(4)
    v_mfma_f32_32x32x16_bf16 v[24:39], v[140:143], v[44:47], v[24:39]
    s_waitcnt lgkmcnt(3)
    v_mfma_f32_32x32x16_bf16 v[24:39], v[244:247], v[48:51], v[24:39]
    s_waitcnt lgkmcnt(2)
    v_mfma_f32_32x32x16_bf16 v[24:39], v[208:211], v[52:55], v[24:39]
    s_waitcnt lgkmcnt(1)
    v_mfma_f32_32x32x16_bf16 v[24:39], v[172:175], v[56:59], v[24:39]
    s_waitcnt lgkmcnt(0)
    v_mfma_f32_32x32x16_bf16 v[24:39], v[136:139], v[60:63], v[24:39]
    s_barrier
    ds_read_b128 v[40:43], v67 offset:3072
    ds_read_b128 v[44:47], v67 offset:12288
    ds_read_b128 v[48:51], v67 offset:21504
    ds_read_b128 v[52:55], v67 offset:30720
    ds_read_b128 v[56:59], v67 offset:4096
    ds_read_b128 v[60:63], v67 offset:13312
    s_waitcnt lgkmcnt(5)
    v_mfma_f32_32x32x16_bf16 v[24:39], v[240:243], v[40:43], v[24:39]
    s_mul_i32 s20, s13, 3
    s_add_u32 s20, s20, 64
    s_min_u32 s20, s20, 73
    s_lshl_b32 s20, s20, 10
    s_mov_b32 m0, s20
    s_add_u32 s20, s20, s53
    buffer_load_dwordx4 v1, s[4:7], s20 offen lds
    ds_read_b128 v[40:43], v67 offset:22528
    s_waitcnt lgkmcnt(5)
    v_mfma_f32_32x32x16_bf16 v[24:39], v[204:207], v[44:47], v[24:39]
    ds_read_b128 v[44:47], v67 offset:31744
    s_waitcnt lgkmcnt(5)
    v_mfma_f32_32x32x16_bf16 v[24:39], v[168:171], v[48:51], v[24:39]
    s_mul_i32 s20, s13, 3
    s_add_u32 s20, s20, 65
    s_min_u32 s20, s20, 73
    s_lshl_b32 s20, s20, 10
    s_mov_b32 m0, s20
    s_add_u32 s20, s20, s53
    buffer_load_dwordx4 v1, s[4:7], s20 offen lds
    ds_read_b128 v[48:51], v67 offset:5120
    s_waitcnt lgkmcnt(5)
    v_mfma_f32_32x32x16_bf16 v[24:39], v[132:135], v[52:55], v[24:39]
    ds_read_b128 v[52:55], v67 offset:14336
    s_waitcnt lgkmcnt(5)
    v_mfma_f32_32x32x16_bf16 v[24:39], v[236:239], v[56:59], v[24:39]
    s_mul_i32 s20, s13, 3
    s_add_u32 s20, s20, 66
    s_min_u32 s20, s20, 73
    s_lshl_b32 s20, s20, 10
    s_mov_b32 m0, s20
    s_add_u32 s20, s20, s53
    buffer_load_dwordx4 v1, s[4:7], s20 offen lds
    ds_read_b128 v[56:59], v67 offset:23552
    s_waitcnt lgkmcnt(5)
    v_mfma_f32_32x32x16_bf16 v[24:39], v[200:203], v[60:63], v[24:39]
    ds_read_b128 v[60:63], v67 offset:32768
    s_waitcnt lgkmcnt(5)
    v_mfma_f32_32x32x16_bf16 v[24:39], v[164:167], v[40:43], v[24:39]
    ds_read_b128 v[40:43], v67 offset:6144
    s_waitcnt lgkmcnt(5)
    v_mfma_f32_32x32x16_bf16 v[24:39], v[128:131], v[44:47], v[24:39]
    ds_read_b128 v[44:47], v67 offset:15360
    s_waitcnt lgkmcnt(5)
    v_mfma_f32_32x32x16_bf16 v[24:39], v[232:235], v[48:51], v[24:39]
    ds_read_b128 v[48:51], v67 offset:24576
    s_waitcnt lgkmcnt(5)
    v_mfma_f32_32x32x16_bf16 v[24:39], v[196:199], v[52:55], v[24:39]
    ds_read_b128 v[52:55], v67 offset:33792
    s_waitcnt lgkmcnt(5)
    v_mfma_f32_32x32x16_bf16 v[24:39], v[160:163], v[56:59], v[24:39]
    ds_read_b128 v[56:59], v67 offset:7168
    s_waitcnt lgkmcnt(5)
    v_mfma_f32_32x32x16_bf16 v[24:39], v[124:127], v[60:63], v[24:39]
    ds_read_b128 v[60:63], v67 offset:16384
    s_waitcnt lgkmcnt(5)
    v_mfma_f32_32x32x16_bf16 v[24:39], v[228:231], v[40:43], v[24:39]
    ds_read_b128 v[40:43], v67 offset:25600
    s_waitcnt lgkmcnt(5)
    v_mfma_f32_32x32x16_bf16 v[24:39], v[192:195], v[44:47], v[24:39]
    ds_read_b128 v[44:47], v67 offset:34816
    s_waitcnt lgkmcnt(5)
    v_mfma_f32_32x32x16_bf16 v[24:39], v[156:159], v[48:51], v[24:39]
    ds_read_b128 v[48:51], v67 offset:8192
    s_waitcnt lgkmcnt(5)
    v_mfma_f32_32x32x16_bf16 v[24:39], v[120:123], v[52:55], v[24:39]
    ds_read_b128 v[52:55], v67 offset:17408
    s_waitcnt lgkmcnt(5)
    v_mfma_f32_32x32x16_bf16 v[24:39], v[224:227], v[56:59], v[24:39]
    ds_read_b128 v[56:59], v67 offset:26624
    s_waitcnt lgkmcnt(5)
    v_mfma_f32_32x32x16_bf16 v[24:39], v[188:191], v[60:63], v[24:39]
    ds_read_b128 v[60:63], v67 offset:35840
    s_waitcnt lgkmcnt(5)
    v_mfma_f32_32x32x16_bf16 v[24:39], v[152:155], v[40:43], v[24:39]
    s_waitcnt lgkmcnt(4)
    v_mfma_f32_32x32x16_bf16 v[24:39], v[116:119], v[44:47], v[24:39]
    s_waitcnt lgkmcnt(3)
    v_mfma_f32_32x32x16_bf16 v[24:39], v[220:223], v[48:51], v[24:39]
    s_waitcnt lgkmcnt(2)
    v_mfma_f32_32x32x16_bf16 v[24:39], v[184:187], v[52:55], v[24:39]
    s_waitcnt lgkmcnt(1)
    v_mfma_f32_32x32x16_bf16 v[24:39], v[148:151], v[56:59], v[24:39]
    s_waitcnt lgkmcnt(0)
    v_mfma_f32_32x32x16_bf16 v[24:39], v[112:115], v[60:63], v[24:39]
    s_nop 11
    v_cvt_pk_bf16_f32 v16, v24, v25
    v_cvt_pk_bf16_f32 v17, v26, v27
    v_cvt_pk_bf16_f32 v18, v28, v29
    v_cvt_pk_bf16_f32 v19, v30, v31
    v_cvt_pk_bf16_f32 v20, v32, v33
    v_cvt_pk_bf16_f32 v21, v34, v35
    v_cvt_pk_bf16_f32 v22, v36, v37
    v_cvt_pk_bf16_f32 v23, v38, v39
    s_add_u32 s30, s30, 0
    s_cmp_eq_u32 s55, 0
    s_cbranch_scc1 LS_86
    buffer_store_dwordx4 v[16:19], v1, s[4:7], s30 offen
    buffer_store_dwordx4 v[20:23], v1, s[4:7], s30 offen offset:1024
    s_branch LD_87
LS_86:
    buffer_store_dwordx4 v[16:19], v1, s[4:7], s30 offen sc1
    buffer_store_dwordx4 v[20:23], v1, s[4:7], s30 offen offset:1024 sc1
LD_87:
    v_pk_add_f32 v[8:9], v[24:25], v[26:27]
    v_pk_mul_f32 v[10:11], v[24:25], v[24:25]
    v_pk_fma_f32 v[10:11], v[26:27], v[26:27], v[10:11]
    v_pk_add_f32 v[8:9], v[8:9], v[28:29]
    v_pk_fma_f32 v[10:11], v[28:29], v[28:29], v[10:11]
    v_pk_add_f32 v[8:9], v[8:9], v[30:31]
    v_pk_fma_f32 v[10:11], v[30:31], v[30:31], v[10:11]
    v_pk_add_f32 v[8:9], v[8:9], v[32:33]
    v_pk_fma_f32 v[10:11], v[32:33], v[32:33], v[10:11]
    v_pk_add_f32 v[8:9], v[8:9], v[34:35]
    v_pk_fma_f32 v[10:11], v[34:35], v[34:35], v[10:11]
    v_pk_add_f32 v[8:9], v[8:9], v[36:37]
    v_pk_fma_f32 v[10:11], v[36:37], v[36:37], v[10:11]
    v_pk_add_f32 v[8:9], v[8:9], v[38:39]
    v_pk_fma_f32 v[10:11], v[38:39], v[38:39], v[10:11]
    v_add_f32 v8, v8, v9
    v_add_f32 v9, v10, v11
    s_nop 1
    v_permlane32_swap_b32 v8, v9
    v_add_f32 v8, v8, v9
OA_PUB:
    s_lshl_b32 s20, s13, 8
    s_add_u32 s20, s20, 161792
    s_lshl_b32 s21, s13, 10
    s_add_u32 s21, s21, 108544
    s_cmp_eq_u32 s19, 0
    s_cselect_b32 s20, s20, s21
    v_lshlrev_b32 v10, 2, v0
    v_add_u32 v11, s20, v10
    ds_write_b32 v11, v8
    s_waitcnt lgkmcnt(0)
    s_barrier
    s_cmp_eq_u32 s12, 7
    s_cbranch_scc1 OA_PB
    s_waitcnt vmcnt(0)
    s_barrier
    s_branch OA_DONE
OA_PB:
    v_add_u32 v10, 108544, v10
    ds_read_b32 v16, v10 offset:53248
    ds_read_b32 v17, v10 offset:53504
    ds_read_b32 v18, v10 offset:53760
    ds_read_b32 v19, v10 offset:54016
    ds_read_b32 v20, v10 offset:0
    ds_read_b32 v21, v10 offset:1024
    ds_read_b32 v22, v10 offset:2048
    ds_read_b32 v23, v10 offset:3072
    s_lshl_b32 s20, s14, 10
    s_add_u32 s20, s20, s41
    s_add_u32 s20, s20, 65536
    s_lshl_b32 s21, s15, 3
    s_add_u32 s20, s20, s21
    v_lshlrev_b32 v11, 5, v2
    s_waitcnt lgkmcnt(0)
    v_add_f32 v16, v16, v17
    v_add_f32 v18, v18, v19
    v_add_f32 v20, v20, v21
    v_add_f32 v22, v22, v23
    v_add_f32 v16, v16, v18
    v_add_f32 v20, v20, v22
    v_add_f32 v16, v16, v20
    v_mov_b32 v17, v16
    s_nop 1
    v_permlane32_swap_b32 v16, v17
    v_or_b32 v17, 0x80000000, v17
    s_waitcnt vmcnt(0)
    s_barrier
    s_mov_b32 exec_hi, 0
    s_cmp_eq_u32 s55, 0
    s_cbranch_scc1 LS_88
    buffer_store_dwordx2 v[16:17], v11, s[4:7], s20 offen
    s_branch LD_89
LS_88:
    buffer_store_dwordx2 v[16:17], v11, s[4:7], s20 offen sc1
LD_89:
    s_mov_b64 exec, -1
OA_DONE:
    s_cmp_eq_u32 s19, 0
    s_cbranch_scc1 QB_C
    s_lshl_b32 s21, s13, 12
    s_add_u32 s21, s21, 108544
    s_add_u32 s20, s53, s21
    s_mov_b32 m0, s21
    s_nop 0
    buffer_load_dwordx4 v1, s[4:7], s20 offen offset:0  lds
    buffer_load_dwordx4 v1, s[4:7], s20 offen offset:1024  lds
    buffer_load_dwordx4 v1, s[4:7], s20 offen offset:2048  lds
    buffer_load_dwordx4 v1, s[4:7], s20 offen offset:3072  lds
    s_lshl_b32 s29, s16, 2
    s_add_u32 s29, s29, s13
    s_lshl_b32 s24, s17, 7
    s_add_u32 s24, s24, s29
    s_mul_i32 s24, s24, 2368
    s_add_u32 s24, s24, s47
    s_mul_i32 s28, s13, 2368
    s_add_u32 s28, s28, 18944
    v_lshrrev_b32 v10, 2, v0
    s_mov_b32 s20, 151552
    v_mul_lo_u32 v8, v10, s20
    v_and_b32 v9, 3, v0
    v_mul_u32_u24 v9, 304, v9
    v_add_u32 v8, v8, v9
    v_mul_u32_u24 v10, 28416, v10
    v_add3_u32 v10, v10, v9, s28
    v_mov_b32 v96, 0x3f803f80
    v_mov_b32 v97, 0x3f803f80
    v_mov_b32 v98, 0x3f803f80
    v_mov_b32 v99, 0x3f803f80
    s_mov_b64 exec, 0xff
    buffer_store_dwordx4 v[96:99], v8, s[4:7], s24 offen offset:1440 sc1
    s_mov_b64 exec, -1
    v_min_u32 v5, 11, v2
    v_lshlrev_b32 v5, 4, v5
    v_mul_u32_u24 v6, 192, v3
    v_add_u32 v5, v5, v6
    s_mul_i32 s22, s13, 36864
    s_cmp_eq_u32 s13, 3
    s_cselect_b32 s22, 88064, s22
    s_cmp_eq_u32 s13, 2
    s_cselect_b64 vcc, -1, 0
    s_mov_b32 s23, 1024
    s_cselect_b32 s23, 384, s23
    v_cndmask_b32 v5, v1, v5, vcc
    v_add_u32 v5, s22, v5
    v_mov_b32 v6, 0
    ds_read_b128 v[20:23], v5
    v_add_u32 v5, s23, v5
    ds_read_b128 v[24:27], v5
    v_add_u32 v5, s23, v5
    ds_read_b128 v[28:31], v5
    v_add_u32 v5, s23, v5
    ds_read_b128 v[32:35], v5
    v_add_u32 v5, s23, v5
    ds_read_b128 v[36:39], v5
    v_add_u32 v5, s23, v5
    ds_read_b128 v[40:43], v5
    v_add_u32 v5, s23, v5
    ds_read_b128 v[44:47], v5
    v_add_u32 v5, s23, v5
    ds_read_b128 v[48:51], v5
    v_add_u32 v5, s23, v5
    ds_read_b128 v[52:55], v5
    v_add_u32 v5, s23, v5
    ds_read_b128 v[56:59], v5
    v_add_u32 v5, s23, v5
    s_waitcnt lgkmcnt(9)
    v_dot2c_f32_bf16 v6, s98, v20
    v_dot2c_f32_bf16 v6, s98, v21
    v_dot2c_f32_bf16 v6, s98, v22
    v_dot2c_f32_bf16 v6, s98, v23
    s_waitcnt lgkmcnt(8)
    v_dot2c_f32_bf16 v6, s98, v24
    v_dot2c_f32_bf16 v6, s98, v25
    v_dot2c_f32_bf16 v6, s98, v26
    v_dot2c_f32_bf16 v6, s98, v27
    s_waitcnt lgkmcnt(7)
    v_dot2c_f32_bf16 v6, s98, v28
    v_dot2c_f32_bf16 v6, s98, v29
    v_dot2c_f32_bf16 v6, s98, v30
    v_dot2c_f32_bf16 v6, s98, v31
    s_waitcnt lgkmcnt(6)
    v_dot2c_f32_bf16 v6, s98, v32
    v_dot2c_f32_bf16 v6, s98, v33
    v_dot2c_f32_bf16 v6, s98, v34
    v_dot2c_f32_bf16 v6, s98, v35
    s_waitcnt lgkmcnt(5)
    v_dot2c_f32_bf16 v6, s98, v36
    v_dot2c_f32_bf16 v6, s98, v37
    v_dot2c_f32_bf16 v6, s98, v38
    v_dot2c_f32_bf16 v6, s98, v39
    s_waitcnt lgkmcnt(4)
    v_dot2c_f32_bf16 v6, s98, v40
    v_dot2c_f32_bf16 v6, s98, v41
    v_dot2c_f32_bf16 v6, s98, v42
    v_dot2c_f32_bf16 v6, s98, v43
    s_waitcnt lgkmcnt(3)
    v_dot2c_f32_bf16 v6, s98, v44
    v_dot2c_f32_bf16 v6, s98, v45
    v_dot2c_f32_bf16 v6, s98, v46
    v_dot2c_f32_bf16 v6, s98, v47
    s_waitcnt lgkmcnt(2)
    v_dot2c_f32_bf16 v6, s98, v48
    v_dot2c_f32_bf16 v6, s98, v49
    v_dot2c_f32_bf16 v6, s98, v50
    v_dot2c_f32_bf16 v6, s98, v51
    s_waitcnt lgkmcnt(1)
    v_dot2c_f32_bf16 v6, s98, v52
    v_dot2c_f32_bf16 v6, s98, v53
    v_dot2c_f32_bf16 v6, s98, v54
    v_dot2c_f32_bf16 v6, s98, v55
    s_waitcnt lgkmcnt(0)
    v_dot2c_f32_bf16 v6, s98, v56
    v_dot2c_f32_bf16 v6, s98, v57
    v_dot2c_f32_bf16 v6, s98, v58
    v_dot2c_f32_bf16 v6, s98, v59
    ds_read_b128 v[20:23], v5
    v_add_u32 v5, s23, v5
    ds_read_b128 v[24:27], v5
    v_add_u32 v5, s23, v5
    ds_read_b128 v[28:31], v5
    v_add_u32 v5, s23, v5
    ds_read_b128 v[32:35], v5
    v_add_u32 v5, s23, v5
    ds_read_b128 v[36:39], v5
    v_add_u32 v5, s23, v5
    ds_read_b128 v[40:43], v5
    v_add_u32 v5, s23, v5
    ds_read_b128 v[44:47], v5
    v_add_u32 v5, s23, v5
    ds_read_b128 v[48:51], v5
    v_add_u32 v5, s23, v5
    ds_read_b128 v[52:55], v5
    v_add_u32 v5, s23, v5
    ds_read_b128 v[56:59], v5
    v_add_u32 v5, s23, v5
    s_waitcnt lgkmcnt(9)
    v_dot2c_f32_bf16 v6, s98, v20
    v_dot2c_f32_bf16 v6, s98, v21
    v_dot2c_f32_bf16 v6, s98, v22
    v_dot2c_f32_bf16 v6, s98, v23
    s_waitcnt lgkmcnt(8)
    v_dot2c_f32_bf16 v6, s98, v24
    v_dot2c_f32_bf16 v6, s98, v25
    v_dot2c_f32_bf16 v6, s98, v26
    v_dot2c_f32_bf16 v6, s98, v27
    s_waitcnt lgkmcnt(7)
    v_dot2c_f32_bf16 v6, s98, v28
    v_dot2c_f32_bf16 v6, s98, v29
    v_dot2c_f32_bf16 v6, s98, v30
    v_dot2c_f32_bf16 v6, s98, v31
    s_waitcnt lgkmcnt(6)
    v_dot2c_f32_bf16 v6, s98, v32
    v_dot2c_f32_bf16 v6, s98, v33
    v_dot2c_f32_bf16 v6, s98, v34
    v_dot2c_f32_bf16 v6, s98, v35
    s_waitcnt lgkmcnt(5)
    v_dot2c_f32_bf16 v6, s98, v36
    v_dot2c_f32_bf16 v6, s98, v37
    v_dot2c_f32_bf16 v6, s98, v38
    v_dot2c_f32_bf16 v6, s98, v39
    s_waitcnt lgkmcnt(4)
    v_dot2c_f32_bf16 v6, s98, v40
    v_dot2c_f32_bf16 v6, s98, v41
    v_dot2c_f32_bf16 v6, s98, v42
    v_dot2c_f32_bf16 v6, s98, v43
    s_waitcnt lgkmcnt(3)
    v_dot2c_f32_bf16 v6, s98, v44
    v_dot2c_f32_bf16 v6, s98, v45
    v_dot2c_f32_bf16 v6, s98, v46
    v_dot2c_f32_bf16 v6, s98, v47
    s_waitcnt lgkmcnt(2)
    v_dot2c_f32_bf16 v6, s98, v48
    v_dot2c_f32_bf16 v6, s98, v49
    v_dot2c_f32_bf16 v6, s98, v50
    v_dot2c_f32_bf16 v6, s98, v51
    s_waitcnt lgkmcnt(1)
    v_dot2c_f32_bf16 v6, s98, v52
    v_dot2c_f32_bf16 v6, s98, v53
    v_dot2c_f32_bf16 v6, s98, v54
    v_dot2c_f32_bf16 v6, s98, v55
    s_waitcnt lgkmcnt(0)
    v_dot2c_f32_bf16 v6, s98, v56
    v_dot2c_f32_bf16 v6, s98, v57
    v_dot2c_f32_bf16 v6, s98, v58
    v_dot2c_f32_bf16 v6, s98, v59
    s_waitcnt vmcnt(1)
    s_lshl_b32 s20, s13, 2
    s_add_u32 s20, s20, 163376
    v_mov_b32 v12, s20
    v_mov_b32 v13, 1
    s_waitcnt lgkmcnt(0)
    ds_write_b32 v12, v13
    v_mov_b32 v12, 163376
PS_90:
    ds_read_b128 v[14:17], v12
    s_waitcnt lgkmcnt(0)
    v_and_b32 v14, v14, v15
    v_and_b32 v16, v16, v17
    v_and_b32 v14, v14, v16
    v_cmp_eq_u32 vcc, 0, v14
    s_cbranch_vccnz PS_90
    ds_read_b128 v[20:23], v5
    v_add_u32 v5, s23, v5
    ds_read_b128 v[24:27], v5
    v_add_u32 v5, s23, v5
    ds_read_b128 v[28:31], v5
    v_add_u32 v5, s23, v5
    ds_read_b128 v[32:35], v5
    v_add_u32 v5, s23, v5
    ds_read_b128 v[36:39], v5
    v_add_u32 v5, s23, v5
    ds_read_b128 v[40:43], v5
    v_add_u32 v5, s23, v5
    ds_read_b128 v[44:47], v5
    v_add_u32 v5, s23, v5
    ds_read_b128 v[48:51], v5
    v_add_u32 v5, s23, v5
    ds_read_b128 v[52:55], v5
    v_add_u32 v5, s23, v5
    ds_read_b128 v[56:59], v5
    v_add_u32 v5, s23, v5
    ds_read_b128 v[60:63], v5
    v_add_u32 v5, s23, v5
    ds_read_b128 v[64:67], v5
    v_add_u32 v5, s23, v5
    ds_read_b128 v[68:71], v5
    v_add_u32 v5, s23, v5
    ds_read_b128 v[72:75], v5
    v_add_u32 v5, s23, v5
    ds_read_b128 v[76:79], v5
    v_add_u32 v5, s23, v5
    ds_read_b128 v[80:83], v5
    v_add_u32 v5, s23, v5
    s_waitcnt lgkmcnt(15)
    v_dot2c_f32_bf16 v6, s98, v20
    v_dot2c_f32_bf16 v6, s98, v21
    v_dot2c_f32_bf16 v6, s98, v22
    v_dot2c_f32_bf16 v6, s98, v23
    s_waitcnt lgkmcnt(14)
    v_dot2c_f32_bf16 v6, s98, v24
    v_dot2c_f32_bf16 v6, s98, v25
    v_dot2c_f32_bf16 v6, s98, v26
    v_dot2c_f32_bf16 v6, s98, v27
    s_waitcnt lgkmcnt(13)
    v_dot2c_f32_bf16 v6, s98, v28
    v_dot2c_f32_bf16 v6, s98, v29
    v_dot2c_f32_bf16 v6, s98, v30
    v_dot2c_f32_bf16 v6, s98, v31
    s_waitcnt lgkmcnt(12)
    v_dot2c_f32_bf16 v6, s98, v32
    v_dot2c_f32_bf16 v6, s98, v33
    v_dot2c_f32_bf16 v6, s98, v34
    v_dot2c_f32_bf16 v6, s98, v35
    s_waitcnt lgkmcnt(11)
    v_dot2c_f32_bf16 v6, s98, v36
    v_dot2c_f32_bf16 v6, s98, v37
    v_dot2c_f32_bf16 v6, s98, v38
    v_dot2c_f32_bf16 v6, s98, v39
    s_waitcnt lgkmcnt(10)
    v_dot2c_f32_bf16 v6, s98, v40
    v_dot2c_f32_bf16 v6, s98, v41
    v_dot2c_f32_bf16 v6, s98, v42
    v_dot2c_f32_bf16 v6, s98, v43
    s_waitcnt lgkmcnt(9)
    v_dot2c_f32_bf16 v6, s98, v44
    v_dot2c_f32_bf16 v6, s98, v45
    v_dot2c_f32_bf16 v6, s98, v46
    v_dot2c_f32_bf16 v6, s98, v47
    s_waitcnt lgkmcnt(8)
    v_dot2c_f32_bf16 v6, s98, v48
    v_dot2c_f32_bf16 v6, s98, v49
    v_dot2c_f32_bf16 v6, s98, v50
    v_dot2c_f32_bf16 v6, s98, v51
    s_waitcnt lgkmcnt(7)
    v_dot2c_f32_bf16 v6, s98, v52
    v_dot2c_f32_bf16 v6, s98, v53
    v_dot2c_f32_bf16 v6, s98, v54
    v_dot2c_f32_bf16 v6, s98, v55
    s_waitcnt lgkmcnt(6)
    v_dot2c_f32_bf16 v6, s98, v56
    v_dot2c_f32_bf16 v6, s98, v57
    v_dot2c_f32_bf16 v6, s98, v58
    v_dot2c_f32_bf16 v6, s98, v59
    s_waitcnt lgkmcnt(5)
    v_dot2c_f32_bf16 v6, s98, v60
    v_dot2c_f32_bf16 v6, s98, v61
    v_dot2c_f32_bf16 v6, s98, v62
    v_dot2c_f32_bf16 v6, s98, v63
    s_waitcnt lgkmcnt(4)
    v_dot2c_f32_bf16 v6, s98, v64
    v_dot2c_f32_bf16 v6, s98, v65
    v_dot2c_f32_bf16 v6, s98, v66
    v_dot2c_f32_bf16 v6, s98, v67
    s_waitcnt lgkmcnt(3)
    v_dot2c_f32_bf16 v6, s98, v68
    v_dot2c_f32_bf16 v6, s98, v69
    v_dot2c_f32_bf16 v6, s98, v70
    v_dot2c_f32_bf16 v6, s98, v71
    s_waitcnt lgkmcnt(2)
    v_dot2c_f32_bf16 v6, s98, v72
    v_dot2c_f32_bf16 v6, s98, v73
    v_dot2c_f32_bf16 v6, s98, v74
    v_dot2c_f32_bf16 v6, s98, v75
    s_waitcnt lgkmcnt(1)
    v_dot2c_f32_bf16 v6, s98, v76
    v_dot2c_f32_bf16 v6, s98, v77
    v_dot2c_f32_bf16 v6, s98, v78
    v_dot2c_f32_bf16 v6, s98, v79
    s_waitcnt lgkmcnt(0)
    v_dot2c_f32_bf16 v6, s98, v80
    v_dot2c_f32_bf16 v6, s98, v81
    v_dot2c_f32_bf16 v6, s98, v82
    v_dot2c_f32_bf16 v6, s98, v83
    s_nop 2
    v_mov_b32 v7, v6
    s_nop 1
    v_permlane32_swap_b32 v6, v7
    v_add_f32 v6, v6, v7
    v_cvt_pk_bf16_f32 v7, v6, v6
    v_lshlrev_b32 v7, 16, v7
    v_sub_f32 v7, v6, v7
    v_cvt_pk_bf16_f32 v6, v6, v7
    v_mov_b32 v7, 0
    s_add_u32 s22, s13, 1
    s_and_b32 s22, s22, 3
    s_lshl_b32 s22, s22, 7
    s_add_u32 s22, s22, 87552
    v_lshlrev_b32 v5, 2, v2
    v_add_u32 v5, s22, v5
    ds_write_b32 v5, v6
    s_lshl_b32 s20, s13, 2
    s_add_u32 s20, s20, 163392
    v_mov_b32 v5, s20
    v_mov_b32 v7, 1
    s_waitcnt lgkmcnt(0)
    ds_write_b32 v5, v7
    s_lshl_b32 s20, s19, 2
    s_add_u32 s21, s20, s52
    s_mul_i32 s21, s21, 1152
    s_add_u32 s21, s21, 124928
    v_add_u32 v16, s21, v1
    v_lshlrev_b32 v17, 2, v2
    v_add_u32 v17, s21, v17
    s_mul_i32 s31, s19, 28416
    s_add_u32 s31, s31, 0
    s_mul_i32 s24, s52, 2368
    s_add_u32 s24, s24, s31
    s_movk_i32 s39, 304
    s_lshl_b32 s29, s16, 2
    s_add_u32 s29, s29, s52
    s_add_u32 s32, s29, 1
    s_min_u32 s32, s32, 9
    v_add_u32 v12, s24, v1
    v_lshlrev_b32 v13, 2, v2
    v_add_u32 v13, s24, v13
    v_min_u32 v14, 18, v2
    v_lshlrev_b32 v14, 4, v14
    v_mad_u32_u24 v14, v3, s39, v14
    v_add_u32 v14, s24, v14
    v_mov_b32 v5, 0xdddddddd
    v_mov_b32 v7, 0
    v_mov_b32 v29, 0
    v_mov_b32 v31, 0
    v_mov_b32 v15, 0xf149f2ca
    v_cmp_eq_u32 vcc, 0, v3
    v_cndmask_b32 v48, v15, 0, s[64:65]
    v_cndmask_b32 v49, v15, 0, s[66:67]
    v_cndmask_b32 v50, v15, 0, s[68:69]
    v_cndmask_b32 v51, v15, 0, s[70:71]
    v_cndmask_b32 v52, v15, 0, s[72:73]
    v_cndmask_b32 v53, v15, 0, s[74:75]
    v_cndmask_b32 v54, v15, 0, s[76:77]
    v_cndmask_b32 v55, v15, 0, s[78:79]
    v_cndmask_b32 v56, v15, 0, s[80:81]
    v_cndmask_b32 v57, v15, 0, s[82:83]
    v_cndmask_b32 v58, v15, 0, s[84:85]
    v_cndmask_b32 v59, v15, 0, s[86:87]
    v_cndmask_b32 v60, v15, 0, s[88:89]
    v_cndmask_b32 v61, v15, 0, s[90:91]
    v_cndmask_b32 v62, v15, 0, s[92:93]
    v_cndmask_b32 v63, v15, 0, s[94:95]
    v_mov_b32 v80, 0
    v_mov_b32 v81, 0
    v_mov_b32 v82, 0
    v_mov_b32 v83, 0
    v_mov_b32 v84, 0
    v_mov_b32 v85, 0
    v_mov_b32 v86, 0
    v_mov_b32 v87, 0
    v_mov_b32 v88, 0
    v_mov_b32 v89, 0
    v_mov_b32 v90, 0
    v_mov_b32 v91, 0
    v_mov_b32 v92, 0
    v_mov_b32 v93, 0
    v_mov_b32 v94, 0
    v_mov_b32 v95, 0
    s_lshl_b32 s56, s15, 2
    s_add_u32 s56, s56, s13
    s_mul_i32 s56, s56, 36864
    s_add_u32 s56, s56, 0
    s_add_u32 s56, s56, s97
    s_and_b32 s57, s15, 1
    s_add_u32 s57, s57, 16
    s_lshl_b32 s57, s57, 2
    s_add_u32 s57, s57, s13
    s_mul_i32 s57, s57, 9216
    s_add_u32 s57, s57, 1403904
    s_lshl_b32 s58, s15, 2
    s_add_u32 s58, s58, s13
    s_lshl_b32 s58, s58, 11
    s_add_u32 s58, s58, s48
    s_add_u32 s58, s58, s40
    s_add_u32 s58, s58, 0
    s_and_b32 s59, s15, 1
    s_add_u32 s59, s59, 16
    s_lshl_b32 s59, s59, 1
    s_lshr_b32 s21, s13, 1
    s_add_u32 s59, s59, s21
    s_lshl_b32 s59, s59, 10
    s_and_b32 s21, s13, 1
    s_lshl_b32 s21, s21, 3
    s_add_u32 s59, s59, s21
    s_add_u32 s59, s59, s48
    s_add_u32 s59, s59, s40
    s_add_u32 s59, s59, 0
    s_cmp_eq_u32 s19, 0
    s_cselect_b32 s30, s59, s58
    s_lshl_b32 s33, s16, 7
    s_add_u32 s33, s33, 0
    s_lshl_b32 s27, s17, 1
    s_add_u32 s27, s27, s19
    s_mul_i32 s28, s29, 36864
    s_add_u32 s28, s28, s46
    s_lshl_b32 s29, s17, 3
    s_add_u32 s29, s29, s12
    s_add_u32 s29, s29, s33
    s_lshl_b32 s20, s27, 10
    s_add_u32 s20, s20, s28
    s_lshr_b32 s21, s27, 3
    s_add_u32 s21, s21, 32
    s_lshl_b32 s21, s21, 10
    s_add_u32 s21, s21, s28
    s_bfe_u32 s22, s27, 0x10002
    s_lshl_b32 s22, s22, 9
    s_add_u32 s21, s21, s22
    s_and_b32 s22, s27, 3
    s_lshl_b32 s22, s22, 2
    s_add_u32 s28, s21, s22
    s_mov_b32 s27, s20
    s_lshl_b32 s20, s49, 5
    s_add_u32 s20, s20, 16384
    v_mov_b32 v8, s20
    v_mov_b32 v9, 1
    s_cmp_eq_u32 s13, 0
    s_cselect_b32 s23, 1, 0
    s_waitcnt vmcnt(0)
    s_barrier
    s_cbranch_scc0 QB_H0
    s_mov_b64 exec, 1
    buffer_store_dword v9, v8, s[4:7], s42 offen sc1
QB_H0:
    s_mov_b64 exec, 0xff
    ds_write_b128 v10, v[96:99] offset:1440
    s_mov_b64 exec, -1
    s_lshr_b32 s22, s13, 1
    s_add_u32 s22, s22, 1
    s_cmp_lt_u32 s16, s22
    s_cbranch_scc1 QB_H1
    s_lshl_b32 s20, s22, 6
    s_sub_u32 s20, s49, s20
    s_lshl_b32 s20, s20, 5
    s_add_u32 s20, s20, 16384
    v_mov_b32 v18, s20
    s_and_b32 s23, s13, 1
    s_lshl_b32 s20, s17, 1
    s_add_u32 s20, s20, s23
    s_lshl_b32 s20, s20, 6
    s_sub_u32 s21, s16, s22
    s_lshl_b32 s21, s21, 2
    s_add_u32 s20, s20, s21
    s_mul_i32 s20, s20, 2368
    s_add_u32 s20, s20, s47
    s_mul_i32 s21, s23, 28416
    s_mul_i32 s22, s22, 9472
    s_sub_u32 s21, s21, s22
    s_add_u32 s21, s21, 18944
    s_mov_b32 s38, 0
POLL_91:
    buffer_load_dword v19, v18, s[4:7], s42 offen sc1
    s_waitcnt vmcnt(0)
    v_cmp_ne_u32 vcc, 1, v19
    s_cbranch_vccz POLLD_92
    s_add_u32 s38, s38, 1
    s_cmp_lt_u32 s38, 200000
    s_cbranch_scc1 POLL_91
POLLD_92:
    s_mov_b32 m0, s21
    s_nop 0
    buffer_load_dwordx4 v1, s[4:7], s20 offen offset:0 sc1 lds
    buffer_load_dwordx4 v1, s[4:7], s20 offen offset:1024 sc1 lds
    buffer_load_dwordx4 v1, s[4:7], s20 offen offset:2048 sc1 lds
    buffer_load_dwordx4 v1, s[4:7], s20 offen offset:3072 sc1 lds
    s_add_u32 s20, s20, 4096
    s_add_u32 s21, s21, 4096
    s_mov_b32 m0, s21
    s_nop 0
    buffer_load_dwordx4 v1, s[4:7], s20 offen offset:0 sc1 lds
    buffer_load_dwordx4 v1, s[4:7], s20 offen offset:1024 sc1 lds
    buffer_load_dwordx4 v1, s[4:7], s20 offen offset:2048 sc1 lds
    buffer_load_dwordx4 v1, s[4:7], s20 offen offset:3072 sc1 lds
    s_add_u32 s20, s20, 4096
    s_add_u32 s21, s21, 4096
    s_mov_b32 m0, s21
    s_nop 0
    buffer_load_dwordx4 v1, s[4:7], s20 offen offset:0 sc1 lds
    s_mov_b32 exec_lo, 0xffff
    s_mov_b32 exec_hi, 0x0
    buffer_load_dwordx4 v1, s[4:7], s20 offen offset:1024 sc1 lds
    s_mov_b64 exec, -1
QB_H1:
    s_waitcnt vmcnt(0) lgkmcnt(0)
    s_barrier
    s_branch QB_DONE
QB_C:
    s_lshl_b32 s29, s16, 2
    s_add_u32 s29, s29, s13
    s_lshl_b32 s22, s29, 10
    s_add_u32 s22, s22, s41
    s_add_u32 s22, s22, 65536
    s_mul_i32 s34, s29, 36864
    s_add_u32 s34, s34, s40
    s_add_u32 s34, s34, 0
    v_add_u32 v5, 36864, v1
    v_min_u32 v9, 11, v2
    v_lshlrev_b32 v9, 4, v9
    v_mul_u32_u24 v12, 192, v3
    v_add_u32 v9, v9, v12
    v_add_u32 v9, 73728, v9
    v_lshlrev_b32 v12, 5, v2
    v_lshl_add_u32 v12, v3, 4, v12
    s_mov_b32 s38, 0
POLL_93:
    buffer_load_dwordx4 v[248:251], v12, s[4:7], s22 offen sc1
    s_waitcnt vmcnt(0)
    v_and_b32 v13, v249, v251
    v_cmp_le_i32 vcc, 0, v13
    s_cbranch_vccz POLLD_94
    s_add_u32 s38, s38, 1
    s_cmp_lt_u32 s38, 200000
    s_cbranch_scc1 POLL_93
POLLD_94:
    buffer_load_dwordx4 v[112:115], v1, s[4:7], s34 offen offset:0 sc1
    buffer_load_dwordx4 v[116:119], v1, s[4:7], s34 offen offset:1024 sc1
    buffer_load_dwordx4 v[120:123], v1, s[4:7], s34 offen offset:2048 sc1
    buffer_load_dwordx4 v[124:127], v1, s[4:7], s34 offen offset:3072 sc1
    s_add_u32 s34, s34, 4096
    buffer_load_dwordx4 v[128:131], v1, s[4:7], s34 offen offset:0 sc1
    buffer_load_dwordx4 v[132:135], v1, s[4:7], s34 offen offset:1024 sc1
    buffer_load_dwordx4 v[136:139], v1, s[4:7], s34 offen offset:2048 sc1
    buffer_load_dwordx4 v[140:143], v1, s[4:7], s34 offen offset:3072 sc1
    ds_read_b128 v[80:83], v1 offset:0
    ds_read_b128 v[84:87], v5 offset:0
    ds_read_b128 v[88:91], v9 offset:0
    ds_read_b128 v[92:95], v1 offset:1024
    ds_read_b128 v[96:99], v5 offset:1024
    ds_read_b128 v[100:103], v9 offset:384
    ds_read_b128 v[16:19], v1 offset:2048
    ds_read_b128 v[20:23], v5 offset:2048
    ds_read_b128 v[24:27], v9 offset:768
    s_waitcnt vmcnt(7) lgkmcnt(6)
    v_mfma_f32_32x32x16_bf16 v[32:47], v[80:83], v[112:115], 0
    s_add_u32 s34, s34, 4096
    buffer_load_dwordx4 v[144:147], v1, s[4:7], s34 offen offset:0 sc1
    v_add_f32 v248, v248, v250
    v_add_f32 v249, v249, v251
    v_mfma_f32_32x32x16_bf16 v[48:63], v[112:115], v[84:87], 0
    buffer_load_dwordx4 v[148:151], v1, s[4:7], s34 offen offset:1024 sc1
    v_mov_b32 v250, v248
    v_mov_b32 v251, v249
    v_mfma_f32_32x32x16_bf16 v[64:79], v[88:91], v[112:115], 0
    ds_read_b128 v[80:83], v1 offset:3072
    ds_read_b128 v[84:87], v5 offset:3072
    ds_read_b128 v[88:91], v9 offset:1152
    s_waitcnt vmcnt(8) lgkmcnt(6)
    v_mfma_f32_32x32x16_bf16 v[32:47], v[92:95], v[116:119], v[32:47]
    buffer_load_dwordx4 v[152:155], v1, s[4:7], s34 offen offset:2048 sc1
    v_permlane32_swap_b32 v248, v250
    v_permlane32_swap_b32 v249, v251
    v_mfma_f32_32x32x16_bf16 v[48:63], v[116:119], v[96:99], v[48:63]
    buffer_load_dwordx4 v[156:159], v1, s[4:7], s34 offen offset:3072 sc1
    v_add_f32 v248, v248, v250
    v_add_f32 v249, v249, v251
    v_mfma_f32_32x32x16_bf16 v[64:79], v[100:103], v[116:119], v[64:79]
    ds_read_b128 v[92:95], v1 offset:4096
    ds_read_b128 v[96:99], v5 offset:4096
    ds_read_b128 v[100:103], v9 offset:1536
    s_waitcnt vmcnt(9) lgkmcnt(6)
    v_mfma_f32_32x32x16_bf16 v[32:47], v[16:19], v[120:123], v[32:47]
    s_add_u32 s34, s34, 4096
    buffer_load_dwordx4 v[160:163], v1, s[4:7], s34 offen offset:0 sc1
    v_mul_f32 v248, 0x3ae38e39, v248
    v_mul_f32 v249, 0xbae38e39, v249
    v_mfma_f32_32x32x16_bf16 v[48:63], v[120:123], v[20:23], v[48:63]
    buffer_load_dwordx4 v[164:167], v1, s[4:7], s34 offen offset:1024 sc1
    v_fma_f32 v249, -v248, v248, v249
    v_max_f32 v249, 0, v249
    v_mfma_f32_32x32x16_bf16 v[64:79], v[24:27], v[120:123], v[64:79]
    ds_read_b128 v[16:19], v1 offset:5120
    ds_read_b128 v[20:23], v5 offset:5120
    ds_read_b128 v[24:27], v9 offset:1920
    s_waitcnt vmcnt(10) lgkmcnt(6)
    v_mfma_f32_32x32x16_bf16 v[32:47], v[80:83], v[124:127], v[32:47]
    buffer_load_dwordx4 v[168:171], v1, s[4:7], s34 offen offset:2048 sc1
    v_cvt_pk_bf16_f32 v10, -v248, -v248
    v_cvt_pk_bf16_f32 v249, v249, v249
    v_mfma_f32_32x32x16_bf16 v[48:63], v[124:127], v[84:87], v[48:63]
    buffer_load_dwordx4 v[172:175], v1, s[4:7], s34 offen offset:3072 sc1
    v_lshlrev_b32 v249, 16, v249
    v_add_f32 v249, 0x3727c5ac, v249
    v_mfma_f32_32x32x16_bf16 v[64:79], v[88:91], v[124:127], v[64:79]
    ds_read_b128 v[80:83], v1 offset:6144
    ds_read_b128 v[84:87], v5 offset:6144
    ds_read_b128 v[88:91], v9 offset:2304
    s_waitcnt vmcnt(11) lgkmcnt(6)
    v_mfma_f32_32x32x16_bf16 v[32:47], v[92:95], v[128:131], v[32:47]
    s_add_u32 s34, s34, 4096
    buffer_load_dwordx4 v[176:179], v1, s[4:7], s34 offen offset:0 sc1
    v_cvt_pk_bf16_f32 v249, v249, v249
    v_lshlrev_b32 v249, 16, v249
    v_mfma_f32_32x32x16_bf16 v[48:63], v[128:131], v[96:99], v[48:63]
    buffer_load_dwordx4 v[180:183], v1, s[4:7], s34 offen offset:1024 sc1
    v_sqrt_f32 v249, v249
    s_nop 0
    v_cvt_pk_bf16_f32 v249, v249, v249
    v_mfma_f32_32x32x16_bf16 v[64:79], v[100:103], v[128:131], v[64:79]
    ds_read_b128 v[92:95], v1 offset:7168
    ds_read_b128 v[96:99], v5 offset:7168
    ds_read_b128 v[100:103], v9 offset:2688
    s_waitcnt vmcnt(12) lgkmcnt(6)
    v_mfma_f32_32x32x16_bf16 v[32:47], v[16:19], v[132:135], v[32:47]
    buffer_load_dwordx4 v[184:187], v1, s[4:7], s34 offen offset:2048 sc1
    v_lshlrev_b32 v249, 16, v249
    v_rcp_f32 v6, v249
    v_mfma_f32_32x32x16_bf16 v[48:63], v[132:135], v[20:23], v[48:63]
    buffer_load_dwordx4 v[188:191], v1, s[4:7], s34 offen offset:3072 sc1
    s_mul_i32 s28, s13, 2368
    s_add_u32 s28, s28, 18944
    v_mfma_f32_32x32x16_bf16 v[64:79], v[24:27], v[132:135], v[64:79]
    ds_read_b128 v[16:19], v1 offset:8192
    ds_read_b128 v[20:23], v5 offset:8192
    ds_read_b128 v[24:27], v9 offset:3072
    s_waitcnt vmcnt(13) lgkmcnt(6)
    v_mfma_f32_32x32x16_bf16 v[32:47], v[80:83], v[136:139], v[32:47]
    s_add_u32 s34, s34, 4096
    buffer_load_dwordx4 v[192:195], v1, s[4:7], s34 offen offset:0 sc1
    s_mul_i32 s27, s13, 1152
    s_add_u32 s27, s27, 124928
    v_mfma_f32_32x32x16_bf16 v[48:63], v[136:139], v[84:87], v[48:63]
    buffer_load_dwordx4 v[196:199], v1, s[4:7], s34 offen offset:1024 sc1
    s_lshl_b32 s24, s17, 7
    s_add_u32 s24, s24, s29
    v_mfma_f32_32x32x16_bf16 v[64:79], v[88:91], v[136:139], v[64:79]
    ds_read_b128 v[80:83], v1 offset:9216
    ds_read_b128 v[84:87], v5 offset:9216
    ds_read_b128 v[88:91], v9 offset:3456
    s_waitcnt vmcnt(14) lgkmcnt(6)
    v_mfma_f32_32x32x16_bf16 v[32:47], v[92:95], v[140:143], v[32:47]
    buffer_load_dwordx4 v[200:203], v1, s[4:7], s34 offen offset:2048 sc1
    s_mul_i32 s24, s24, 2368
    s_add_u32 s24, s24, s47
    v_mfma_f32_32x32x16_bf16 v[48:63], v[140:143], v[96:99], v[48:63]
    buffer_load_dwordx4 v[204:207], v1, s[4:7], s34 offen offset:3072 sc1
    s_add_u32 s25, s24, 151552
    s_lshl_b32 s23, s13, 8
    v_mfma_f32_32x32x16_bf16 v[64:79], v[100:103], v[140:143], v[64:79]
    ds_read_b128 v[92:95], v1 offset:10240
    ds_read_b128 v[96:99], v5 offset:10240
    ds_read_b128 v[100:103], v9 offset:3840
    s_waitcnt vmcnt(15) lgkmcnt(6)
    v_mfma_f32_32x32x16_bf16 v[32:47], v[16:19], v[144:147], v[32:47]
    s_add_u32 s34, s34, 4096
    buffer_load_dwordx4 v[208:211], v1, s[4:7], s34 offen offset:0 sc1
    s_add_u32 s23, s23, 161792
    s_mov_b32 s20, 151552
    v_mfma_f32_32x32x16_bf16 v[48:63], v[144:147], v[20:23], v[48:63]
    buffer_load_dwordx4 v[212:215], v1, s[4:7], s34 offen offset:1024 sc1
    v_cmp_eq_u32 vcc, 0, v3
    v_mov_b32 v109, s51
    v_mfma_f32_32x32x16_bf16 v[64:79], v[24:27], v[144:147], v[64:79]
    ds_read_b128 v[16:19], v1 offset:11264
    ds_read_b128 v[20:23], v5 offset:11264
    ds_read_b128 v[24:27], v9 offset:4224
    s_waitcnt vmcnt(16) lgkmcnt(6)
    v_mfma_f32_32x32x16_bf16 v[32:47], v[80:83], v[148:151], v[32:47]
    buffer_load_dwordx4 v[216:219], v1, s[4:7], s34 offen offset:2048 sc1
    v_mov_b32 v11, 0
    v_cndmask_b32 v109, 1.0, v109, vcc
    v_mfma_f32_32x32x16_bf16 v[48:63], v[148:151], v[84:87], v[48:63]
    buffer_load_dwordx4 v[220:223], v1, s[4:7], s34 offen offset:3072 sc1
    v_cndmask_b32 v10, 0, v10, vcc
    v_mul_f32 v8, v6, v109
    v_mfma_f32_32x32x16_bf16 v[64:79], v[88:91], v[148:151], v[64:79]
    ds_read_b128 v[80:83], v1 offset:12288
    ds_read_b128 v[84:87], v5 offset:12288
    ds_read_b128 v[88:91], v9 offset:4608
    s_waitcnt vmcnt(17) lgkmcnt(6)
    v_mfma_f32_32x32x16_bf16 v[32:47], v[92:95], v[152:155], v[32:47]
    s_add_u32 s34, s34, 4096
    buffer_load_dwordx4 v[224:227], v1, s[4:7], s34 offen offset:0 sc1
    v_lshlrev_b32 v12, 2, v2
    v_add_u32 v13, s23, v12
    v_mfma_f32_32x32x16_bf16 v[48:63], v[152:155], v[96:99], v[48:63]
    buffer_load_dwordx4 v[228:231], v1, s[4:7], s34 offen offset:1024 sc1
    v_add_u32 v12, 87552, v12
    v_lshlrev_b32 v14, 4, v3
    v_mfma_f32_32x32x16_bf16 v[64:79], v[100:103], v[152:155], v[64:79]
    ds_read_b128 v[92:95], v1 offset:13312
    ds_read_b128 v[96:99], v5 offset:13312
    ds_read_b128 v[100:103], v9 offset:4992
    s_waitcnt vmcnt(18) lgkmcnt(6)
    v_mfma_f32_32x32x16_bf16 v[32:47], v[16:19], v[156:159], v[32:47]
    buffer_load_dwordx4 v[232:235], v1, s[4:7], s34 offen offset:2048 sc1
    v_add_u32 v14, s23, v14
    v_mov_b32 v29, 0
    v_mfma_f32_32x32x16_bf16 v[48:63], v[156:159], v[20:23], v[48:63]
    buffer_load_dwordx4 v[236:239], v1, s[4:7], s34 offen offset:3072 sc1
    v_mov_b32 v31, 0
    v_mov_b32 v111, 0
    v_mfma_f32_32x32x16_bf16 v[64:79], v[24:27], v[156:159], v[64:79]
    ds_read_b128 v[16:19], v1 offset:14336
    ds_read_b128 v[20:23], v5 offset:14336
    ds_read_b128 v[24:27], v9 offset:5376
    s_waitcnt vmcnt(19) lgkmcnt(6)
    v_mfma_f32_32x32x16_bf16 v[32:47], v[80:83], v[160:163], v[32:47]
    s_add_u32 s34, s34, 4096
    buffer_load_dwordx4 v[240:243], v1, s[4:7], s34 offen offset:0 sc1
    v_and_b32 v106, 0x13, v2
    v_bfe_u32 v109, v2, 2, 1
    v_mfma_f32_32x32x16_bf16 v[48:63], v[160:163], v[84:87], v[48:63]
    buffer_load_dwordx4 v[244:247], v1, s[4:7], s34 offen offset:1024 sc1
    v_lshl_or_b32 v106, v109, 3, v106
    v_bfe_u32 v109, v2, 3, 1
    v_mfma_f32_32x32x16_bf16 v[64:79], v[88:91], v[160:163], v[64:79]
    ds_read_b128 v[80:83], v1 offset:15360
    ds_read_b128 v[84:87], v5 offset:15360
    ds_read_b128 v[88:91], v9 offset:5760
    s_waitcnt vmcnt(20) lgkmcnt(6)
    v_mfma_f32_32x32x16_bf16 v[32:47], v[92:95], v[164:167], v[32:47]
    buffer_load_dwordx4 v[248:251], v1, s[4:7], s34 offen offset:2048 sc1
    v_lshl_or_b32 v106, v109, 2, v106
    v_lshl_add_u32 v104, v3, 5, v106
    v_mfma_f32_32x32x16_bf16 v[48:63], v[164:167], v[96:99], v[48:63]
    buffer_load_dwordx4 v[252:255], v1, s[4:7], s34 offen offset:3072 sc1
    v_lshlrev_b32 v104, 4, v104
    v_lshlrev_b32 v106, 2, v106
    v_mfma_f32_32x32x16_bf16 v[64:79], v[100:103], v[164:167], v[64:79]
    ds_read_b128 v[92:95], v1 offset:16384
    ds_read_b128 v[96:99], v5 offset:16384
    ds_read_b128 v[100:103], v9 offset:6144
    s_waitcnt vmcnt(21) lgkmcnt(6)
    v_mfma_f32_32x32x16_bf16 v[32:47], v[16:19], v[168:171], v[32:47]
    v_and_b32 v109, 15, v0
    v_lshlrev_b32 v109, 4, v109
    v_mfma_f32_32x32x16_bf16 v[48:63], v[168:171], v[20:23], v[48:63]
    v_mul_u32_u24 v108, 304, v3
    v_add_u32 v109, v109, v108
    v_mfma_f32_32x32x16_bf16 v[64:79], v[24:27], v[168:171], v[64:79]
    ds_read_b128 v[16:19], v1 offset:17408
    ds_read_b128 v[20:23], v5 offset:17408
    ds_read_b128 v[24:27], v9 offset:6528
    s_waitcnt vmcnt(20) lgkmcnt(6)
    v_mfma_f32_32x32x16_bf16 v[32:47], v[80:83], v[172:175], v[32:47]
    v_lshrrev_b32 v108, 4, v2
    v_mul_lo_u32 v105, v108, s20
    v_mfma_f32_32x32x16_bf16 v[48:63], v[172:175], v[84:87], v[48:63]
    v_add_u32 v105, v105, v109
    v_mul_u32_u24 v108, 28416, v108
    v_mfma_f32_32x32x16_bf16 v[64:79], v[88:91], v[172:175], v[64:79]
    ds_read_b128 v[80:83], v1 offset:18432
    ds_read_b128 v[84:87], v5 offset:18432
    ds_read_b128 v[88:91], v9 offset:6912
    s_waitcnt vmcnt(19) lgkmcnt(6)
    v_mfma_f32_32x32x16_bf16 v[32:47], v[92:95], v[176:179], v[32:47]
    v_add3_u32 v108, v108, v109, s28
    v_lshrrev_b32 v107, 4, v2
    v_mfma_f32_32x32x16_bf16 v[48:63], v[176:179], v[96:99], v[48:63]
    v_mul_u32_u24 v107, 608, v107
    v_bfe_u32 v109, v2, 2, 1
    v_mfma_f32_32x32x16_bf16 v[64:79], v[100:103], v[176:179], v[64:79]
    ds_read_b128 v[92:95], v1 offset:19456
    ds_read_b128 v[96:99], v5 offset:19456
    ds_read_b128 v[100:103], v9 offset:7296
    s_waitcnt vmcnt(18) lgkmcnt(6)
    v_mfma_f32_32x32x16_bf16 v[32:47], v[16:19], v[180:183], v[32:47]
    v_mul_u32_u24 v109, 304, v109
    v_add_u32 v107, v107, v109
    v_mfma_f32_32x32x16_bf16 v[48:63], v[180:183], v[20:23], v[48:63]
    v_bfe_u32 v109, v2, 3, 1
    v_lshl_add_u32 v107, v109, 3, v107
    v_mfma_f32_32x32x16_bf16 v[64:79], v[24:27], v[180:183], v[64:79]
    ds_read_b128 v[16:19], v1 offset:20480
    ds_read_b128 v[20:23], v5 offset:20480
    ds_read_b128 v[24:27], v9 offset:7680
    s_waitcnt vmcnt(17) lgkmcnt(6)
    v_mfma_f32_32x32x16_bf16 v[32:47], v[80:83], v[184:187], v[32:47]
    v_and_b32 v109, 3, v2
    v_lshl_add_u32 v107, v109, 1, v107
    v_mfma_f32_32x32x16_bf16 v[48:63], v[184:187], v[84:87], v[48:63]
    v_add_u32 v109, 88064, v1
    v_mfma_f32_32x32x16_bf16 v[64:79], v[88:91], v[184:187], v[64:79]
    ds_read_b128 v[80:83], v1 offset:21504
    ds_read_b128 v[84:87], v5 offset:21504
    ds_read_b128 v[88:91], v9 offset:8064
    s_waitcnt vmcnt(16) lgkmcnt(6)
    v_mfma_f32_32x32x16_bf16 v[32:47], v[92:95], v[188:191], v[32:47]
    v_mfma_f32_32x32x16_bf16 v[48:63], v[188:191], v[96:99], v[48:63]
    v_mfma_f32_32x32x16_bf16 v[64:79], v[100:103], v[188:191], v[64:79]
    ds_read_b128 v[92:95], v1 offset:22528
    ds_read_b128 v[96:99], v5 offset:22528
    ds_read_b128 v[100:103], v9 offset:8448
    s_waitcnt vmcnt(15) lgkmcnt(6)
    v_mfma_f32_32x32x16_bf16 v[32:47], v[16:19], v[192:195], v[32:47]
    v_mfma_f32_32x32x16_bf16 v[48:63], v[192:195], v[20:23], v[48:63]
    v_mfma_f32_32x32x16_bf16 v[64:79], v[24:27], v[192:195], v[64:79]
    ds_read_b128 v[16:19], v1 offset:23552
    ds_read_b128 v[20:23], v5 offset:23552
    ds_read_b128 v[24:27], v9 offset:8832
    s_waitcnt vmcnt(14) lgkmcnt(6)
    v_mfma_f32_32x32x16_bf16 v[32:47], v[80:83], v[196:199], v[32:47]
    v_mfma_f32_32x32x16_bf16 v[48:63], v[196:199], v[84:87], v[48:63]
    v_mfma_f32_32x32x16_bf16 v[64:79], v[88:91], v[196:199], v[64:79]
    ds_read_b128 v[80:83], v1 offset:24576
    ds_read_b128 v[84:87], v5 offset:24576
    ds_read_b128 v[88:91], v9 offset:9216
    s_waitcnt vmcnt(13) lgkmcnt(6)
    v_mfma_f32_32x32x16_bf16 v[32:47], v[92:95], v[200:203], v[32:47]
    v_mfma_f32_32x32x16_bf16 v[48:63], v[200:203], v[96:99], v[48:63]
    v_mfma_f32_32x32x16_bf16 v[64:79], v[100:103], v[200:203], v[64:79]
    ds_read_b128 v[92:95], v1 offset:25600
    ds_read_b128 v[96:99], v5 offset:25600
    ds_read_b128 v[100:103], v9 offset:9600
    s_waitcnt vmcnt(12) lgkmcnt(6)
    v_mfma_f32_32x32x16_bf16 v[32:47], v[16:19], v[204:207], v[32:47]
    v_mfma_f32_32x32x16_bf16 v[48:63], v[204:207], v[20:23], v[48:63]
    v_mfma_f32_32x32x16_bf16 v[64:79], v[24:27], v[204:207], v[64:79]
    ds_read_b128 v[16:19], v1 offset:26624
    ds_read_b128 v[20:23], v5 offset:26624
    ds_read_b128 v[24:27], v9 offset:9984
    s_waitcnt vmcnt(11) lgkmcnt(6)
    v_mfma_f32_32x32x16_bf16 v[32:47], v[80:83], v[208:211], v[32:47]
    v_mfma_f32_32x32x16_bf16 v[48:63], v[208:211], v[84:87], v[48:63]
    v_mfma_f32_32x32x16_bf16 v[64:79], v[88:91], v[208:211], v[64:79]
    ds_read_b128 v[80:83], v1 offset:27648
    ds_read_b128 v[84:87], v5 offset:27648
    ds_read_b128 v[88:91], v9 offset:10368
    s_waitcnt vmcnt(10) lgkmcnt(6)
    v_mfma_f32_32x32x16_bf16 v[32:47], v[92:95], v[212:215], v[32:47]
    v_mfma_f32_32x32x16_bf16 v[48:63], v[212:215], v[96:99], v[48:63]
    v_mfma_f32_32x32x16_bf16 v[64:79], v[100:103], v[212:215], v[64:79]
    ds_read_b128 v[92:95], v1 offset:28672
    ds_read_b128 v[96:99], v5 offset:28672
    ds_read_b128 v[100:103], v9 offset:10752
    s_waitcnt vmcnt(9) lgkmcnt(6)
    v_mfma_f32_32x32x16_bf16 v[32:47], v[16:19], v[216:219], v[32:47]
    v_mfma_f32_32x32x16_bf16 v[48:63], v[216:219], v[20:23], v[48:63]
    v_mfma_f32_32x32x16_bf16 v[64:79], v[24:27], v[216:219], v[64:79]
    ds_read_b128 v[16:19], v1 offset:29696
    ds_read_b128 v[20:23], v5 offset:29696
    ds_read_b128 v[24:27], v9 offset:11136
    s_waitcnt vmcnt(8) lgkmcnt(6)
    v_mfma_f32_32x32x16_bf16 v[32:47], v[80:83], v[220:223], v[32:47]
    v_mfma_f32_32x32x16_bf16 v[48:63], v[220:223], v[84:87], v[48:63]
    v_mfma_f32_32x32x16_bf16 v[64:79], v[88:91], v[220:223], v[64:79]
    v_mov_b32 v28, 163392
CW_95:
    ds_read_b32 v30, v28
    ds_read_b32 v110, v28 offset:4
    ds_read_b32 v15, v28 offset:8
    ds_read_b32 v7, v28 offset:12
    s_waitcnt lgkmcnt(0)
    v_and_b32 v110, v110, v30
    v_and_b32 v15, v15, v7
    v_and_b32 v15, v15, v110
    s_nop 0
    v_readfirstlane_b32 s20, v15
    s_nop 0
    s_cmp_eq_u32 s20, 0
    s_cbranch_scc1 CW_95
    ds_write_b32 v13, v6
    ds_read_b32 v28, v12 offset:128
    ds_read_b32 v30, v12 offset:256
    ds_read_b32 v110, v12 offset:384
    ds_read_b128 v[80:83], v1 offset:30720
    ds_read_b128 v[84:87], v5 offset:30720
    ds_read_b128 v[88:91], v9 offset:11520
    s_waitcnt vmcnt(7) lgkmcnt(10)
    v_mfma_f32_32x32x16_bf16 v[32:47], v[92:95], v[224:227], v[32:47]
    v_mfma_f32_32x32x16_bf16 v[48:63], v[224:227], v[96:99], v[48:63]
    v_mfma_f32_32x32x16_bf16 v[64:79], v[100:103], v[224:227], v[64:79]
    ds_read_b128 v[92:95], v1 offset:31744
    ds_read_b128 v[96:99], v5 offset:31744
    ds_read_b128 v[100:103], v9 offset:11904
    s_waitcnt vmcnt(6) lgkmcnt(6)
    v_mfma_f32_32x32x16_bf16 v[32:47], v[16:19], v[228:231], v[32:47]
    v_mfma_f32_32x32x16_bf16 v[48:63], v[228:231], v[20:23], v[48:63]
    v_mfma_f32_32x32x16_bf16 v[64:79], v[24:27], v[228:231], v[64:79]
    ds_read_b128 v[16:19], v1 offset:32768
    ds_read_b128 v[20:23], v5 offset:32768
    ds_read_b128 v[24:27], v9 offset:12288
    s_waitcnt vmcnt(5) lgkmcnt(6)
    v_mfma_f32_32x32x16_bf16 v[32:47], v[80:83], v[232:235], v[32:47]
    v_mfma_f32_32x32x16_bf16 v[48:63], v[232:235], v[84:87], v[48:63]
    v_mfma_f32_32x32x16_bf16 v[64:79], v[88:91], v[232:235], v[64:79]
    ds_read_b128 v[80:83], v1 offset:33792
    ds_read_b128 v[84:87], v5 offset:33792
    ds_read_b128 v[88:91], v9 offset:12672
    s_waitcnt vmcnt(4) lgkmcnt(6)
    v_mfma_f32_32x32x16_bf16 v[32:47], v[92:95], v[236:239], v[32:47]
    v_mfma_f32_32x32x16_bf16 v[48:63], v[236:239], v[96:99], v[48:63]
    v_mfma_f32_32x32x16_bf16 v[64:79], v[100:103], v[236:239], v[64:79]
    ds_read_b128 v[92:95], v1 offset:34816
    ds_read_b128 v[96:99], v5 offset:34816
    ds_read_b128 v[100:103], v9 offset:13056
    s_waitcnt vmcnt(3) lgkmcnt(6)
    v_mfma_f32_32x32x16_bf16 v[32:47], v[16:19], v[240:243], v[32:47]
    v_mfma_f32_32x32x16_bf16 v[48:63], v[240:243], v[20:23], v[48:63]
    v_mfma_f32_32x32x16_bf16 v[64:79], v[24:27], v[240:243], v[64:79]
    v_mfma_f32_32x32x8_bf16 v[32:47], v[28:29], v[10:11], v[32:47]
    v_mfma_f32_32x32x8_bf16 v[48:63], v[10:11], v[30:31], v[48:63]
    v_mfma_f32_32x32x8_bf16 v[64:79], v[110:111], v[10:11], v[64:79]
    ds_read_b128 v[16:19], v1 offset:35840
    ds_read_b128 v[20:23], v5 offset:35840
    ds_read_b128 v[24:27], v9 offset:13440
    s_waitcnt vmcnt(2) lgkmcnt(6)
    v_mfma_f32_32x32x16_bf16 v[32:47], v[80:83], v[244:247], v[32:47]
    v_mfma_f32_32x32x16_bf16 v[48:63], v[244:247], v[84:87], v[48:63]
    v_mfma_f32_32x32x16_bf16 v[64:79], v[88:91], v[244:247], v[64:79]
    s_waitcnt vmcnt(1) lgkmcnt(3)
    v_mfma_f32_32x32x16_bf16 v[32:47], v[92:95], v[248:251], v[32:47]
    v_mfma_f32_32x32x16_bf16 v[48:63], v[248:251], v[96:99], v[48:63]
    v_mfma_f32_32x32x16_bf16 v[64:79], v[100:103], v[248:251], v[64:79]
    s_waitcnt vmcnt(0) lgkmcnt(0)
    v_mfma_f32_32x32x16_bf16 v[32:47], v[16:19], v[252:255], v[32:47]
    v_mfma_f32_32x32x16_bf16 v[48:63], v[252:255], v[20:23], v[48:63]
    v_mfma_f32_32x32x16_bf16 v[64:79], v[24:27], v[252:255], v[64:79]
    ds_read_b128 v[80:83], v14 offset:0
    ds_read_b128 v[84:87], v14 offset:32
    ds_read_b128 v[88:91], v14 offset:64
    ds_read_b128 v[92:95], v14 offset:96
    ds_read_b32 v110, v12
    s_nop 4
    v_pk_mul_f32 v[32:33], v[32:33], v[6:7] op_sel_hi:[1,0]
    v_pk_mul_f32 v[34:35], v[34:35], v[6:7] op_sel_hi:[1,0]
    v_pk_mul_f32 v[36:37], v[36:37], v[6:7] op_sel_hi:[1,0]
    v_pk_mul_f32 v[38:39], v[38:39], v[6:7] op_sel_hi:[1,0]
    v_pk_mul_f32 v[40:41], v[40:41], v[6:7] op_sel_hi:[1,0]
    v_pk_mul_f32 v[42:43], v[42:43], v[6:7] op_sel_hi:[1,0]
    v_pk_mul_f32 v[44:45], v[44:45], v[6:7] op_sel_hi:[1,0]
    v_pk_mul_f32 v[46:47], v[46:47], v[6:7] op_sel_hi:[1,0]
    v_cvt_pk_bf16_f32 v32, v32, v33
    v_cvt_pk_bf16_f32 v33, v34, v35
    v_cvt_pk_bf16_f32 v34, v36, v37
    v_cvt_pk_bf16_f32 v35, v38, v39
    v_cvt_pk_bf16_f32 v36, v40, v41
    v_cvt_pk_bf16_f32 v37, v42, v43
    v_cvt_pk_bf16_f32 v38, v44, v45
    v_cvt_pk_bf16_f32 v39, v46, v47
    buffer_store_dwordx4 v[32:35], v104, s[4:7], s24 offen sc1
    buffer_store_dwordx4 v[36:39], v104, s[4:7], s25 offen sc1
    s_waitcnt lgkmcnt(1)
    v_pk_mul_f32 v[48:49], v[48:49], v[80:81]
    v_pk_mul_f32 v[50:51], v[50:51], v[82:83]
    v_pk_mul_f32 v[52:53], v[52:53], v[84:85]
    v_pk_mul_f32 v[54:55], v[54:55], v[86:87]
    v_pk_mul_f32 v[56:57], v[56:57], v[88:89]
    v_pk_mul_f32 v[58:59], v[58:59], v[90:91]
    v_pk_mul_f32 v[60:61], v[60:61], v[92:93]
    v_pk_mul_f32 v[62:63], v[62:63], v[94:95]
    ds_read_b128 v[80:83], v109 offset:0
    ds_read_b128 v[84:87], v109 offset:1024
    ds_read_b128 v[88:91], v109 offset:2048
    ds_read_b128 v[92:95], v109 offset:3072
    ds_read_b128 v[96:99], v109 offset:4096
    v_cvt_pk_bf16_f32 v48, v48, v49
    v_cvt_pk_bf16_f32 v49, v50, v51
    v_cvt_pk_bf16_f32 v50, v52, v53
    v_cvt_pk_bf16_f32 v51, v54, v55
    v_cvt_pk_bf16_f32 v52, v56, v57
    v_cvt_pk_bf16_f32 v53, v58, v59
    v_cvt_pk_bf16_f32 v54, v60, v61
    v_cvt_pk_bf16_f32 v55, v62, v63
    buffer_store_dwordx4 v[48:51], v105, s[4:7], s24 offen offset:1152 sc1
    buffer_store_dwordx4 v[52:55], v105, s[4:7], s24 offen offset:1760 sc1
    v_mfma_f32_32x32x8_bf16 v[16:31], v[110:111], v[10:11], 0
    v_pk_mul_f32 v[64:65], v[64:65], v[8:9] op_sel_hi:[1,0]
    v_pk_mul_f32 v[66:67], v[66:67], v[8:9] op_sel_hi:[1,0]
    v_pk_mul_f32 v[68:69], v[68:69], v[6:7] op_sel_hi:[1,0]
    v_pk_mul_f32 v[70:71], v[70:71], v[6:7] op_sel_hi:[1,0]
    v_cvt_pk_bf16_f32 v64, v64, v65
    v_cvt_pk_bf16_f32 v65, v66, v67
    v_cvt_pk_bf16_f32 v66, v68, v69
    v_cvt_pk_bf16_f32 v67, v70, v71
    s_mov_b32 exec_lo, 0
    buffer_store_dword v64, v106, s[4:7], s24 offen offset:1024 sc1
    buffer_store_dword v65, v106, s[4:7], s25 offen offset:1024 sc1
    s_mov_b32 exec_lo, -1
    s_mov_b32 exec_hi, 0
    buffer_store_short v66, v107, s[4:7], s24 offen offset:1408 sc1
    buffer_store_short_d16_hi v66, v107, s[4:7], s24 offen offset:1424 sc1
    buffer_store_short v67, v107, s[4:7], s25 offen offset:1408 sc1
    buffer_store_short_d16_hi v67, v107, s[4:7], s25 offen offset:1424 sc1
    s_mov_b32 exec_hi, -1
    ds_read_b128 v[100:103], v109 offset:5120
    s_waitcnt lgkmcnt(5)
    v_mfma_f32_32x32x16_bf16 v[16:31], v[80:83], v[112:115], v[16:31]
    ds_read_b128 v[80:83], v109 offset:6144
    s_waitcnt lgkmcnt(5)
    v_mfma_f32_32x32x16_bf16 v[16:31], v[84:87], v[116:119], v[16:31]
    ds_read_b128 v[84:87], v109 offset:7168
    s_waitcnt lgkmcnt(5)
    v_mfma_f32_32x32x16_bf16 v[16:31], v[88:91], v[120:123], v[16:31]
    ds_read_b128 v[88:91], v109 offset:8192
    s_waitcnt lgkmcnt(5)
    v_mfma_f32_32x32x16_bf16 v[16:31], v[92:95], v[124:127], v[16:31]
    ds_read_b128 v[92:95], v109 offset:9216
    s_waitcnt lgkmcnt(5)
    v_mfma_f32_32x32x16_bf16 v[16:31], v[96:99], v[128:131], v[16:31]
    ds_read_b128 v[96:99], v109 offset:10240
    s_waitcnt lgkmcnt(5)
    v_mfma_f32_32x32x16_bf16 v[16:31], v[100:103], v[132:135], v[16:31]
    ds_read_b128 v[100:103], v109 offset:11264
    s_waitcnt lgkmcnt(5)
    v_mfma_f32_32x32x16_bf16 v[16:31], v[80:83], v[136:139], v[16:31]
    ds_read_b128 v[80:83], v109 offset:12288
    s_waitcnt lgkmcnt(5)
    v_mfma_f32_32x32x16_bf16 v[16:31], v[84:87], v[140:143], v[16:31]
    ds_read_b128 v[84:87], v109 offset:13312
    s_waitcnt lgkmcnt(5)
    v_mfma_f32_32x32x16_bf16 v[16:31], v[88:91], v[144:147], v[16:31]
    ds_read_b128 v[88:91], v109 offset:14336
    s_waitcnt lgkmcnt(5)
    v_mfma_f32_32x32x16_bf16 v[16:31], v[92:95], v[148:151], v[16:31]
    ds_read_b128 v[92:95], v109 offset:15360
    s_waitcnt lgkmcnt(5)
    v_mfma_f32_32x32x16_bf16 v[16:31], v[96:99], v[152:155], v[16:31]
    ds_read_b128 v[96:99], v109 offset:16384
    s_waitcnt lgkmcnt(5)
    v_mfma_f32_32x32x16_bf16 v[16:31], v[100:103], v[156:159], v[16:31]
    ds_read_b128 v[100:103], v109 offset:17408
    s_waitcnt lgkmcnt(5)
    v_mfma_f32_32x32x16_bf16 v[16:31], v[80:83], v[160:163], v[16:31]
    s_waitcnt vmcnt(0)
    s_barrier
    ds_read_b128 v[80:83], v109 offset:18432
    s_waitcnt lgkmcnt(5)
    v_mfma_f32_32x32x16_bf16 v[16:31], v[84:87], v[164:167], v[16:31]
    v_add_u32 v104, s28, v104
    v_add_u32 v107, s28, v107
    ds_read_b128 v[84:87], v109 offset:19456
    s_waitcnt lgkmcnt(5)
    v_mfma_f32_32x32x16_bf16 v[16:31], v[88:91], v[168:171], v[16:31]
    ds_write_b128 v104, v[32:35]
    ds_write_b128 v104, v[36:39] offset:28416
    ds_read_b128 v[88:91], v109 offset:20480
    s_waitcnt lgkmcnt(7)
    v_mfma_f32_32x32x16_bf16 v[16:31], v[92:95], v[172:175], v[16:31]
    ds_write_b128 v108, v[48:51] offset:1152
    ds_write_b128 v108, v[52:55] offset:1760
    ds_read_b128 v[92:95], v109 offset:21504
    s_waitcnt lgkmcnt(9)
    v_mfma_f32_32x32x16_bf16 v[16:31], v[96:99], v[176:179], v[16:31]
    v_add_u32 v106, s28, v106
    v_lshlrev_b32 v120, 2, v2
    ds_read_b128 v[96:99], v109 offset:22528
    s_waitcnt lgkmcnt(9)
    v_mfma_f32_32x32x16_bf16 v[16:31], v[100:103], v[180:183], v[16:31]
    v_add_u32 v120, s27, v120
    v_add_u32 v121, 4608, v120
    ds_read_b128 v[100:103], v109 offset:23552
    s_waitcnt lgkmcnt(9)
    v_mfma_f32_32x32x16_bf16 v[16:31], v[80:83], v[184:187], v[16:31]
    v_add_u32 v122, 28416, v106
    v_cndmask_b32 v120, v106, v120, vcc
    ds_read_b128 v[80:83], v109 offset:24576
    s_waitcnt lgkmcnt(9)
    v_mfma_f32_32x32x16_bf16 v[16:31], v[84:87], v[188:191], v[16:31]
    v_cndmask_b32 v121, v122, v121, vcc
    ds_write_b32 v120, v64 offset:1024
    ds_read_b128 v[84:87], v109 offset:25600
    s_waitcnt lgkmcnt(8)
    v_mfma_f32_32x32x16_bf16 v[16:31], v[88:91], v[192:195], v[16:31]
    ds_write_b32 v121, v65 offset:1024
    s_mov_b32 exec_hi, 0
    ds_write_b16 v107, v66 offset:1408
    ds_write_b16_d16_hi v107, v66 offset:1424
    ds_write_b16 v107, v67 offset:29824
    ds_write_b16_d16_hi v107, v67 offset:29840
    s_mov_b32 exec_hi, -1
    ds_read_b128 v[88:91], v109 offset:26624
    s_waitcnt lgkmcnt(11)
    v_mfma_f32_32x32x16_bf16 v[16:31], v[92:95], v[196:199], v[16:31]
    v_mul_f32 v6, s51, v6
    v_add_u32 v12, s27, v1
    ds_read_b128 v[92:95], v109 offset:27648
    s_waitcnt lgkmcnt(11)
    v_mfma_f32_32x32x16_bf16 v[16:31], v[96:99], v[200:203], v[16:31]
    ds_read_b128 v[96:99], v109 offset:28672
    s_waitcnt lgkmcnt(11)
    v_mfma_f32_32x32x16_bf16 v[16:31], v[100:103], v[204:207], v[16:31]
    ds_read_b128 v[100:103], v109 offset:29696
    s_waitcnt lgkmcnt(11)
    v_mfma_f32_32x32x16_bf16 v[16:31], v[80:83], v[208:211], v[16:31]
    ds_read_b128 v[80:83], v109 offset:30720
    s_waitcnt lgkmcnt(10)
    v_mfma_f32_32x32x16_bf16 v[16:31], v[84:87], v[212:215], v[16:31]
    ds_read_b128 v[84:87], v109 offset:31744
    s_waitcnt lgkmcnt(5)
    v_mfma_f32_32x32x16_bf16 v[16:31], v[88:91], v[216:219], v[16:31]
    ds_read_b128 v[88:91], v109 offset:32768
    s_waitcnt lgkmcnt(5)
    v_mfma_f32_32x32x16_bf16 v[16:31], v[92:95], v[220:223], v[16:31]
    ds_read_b128 v[92:95], v109 offset:33792
    s_waitcnt lgkmcnt(5)
    v_mfma_f32_32x32x16_bf16 v[16:31], v[96:99], v[224:227], v[16:31]
    ds_read_b128 v[96:99], v109 offset:34816
    s_waitcnt lgkmcnt(5)
    v_mfma_f32_32x32x16_bf16 v[16:31], v[100:103], v[228:231], v[16:31]
    ds_read_b128 v[100:103], v109 offset:35840
    s_waitcnt lgkmcnt(5)
    v_mfma_f32_32x32x16_bf16 v[16:31], v[80:83], v[232:235], v[16:31]
    s_waitcnt lgkmcnt(4)
    v_mfma_f32_32x32x16_bf16 v[16:31], v[84:87], v[236:239], v[16:31]
    s_waitcnt lgkmcnt(3)
    v_mfma_f32_32x32x16_bf16 v[16:31], v[88:91], v[240:243], v[16:31]
    s_waitcnt lgkmcnt(2)
    v_mfma_f32_32x32x16_bf16 v[16:31], v[92:95], v[244:247], v[16:31]
    s_waitcnt lgkmcnt(1)
    v_mfma_f32_32x32x16_bf16 v[16:31], v[96:99], v[248:251], v[16:31]
    s_waitcnt lgkmcnt(0)
    v_mfma_f32_32x32x16_bf16 v[16:31], v[100:103], v[252:255], v[16:31]
    s_nop 11
    v_pk_mul_f32 v[16:17], v[16:17], v[6:7] op_sel_hi:[1,0]
    v_pk_mul_f32 v[18:19], v[18:19], v[6:7] op_sel_hi:[1,0]
    v_pk_mul_f32 v[20:21], v[20:21], v[6:7] op_sel_hi:[1,0]
    v_pk_mul_f32 v[22:23], v[22:23], v[6:7] op_sel_hi:[1,0]
    v_pk_mul_f32 v[24:25], v[24:25], v[6:7] op_sel_hi:[1,0]
    v_pk_mul_f32 v[26:27], v[26:27], v[6:7] op_sel_hi:[1,0]
    v_pk_mul_f32 v[28:29], v[28:29], v[6:7] op_sel_hi:[1,0]
    v_pk_mul_f32 v[30:31], v[30:31], v[6:7] op_sel_hi:[1,0]
    v_cvt_pk_bf16_f32 v112, v16, v17
    v_cvt_pk_bf16_f32 v113, v18, v19
    v_cvt_pk_bf16_f32 v114, v20, v21
    v_cvt_pk_bf16_f32 v115, v22, v23
    v_cvt_pk_bf16_f32 v116, v24, v25
    v_cvt_pk_bf16_f32 v117, v26, v27
    v_cvt_pk_bf16_f32 v118, v28, v29
    v_cvt_pk_bf16_f32 v119, v30, v31
    ds_write_b128 v12, v[112:115]
    ds_write_b128 v12, v[116:119] offset:4608
    s_lshl_b32 s20, s19, 2
    s_add_u32 s21, s20, s52
    s_mul_i32 s21, s21, 1152
    s_add_u32 s21, s21, 124928
    v_add_u32 v16, s21, v1
    v_lshlrev_b32 v17, 2, v2
    v_add_u32 v17, s21, v17
    s_mul_i32 s31, s19, 28416
    s_add_u32 s31, s31, 0
    s_mul_i32 s24, s52, 2368
    s_add_u32 s24, s24, s31
    s_movk_i32 s39, 304
    s_lshl_b32 s29, s16, 2
    s_add_u32 s29, s29, s52
    s_add_u32 s32, s29, 1
    s_min_u32 s32, s32, 9
    v_add_u32 v12, s24, v1
    v_lshlrev_b32 v13, 2, v2
    v_add_u32 v13, s24, v13
    v_min_u32 v14, 18, v2
    v_lshlrev_b32 v14, 4, v14
    v_mad_u32_u24 v14, v3, s39, v14
    v_add_u32 v14, s24, v14
    v_mov_b32 v5, 0xdddddddd
    v_mov_b32 v7, 0
    v_mov_b32 v29, 0
    v_mov_b32 v31, 0
    v_mov_b32 v15, 0xf149f2ca
    v_cmp_eq_u32 vcc, 0, v3
    v_cndmask_b32 v48, v15, 0, s[64:65]
    v_cndmask_b32 v49, v15, 0, s[66:67]
    v_cndmask_b32 v50, v15, 0, s[68:69]
    v_cndmask_b32 v51, v15, 0, s[70:71]
    v_cndmask_b32 v52, v15, 0, s[72:73]
    v_cndmask_b32 v53, v15, 0, s[74:75]
    v_cndmask_b32 v54, v15, 0, s[76:77]
    v_cndmask_b32 v55, v15, 0, s[78:79]
    v_cndmask_b32 v56, v15, 0, s[80:81]
    v_cndmask_b32 v57, v15, 0, s[82:83]
    v_cndmask_b32 v58, v15, 0, s[84:85]
    v_cndmask_b32 v59, v15, 0, s[86:87]
    v_cndmask_b32 v60, v15, 0, s[88:89]
    v_cndmask_b32 v61, v15, 0, s[90:91]
    v_cndmask_b32 v62, v15, 0, s[92:93]
    v_cndmask_b32 v63, v15, 0, s[94:95]
    v_mov_b32 v80, 0
    v_mov_b32 v81, 0
    v_mov_b32 v82, 0
    v_mov_b32 v83, 0
    v_mov_b32 v84, 0
    v_mov_b32 v85, 0
    v_mov_b32 v86, 0
    v_mov_b32 v87, 0
    v_mov_b32 v88, 0
    v_mov_b32 v89, 0
    v_mov_b32 v90, 0
    v_mov_b32 v91, 0
    v_mov_b32 v92, 0
    v_mov_b32 v93, 0
    v_mov_b32 v94, 0
    v_mov_b32 v95, 0
    s_lshl_b32 s56, s15, 2
    s_add_u32 s56, s56, s13
    s_mul_i32 s56, s56, 36864
    s_add_u32 s56, s56, 0
    s_add_u32 s56, s56, s97
    s_and_b32 s57, s15, 1
    s_add_u32 s57, s57, 16
    s_lshl_b32 s57, s57, 2
    s_add_u32 s57, s57, s13
    s_mul_i32 s57, s57, 9216
    s_add_u32 s57, s57, 1403904
    s_lshl_b32 s58, s15, 2
    s_add_u32 s58, s58, s13
    s_lshl_b32 s58, s58, 11
    s_add_u32 s58, s58, s48
    s_add_u32 s58, s58, s40
    s_add_u32 s58, s58, 0
    s_and_b32 s59, s15, 1
    s_add_u32 s59, s59, 16
    s_lshl_b32 s59, s59, 1
    s_lshr_b32 s21, s13, 1
    s_add_u32 s59, s59, s21
    s_lshl_b32 s59, s59, 10
    s_and_b32 s21, s13, 1
    s_lshl_b32 s21, s21, 3
    s_add_u32 s59, s59, s21
    s_add_u32 s59, s59, s48
    s_add_u32 s59, s59, s40
    s_add_u32 s59, s59, 0
    s_cmp_eq_u32 s19, 0
    s_cselect_b32 s30, s59, s58
    s_lshl_b32 s33, s16, 7
    s_add_u32 s33, s33, 0
    s_lshl_b32 s27, s17, 1
    s_add_u32 s27, s27, s19
    s_mul_i32 s28, s29, 36864
    s_add_u32 s28, s28, s46
    s_lshl_b32 s29, s17, 3
    s_add_u32 s29, s29, s12
    s_add_u32 s29, s29, s33
    s_lshl_b32 s20, s27, 10
    s_add_u32 s20, s20, s28
    s_lshr_b32 s21, s27, 3
    s_add_u32 s21, s21, 32
    s_lshl_b32 s21, s21, 10
    s_add_u32 s21, s21, s28
    s_bfe_u32 s22, s27, 0x10002
    s_lshl_b32 s22, s22, 9
    s_add_u32 s21, s21, s22
    s_and_b32 s22, s27, 3
    s_lshl_b32 s22, s22, 2
    s_add_u32 s28, s21, s22
    s_mov_b32 s27, s20
    s_waitcnt lgkmcnt(0)
    s_barrier
QB_DONE:
    ds_read_b128 v[8:11], v16
    ds_read_b32 v6, v17 offset:1024
    ds_read_b128 v[20:23], v12 offset:18944
    ds_read_b32 v28, v13 offset:19968
    ds_read_b128 v[24:27], v12 offset:16576
    ds_read_b32 v30, v13 offset:17600
    ds_read_b128 v[32:35], v14 offset:20096
    ds_read_b128 v[36:39], v14 offset:20704
    v_cmp_eq_u32 vcc, 0, v3
    s_waitcnt lgkmcnt(4)
    s_nop 0
    v_cndmask_b32 v6, 0, v6, vcc
    v_mfma_f32_32x32x16_bf16 v[48:63], v[20:23], v[8:11], v[48:63]
    s_nop 0
    v_mfma_f32_32x32x8_bf16 v[48:63], v[28:29], v[6:7], v[48:63]
    buffer_load_dwordx4 v[96:99], v1, s[4:7], s30 offen sc1
    buffer_load_dwordx4 v[100:103], v1, s[4:7], s30 offen offset:1024 sc1
    s_waitcnt lgkmcnt(0)
    s_setprio 3
    s_cmp_le_u32 s32, 1
    s_cbranch_scc1 AB_DRAIN0F
    s_cmp_eq_u32 s19, 0
    ds_read_b128 v[20:23], v12 offset:14208
    ds_read_b32 v28, v13 offset:15232
    s_nop 2
    v_exp_f32 v48, v48
    v_exp_f32 v49, v49
    ds_read_b128 v[40:43], v14 offset:17728
    ds_read_b128 v[44:47], v14 offset:18336
    v_exp_f32 v50, v50
    v_exp_f32 v51, v51
    v_exp_f32 v52, v52
    v_mfma_f32_32x32x8_bf16 v[64:79], v[30:31], v[6:7], 0
    s_cbranch_scc0 WQ_96
    buffer_load_dwordx4 v[108:111], v1, s[4:7], s57 offen offset:0
    buffer_load_dwordx4 v[112:115], v1, s[4:7], s57 offen offset:1024
WQ_96:
    v_exp_f32 v53, v53
    v_exp_f32 v54, v54
    v_exp_f32 v55, v55
    v_mfma_f32_32x32x16_bf16 v[64:79], v[24:27], v[8:11], v[64:79]
    v_exp_f32 v56, v56
    v_exp_f32 v57, v57
    v_exp_f32 v58, v58
    v_exp_f32 v59, v59
    v_smfmac_f32_32x32x32_bf16 v[80:95], v[32:35], v[48:55], v5
    s_cbranch_scc0 WQ_97
    buffer_load_dwordx4 v[116:119], v1, s[4:7], s57 offen offset:2048
    buffer_load_dwordx4 v[120:123], v1, s[4:7], s57 offen offset:3072
    s_add_u32 s57, s57, 4096
    s_cmp_eq_u32 s19, 0
WQ_97:
    v_exp_f32 v60, v60
    v_exp_f32 v61, v61
    v_exp_f32 v62, v62
    v_exp_f32 v63, v63
    s_waitcnt lgkmcnt(0)
    s_cmp_le_u32 s32, 2
    s_cbranch_scc1 AB_DRAIN1
    s_cmp_eq_u32 s19, 0
    ds_read_b128 v[24:27], v12 offset:11840
    ds_read_b32 v30, v13 offset:12864
    v_exp_f32 v64, v64
    v_exp_f32 v65, v65
    v_smfmac_f32_32x32x32_bf16 v[80:95], v[36:39], v[56:63], v5
    ds_read_b128 v[32:35], v14 offset:15360
    ds_read_b128 v[36:39], v14 offset:15968
    v_exp_f32 v66, v66
    v_exp_f32 v67, v67
    v_exp_f32 v68, v68
    v_mfma_f32_32x32x8_bf16 v[48:63], v[28:29], v[6:7], 0
    s_cbranch_scc0 WQ_98
    buffer_load_dwordx4 v[124:127], v1, s[4:7], s57 offen offset:0
    buffer_load_dwordx4 v[128:131], v1, s[4:7], s57 offen offset:1024
WQ_98:
    v_exp_f32 v69, v69
    v_exp_f32 v70, v70
    v_exp_f32 v71, v71
    v_mfma_f32_32x32x16_bf16 v[48:63], v[20:23], v[8:11], v[48:63]
    v_exp_f32 v72, v72
    v_exp_f32 v73, v73
    v_exp_f32 v74, v74
    v_exp_f32 v75, v75
    v_smfmac_f32_32x32x32_bf16 v[80:95], v[40:43], v[64:71], v5
    s_cbranch_scc0 WQ_99
    buffer_load_dwordx4 v[132:135], v1, s[4:7], s57 offen offset:2048
    buffer_load_dwordx4 v[136:139], v1, s[4:7], s57 offen offset:3072
    s_add_u32 s57, s57, 4096
    s_cmp_eq_u32 s19, 0
WQ_99:
    v_exp_f32 v76, v76
    v_exp_f32 v77, v77
    v_exp_f32 v78, v78
    v_exp_f32 v79, v79
    s_waitcnt lgkmcnt(0)
    s_cmp_le_u32 s32, 3
    s_cbranch_scc1 AB_DRAIN0
    s_cmp_eq_u32 s19, 0
    ds_read_b128 v[20:23], v12 offset:9472
    ds_read_b32 v28, v13 offset:10496
    v_exp_f32 v48, v48
    v_exp_f32 v49, v49
    v_smfmac_f32_32x32x32_bf16 v[80:95], v[44:47], v[72:79], v5
    ds_read_b128 v[40:43], v14 offset:12992
    ds_read_b128 v[44:47], v14 offset:13600
    v_exp_f32 v50, v50
    v_exp_f32 v51, v51
    v_exp_f32 v52, v52
    v_mfma_f32_32x32x8_bf16 v[64:79], v[30:31], v[6:7], 0
    s_cbranch_scc0 WQ_100
    buffer_load_dwordx4 v[140:143], v1, s[4:7], s57 offen offset:0
    buffer_load_dwordx4 v[252:255], v1, s[4:7], s56 offen offset:0
WQ_100:
    v_exp_f32 v53, v53
    v_exp_f32 v54, v54
    v_exp_f32 v55, v55
    v_mfma_f32_32x32x16_bf16 v[64:79], v[24:27], v[8:11], v[64:79]
    v_exp_f32 v56, v56
    v_exp_f32 v57, v57
    v_exp_f32 v58, v58
    v_exp_f32 v59, v59
    v_smfmac_f32_32x32x32_bf16 v[80:95], v[32:35], v[48:55], v5
    s_cbranch_scc0 WQ_101
    buffer_load_dwordx4 v[248:251], v1, s[4:7], s56 offen offset:1024
    buffer_load_dwordx4 v[244:247], v1, s[4:7], s56 offen offset:2048
WQ_101:
    v_exp_f32 v60, v60
    v_exp_f32 v61, v61
    v_exp_f32 v62, v62
    v_exp_f32 v63, v63
    s_waitcnt lgkmcnt(0)
    s_setprio 2
    s_cmp_le_u32 s32, 4
    s_cbranch_scc1 AB_DRAIN1
    s_cmp_eq_u32 s19, 0
    ds_read_b128 v[24:27], v12 offset:7104
    ds_read_b32 v30, v13 offset:8128
    v_exp_f32 v64, v64
    v_exp_f32 v65, v65
    v_smfmac_f32_32x32x32_bf16 v[80:95], v[36:39], v[56:63], v5
    ds_read_b128 v[32:35], v14 offset:10624
    ds_read_b128 v[36:39], v14 offset:11232
    v_exp_f32 v66, v66
    v_exp_f32 v67, v67
    v_exp_f32 v68, v68
    v_mfma_f32_32x32x8_bf16 v[48:63], v[28:29], v[6:7], 0
    s_cbranch_scc0 WQ_102
    buffer_load_dwordx4 v[240:243], v1, s[4:7], s56 offen offset:3072
    s_add_u32 s56, s56, 4096
    s_cmp_eq_u32 s19, 0
    buffer_load_dwordx4 v[236:239], v1, s[4:7], s56 offen offset:0
WQ_102:
    v_exp_f32 v69, v69
    v_exp_f32 v70, v70
    v_exp_f32 v71, v71
    v_mfma_f32_32x32x16_bf16 v[48:63], v[20:23], v[8:11], v[48:63]
    v_exp_f32 v72, v72
    v_exp_f32 v73, v73
    v_exp_f32 v74, v74
    v_exp_f32 v75, v75
    v_smfmac_f32_32x32x32_bf16 v[80:95], v[40:43], v[64:71], v5
    s_cbranch_scc0 WQ_103
    buffer_load_dwordx4 v[232:235], v1, s[4:7], s56 offen offset:1024
    buffer_load_dwordx4 v[228:231], v1, s[4:7], s56 offen offset:2048
WQ_103:
    v_exp_f32 v76, v76
    v_exp_f32 v77, v77
    v_exp_f32 v78, v78
    v_exp_f32 v79, v79
    s_waitcnt lgkmcnt(0)
    s_cmp_le_u32 s32, 5
    s_cbranch_scc1 AB_DRAIN0
    s_cmp_eq_u32 s19, 0
    ds_read_b128 v[20:23], v12 offset:4736
    ds_read_b32 v28, v13 offset:5760
    v_exp_f32 v48, v48
    v_exp_f32 v49, v49
    v_smfmac_f32_32x32x32_bf16 v[80:95], v[44:47], v[72:79], v5
    ds_read_b128 v[40:43], v14 offset:8256
    ds_read_b128 v[44:47], v14 offset:8864
    v_exp_f32 v50, v50
    v_exp_f32 v51, v51
    v_exp_f32 v52, v52
    v_mfma_f32_32x32x8_bf16 v[64:79], v[30:31], v[6:7], 0
    s_cbranch_scc0 WQ_104
    buffer_load_dwordx4 v[224:227], v1, s[4:7], s56 offen offset:3072
    s_add_u32 s56, s56, 4096
    s_cmp_eq_u32 s19, 0
    buffer_load_dwordx4 v[220:223], v1, s[4:7], s56 offen offset:0
WQ_104:
    v_exp_f32 v53, v53
    v_exp_f32 v54, v54
    v_exp_f32 v55, v55
    v_mfma_f32_32x32x16_bf16 v[64:79], v[24:27], v[8:11], v[64:79]
    v_exp_f32 v56, v56
    v_exp_f32 v57, v57
    v_exp_f32 v58, v58
    v_exp_f32 v59, v59
    v_smfmac_f32_32x32x32_bf16 v[80:95], v[32:35], v[48:55], v5
    s_cbranch_scc0 WQ_105
    buffer_load_dwordx4 v[216:219], v1, s[4:7], s56 offen offset:1024
    buffer_load_dwordx4 v[212:215], v1, s[4:7], s56 offen offset:2048
WQ_105:
    v_exp_f32 v60, v60
    v_exp_f32 v61, v61
    v_exp_f32 v62, v62
    v_exp_f32 v63, v63
    s_waitcnt lgkmcnt(0)
    s_cmp_le_u32 s32, 6
    s_cbranch_scc1 AB_DRAIN1
    s_cmp_eq_u32 s19, 0
    ds_read_b128 v[24:27], v12 offset:2368
    ds_read_b32 v30, v13 offset:3392
    v_exp_f32 v64, v64
    v_exp_f32 v65, v65
    v_smfmac_f32_32x32x32_bf16 v[80:95], v[36:39], v[56:63], v5
    ds_read_b128 v[32:35], v14 offset:5888
    ds_read_b128 v[36:39], v14 offset:6496
    v_exp_f32 v66, v66
    v_exp_f32 v67, v67
    v_exp_f32 v68, v68
    v_mfma_f32_32x32x8_bf16 v[48:63], v[28:29], v[6:7], 0
    s_cbranch_scc0 WQ_106
    buffer_load_dwordx4 v[208:211], v1, s[4:7], s56 offen offset:3072
    s_add_u32 s56, s56, 4096
    s_cmp_eq_u32 s19, 0
    buffer_load_dwordx4 v[204:207], v1, s[4:7], s56 offen offset:0
WQ_106:
    v_exp_f32 v69, v69
    v_exp_f32 v70, v70
    v_exp_f32 v71, v71
    v_mfma_f32_32x32x16_bf16 v[48:63], v[20:23], v[8:11], v[48:63]
    v_exp_f32 v72, v72
    v_exp_f32 v73, v73
    v_exp_f32 v74, v74
    v_exp_f32 v75, v75
    v_smfmac_f32_32x32x32_bf16 v[80:95], v[40:43], v[64:71], v5
    s_cbranch_scc0 WQ_107
    buffer_load_dwordx4 v[200:203], v1, s[4:7], s56 offen offset:1024
    buffer_load_dwordx4 v[196:199], v1, s[4:7], s56 offen offset:2048
WQ_107:
    v_exp_f32 v76, v76
    v_exp_f32 v77, v77
    v_exp_f32 v78, v78
    v_exp_f32 v79, v79
    s_waitcnt lgkmcnt(0)
    s_setprio 1
    s_cmp_le_u32 s32, 7
    s_cbranch_scc1 AB_DRAIN0
    s_cmp_eq_u32 s19, 0
    ds_read_b128 v[20:23], v12 offset:0
    ds_read_b32 v28, v13 offset:1024
    v_exp_f32 v48, v48
    v_exp_f32 v49, v49
    v_smfmac_f32_32x32x32_bf16 v[80:95], v[44:47], v[72:79], v5
    ds_read_b128 v[40:43], v14 offset:3520
    ds_read_b128 v[44:47], v14 offset:4128
    v_exp_f32 v50, v50
    v_exp_f32 v51, v51
    v_exp_f32 v52, v52
    v_mfma_f32_32x32x8_bf16 v[64:79], v[30:31], v[6:7], 0
    s_cbranch_scc0 WQ_108
    buffer_load_dwordx4 v[192:195], v1, s[4:7], s56 offen offset:3072
    s_add_u32 s56, s56, 4096
    s_cmp_eq_u32 s19, 0
    buffer_load_dwordx4 v[188:191], v1, s[4:7], s56 offen offset:0
WQ_108:
    v_exp_f32 v53, v53
    v_exp_f32 v54, v54
    v_exp_f32 v55, v55
    v_mfma_f32_32x32x16_bf16 v[64:79], v[24:27], v[8:11], v[64:79]
    v_exp_f32 v56, v56
    v_exp_f32 v57, v57
    v_exp_f32 v58, v58
    v_exp_f32 v59, v59
    v_smfmac_f32_32x32x32_bf16 v[80:95], v[32:35], v[48:55], v5
    s_cbranch_scc0 WQ_109
    buffer_load_dwordx4 v[184:187], v1, s[4:7], s56 offen offset:1024
    buffer_load_dwordx4 v[180:183], v1, s[4:7], s56 offen offset:2048
WQ_109:
    v_exp_f32 v60, v60
    v_exp_f32 v61, v61
    v_exp_f32 v62, v62
    v_exp_f32 v63, v63
    s_waitcnt lgkmcnt(0)
    s_cmp_le_u32 s32, 8
    s_cbranch_scc1 AB_DRAIN1
    s_cmp_eq_u32 s19, 0
    v_exp_f32 v64, v64
    v_exp_f32 v65, v65
    v_smfmac_f32_32x32x32_bf16 v[80:95], v[36:39], v[56:63], v5
    ds_read_b128 v[32:35], v14 offset:1152
    ds_read_b128 v[36:39], v14 offset:1760
    v_exp_f32 v66, v66
    v_exp_f32 v67, v67
    v_exp_f32 v68, v68
    v_cndmask_b32 v48, 0, v15, s[64:65]
    v_cndmask_b32 v49, 0, v15, s[66:67]
    v_cndmask_b32 v50, 0, v15, s[68:69]
    v_cndmask_b32 v51, 0, v15, s[70:71]
    v_cndmask_b32 v52, 0, v15, s[72:73]
    v_cndmask_b32 v53, 0, v15, s[74:75]
    v_cndmask_b32 v54, 0, v15, s[76:77]
    v_cndmask_b32 v55, 0, v15, s[78:79]
    v_cndmask_b32 v56, 0, v15, s[80:81]
    v_cndmask_b32 v57, 0, v15, s[82:83]
    v_cndmask_b32 v58, 0, v15, s[84:85]
    v_cndmask_b32 v59, 0, v15, s[86:87]
    v_cndmask_b32 v60, 0, v15, s[88:89]
    v_cndmask_b32 v61, 0, v15, s[90:91]
    v_cndmask_b32 v62, 0, v15, s[92:93]
    v_cndmask_b32 v63, 0, v15, s[94:95]
    s_nop 1
    v_mfma_f32_32x32x8_bf16 v[48:63], v[28:29], v[6:7], v[48:63]
    v_exp_f32 v69, v69
    v_exp_f32 v70, v70
    v_exp_f32 v71, v71
    v_mfma_f32_32x32x16_bf16 v[48:63], v[20:23], v[8:11], v[48:63]
    v_exp_f32 v72, v72
    v_exp_f32 v73, v73
    v_exp_f32 v74, v74
    v_exp_f32 v75, v75
    v_smfmac_f32_32x32x32_bf16 v[80:95], v[40:43], v[64:71], v5
    v_exp_f32 v76, v76
    v_exp_f32 v77, v77
    v_exp_f32 v78, v78
    v_exp_f32 v79, v79
    s_waitcnt lgkmcnt(0)
AB_DRAIN0:
    s_setprio 0
    s_nop 0
    v_exp_f32 v48, v48
    v_exp_f32 v49, v49
    v_smfmac_f32_32x32x32_bf16 v[80:95], v[44:47], v[72:79], v5
    v_exp_f32 v50, v50
    v_exp_f32 v51, v51
    v_exp_f32 v52, v52
    v_exp_f32 v53, v53
    v_exp_f32 v54, v54
    v_exp_f32 v55, v55
    v_exp_f32 v56, v56
    v_exp_f32 v57, v57
    v_smfmac_f32_32x32x32_bf16 v[80:95], v[32:35], v[48:55], v5
    v_exp_f32 v58, v58
    v_exp_f32 v59, v59
    v_exp_f32 v60, v60
    v_exp_f32 v61, v61
    v_exp_f32 v62, v62
    v_exp_f32 v63, v63
    s_nop 1
    v_smfmac_f32_32x32x32_bf16 v[80:95], v[36:39], v[56:63], v5
    s_branch AB_FIN
AB_DRAIN0F:
    s_setprio 0
    s_nop 4
    v_exp_f32 v48, v48
    v_exp_f32 v49, v49
    v_exp_f32 v50, v50
    v_exp_f32 v51, v51
    v_exp_f32 v52, v52
    v_exp_f32 v53, v53
    v_exp_f32 v54, v54
    v_exp_f32 v55, v55
    v_exp_f32 v56, v56
    v_exp_f32 v57, v57
    v_smfmac_f32_32x32x32_bf16 v[80:95], v[32:35], v[48:55], v5
    v_exp_f32 v58, v58
    v_exp_f32 v59, v59
    v_exp_f32 v60, v60
    v_exp_f32 v61, v61
    v_exp_f32 v62, v62
    v_exp_f32 v63, v63
    s_nop 1
    v_smfmac_f32_32x32x32_bf16 v[80:95], v[36:39], v[56:63], v5
    s_branch AB_FIN
AB_DRAIN1:
    s_setprio 0
    v_exp_f32 v64, v64
    v_exp_f32 v65, v65
    v_smfmac_f32_32x32x32_bf16 v[80:95], v[36:39], v[56:63], v5
    v_exp_f32 v66, v66
    v_exp_f32 v67, v67
    v_exp_f32 v68, v68
    v_exp_f32 v69, v69
    v_exp_f32 v70, v70
    v_exp_f32 v71, v71
    v_exp_f32 v72, v72
    v_exp_f32 v73, v73
    v_smfmac_f32_32x32x32_bf16 v[80:95], v[40:43], v[64:71], v5
    v_exp_f32 v74, v74
    v_exp_f32 v75, v75
    v_exp_f32 v76, v76
    v_exp_f32 v77, v77
    v_exp_f32 v78, v78
    v_exp_f32 v79, v79
    s_nop 1
    v_smfmac_f32_32x32x32_bf16 v[80:95], v[44:47], v[72:79], v5
AB_FIN:
    s_cmp_lt_u32 s32, 9
    s_cbranch_scc0 AB_OUT
    s_cmp_eq_u32 s19, 0
    s_cbranch_scc0 AB_OUT
    s_and_b32 s57, s15, 1
    s_add_u32 s57, s57, 16
    s_lshl_b32 s57, s57, 2
    s_add_u32 s57, s57, s13
    s_mul_i32 s57, s57, 9216
    s_add_u32 s57, s57, 1403904
    s_mov_b32 s21, s57
    buffer_load_dwordx4 v[108:111], v1, s[4:7], s21 offen offset:0
    buffer_load_dwordx4 v[112:115], v1, s[4:7], s21 offen offset:1024
    buffer_load_dwordx4 v[116:119], v1, s[4:7], s21 offen offset:2048
    buffer_load_dwordx4 v[120:123], v1, s[4:7], s21 offen offset:3072
    s_add_u32 s21, s21, 4096
    buffer_load_dwordx4 v[124:127], v1, s[4:7], s21 offen offset:0
    buffer_load_dwordx4 v[128:131], v1, s[4:7], s21 offen offset:1024
    buffer_load_dwordx4 v[132:135], v1, s[4:7], s21 offen offset:2048
    buffer_load_dwordx4 v[136:139], v1, s[4:7], s21 offen offset:3072
    s_add_u32 s21, s21, 4096
    buffer_load_dwordx4 v[140:143], v1, s[4:7], s21 offen offset:0
    s_lshl_b32 s20, s15, 2
    s_add_u32 s20, s20, s13
    s_mul_i32 s20, s20, 36864
    s_add_u32 s20, s20, 0
    s_add_u32 s20, s20, s97
    s_mov_b32 s21, s20
    buffer_load_dwordx4 v[252:255], v1, s[4:7], s21 offen offset:0
    buffer_load_dwordx4 v[248:251], v1, s[4:7], s21 offen offset:1024
    buffer_load_dwordx4 v[244:247], v1, s[4:7], s21 offen offset:2048
    buffer_load_dwordx4 v[240:243], v1, s[4:7], s21 offen offset:3072
    s_add_u32 s21, s21, 4096
    buffer_load_dwordx4 v[236:239], v1, s[4:7], s21 offen offset:0
    buffer_load_dwordx4 v[232:235], v1, s[4:7], s21 offen offset:1024
    buffer_load_dwordx4 v[228:231], v1, s[4:7], s21 offen offset:2048
    buffer_load_dwordx4 v[224:227], v1, s[4:7], s21 offen offset:3072
    s_add_u32 s21, s21, 4096
    buffer_load_dwordx4 v[220:223], v1, s[4:7], s21 offen offset:0
    buffer_load_dwordx4 v[216:219], v1, s[4:7], s21 offen offset:1024
    buffer_load_dwordx4 v[212:215], v1, s[4:7], s21 offen offset:2048
    buffer_load_dwordx4 v[208:211], v1, s[4:7], s21 offen offset:3072
    s_add_u32 s21, s21, 4096
    buffer_load_dwordx4 v[204:207], v1, s[4:7], s21 offen offset:0
    buffer_load_dwordx4 v[200:203], v1, s[4:7], s21 offen offset:1024
    buffer_load_dwordx4 v[196:199], v1, s[4:7], s21 offen offset:2048
    buffer_load_dwordx4 v[192:195], v1, s[4:7], s21 offen offset:3072
    s_add_u32 s21, s21, 4096
    buffer_load_dwordx4 v[188:191], v1, s[4:7], s21 offen offset:0
    buffer_load_dwordx4 v[184:187], v1, s[4:7], s21 offen offset:1024
    buffer_load_dwordx4 v[180:183], v1, s[4:7], s21 offen offset:2048
AB_OUT:
    s_nop 9
    v_rcp_f32 v30, v90
    s_nop 0
    v_pk_mul_f32 v[20:21], v[80:81], v[30:31] op_sel_hi:[1,0]
    v_pk_mul_f32 v[22:23], v[82:83], v[30:31] op_sel_hi:[1,0]
    v_pk_mul_f32 v[24:25], v[84:85], v[30:31] op_sel_hi:[1,0]
    v_pk_mul_f32 v[26:27], v[86:87], v[30:31] op_sel_hi:[1,0]
    v_pk_mul_f32 v[28:29], v[88:89], v[30:31] op_sel_hi:[1,0]
    v_cvt_pk_bf16_f32 v20, v20, v21
    v_cvt_pk_bf16_f32 v21, v22, v23
    v_cvt_pk_bf16_f32 v22, v24, v25
    v_cvt_pk_bf16_f32 v23, v26, v27
    v_cvt_pk_bf16_f32 v24, v28, v29
    s_cmp_eq_u32 s55, 0
    s_cbranch_scc1 LS_110
    buffer_store_dwordx4 v[20:23], v1, s[4:7], s27 offen
    s_mov_b32 exec_hi, 0
    buffer_store_dword v24, v1, s[4:7], s28 offen
    s_mov_b64 exec, -1
    s_branch LD_111
LS_110:
    buffer_store_dwordx4 v[20:23], v1, s[4:7], s27 offen sc1
    s_mov_b32 exec_hi, 0
    buffer_store_dword v24, v1, s[4:7], s28 offen sc1
    s_mov_b64 exec, -1
LD_111:
    v_max3_f32 v32, |v80|, |v81|, |v82|
    v_max3_f32 v33, |v83|, |v84|, |v85|
    v_max3_f32 v34, |v86|, |v87|, |v88|
    v_add_f32 v35, v80, v81
    v_add_f32 v36, v82, v83
    v_add_f32 v35, v35, v84
    v_add_f32 v36, v36, v85
    v_add_f32 v35, v35, v86
    v_add_f32 v36, v36, v87
    v_add_f32 v35, v35, v88
    v_add_f32 v36, v36, v89
    v_max3_f32 v32, v32, v33, v34
    v_max_f32 v32, v32, |v89|
    v_mov_b32 v33, 0x7f000000
    v_mov_b32 v34, 0x5f800000
    v_cmp_lt_f32 s[20:21], v32, v33
    v_cmp_o_f32 s[22:23], v35, v36
    v_cmp_le_f32 s[24:25], v90, v34
    v_cmp_le_f32 vcc, 0x21800000, v90
    s_and_b64 s[20:21], s[20:21], s[22:23]
    s_and_b64 s[24:25], s[24:25], vcc
    s_and_b64 s[20:21], s[20:21], s[24:25]
    s_cmp_eq_u64 s[20:21], -1
    s_cbranch_scc0 AB_SLOW
AB_ST:
    v_mov_b32 v32, 1
    v_mov_b32 v33, s29
    s_waitcnt vmcnt(0)
    s_mov_b64 exec, 1
    s_cmp_eq_u32 s55, 0
    s_cbranch_scc1 LS_112
    buffer_store_byte v32, v33, s[4:7], s42 offen
    s_branch LD_113
LS_112:
    buffer_store_byte v32, v33, s[4:7], s42 offen sc1
LD_113:
    s_mov_b64 exec, -1
    s_cmp_eq_u32 s19, 1
    s_cbranch_scc1 OB_FULL
    s_setprio 2
    v_and_b32 v20, 31, v0
    v_lshlrev_b32 v20, 2, v20
    v_add_u32 v20, s33, v20
    s_mul_i32 s25, s13, 9216
    s_add_u32 s24, s46, s48
    s_add_u32 s24, s24, s25
    s_add_u32 s25, s25, 124928
    v_add_u32 v19, s25, v1
    v_mov_b32 v8, 0
    s_lshl_b32 s20, s13, 2
    s_add_u32 s20, s20, 163328
    v_mov_b32 v22, s20
    v_mov_b32 v23, 0
    ds_write_b32 v22, v23
    s_mov_b32 s38, 0
POLL_114:
    buffer_load_dword v21, v20, s[4:7], s42 offen sc1
    s_waitcnt vmcnt(0)
    v_cmp_ne_u32 vcc, 0x01010101, v21
    s_cbranch_vccz POLLD_115
    s_add_u32 s38, s38, 1
    s_cmp_lt_u32 s38, 200000
    s_cbranch_scc1 POLL_114
POLLD_115:
    s_mov_b32 m0, s25
    s_nop 0
    buffer_load_dwordx4 v1, s[4:7], s24 offen offset:0 sc1 lds
    buffer_load_dwordx4 v1, s[4:7], s24 offen offset:1024 sc1 lds
    buffer_load_dwordx4 v1, s[4:7], s24 offen offset:2048 sc1 lds
    buffer_load_dwordx4 v1, s[4:7], s24 offen offset:3072 sc1 lds
    s_add_u32 s24, s24, 4096
    s_add_u32 s25, s25, 4096
    s_mov_b32 m0, s25
    s_nop 0
    buffer_load_dwordx4 v1, s[4:7], s24 offen offset:0 sc1 lds
    buffer_load_dwordx4 v1, s[4:7], s24 offen offset:1024 sc1 lds
    buffer_load_dwordx4 v1, s[4:7], s24 offen offset:2048 sc1 lds
    buffer_load_dwordx4 v1, s[4:7], s24 offen offset:3072 sc1 lds
    s_add_u32 s24, s24, 4096
    s_add_u32 s25, s25, 4096
    s_mov_b32 m0, s25
    s_nop 0
    buffer_load_dwordx4 v1, s[4:7], s24 offen offset:0 sc1 lds
    s_waitcnt vmcnt(6) lgkmcnt(0)
    s_barrier
    s_cmp_lt_u32 s15, 2
    s_cbranch_scc1 OB_S2
    s_waitcnt vmcnt(0)
    s_barrier
    s_branch OB_S3
OB_S2:
    ds_read_b128 v[40:43], v19 offset:0
    ds_read_b128 v[44:47], v19 offset:1024
    ds_read_b128 v[48:51], v19 offset:2048
    s_waitcnt lgkmcnt(2)
    v_mfma_f32_32x32x16_bf16 v[24:39], v[108:111], v[40:43], 0
    s_waitcnt lgkmcnt(1)
    v_mfma_f32_32x32x16_bf16 v[24:39], v[112:115], v[44:47], v[24:39]
    s_waitcnt lgkmcnt(0)
    v_mfma_f32_32x32x16_bf16 v[24:39], v[116:119], v[48:51], v[24:39]
    s_waitcnt vmcnt(0)
    s_barrier
    ds_read_b128 v[52:55], v19 offset:3072
    ds_read_b128 v[56:59], v19 offset:4096
    ds_read_b128 v[60:63], v19 offset:5120
    ds_read_b128 v[64:67], v19 offset:6144
    ds_read_b128 v[68:71], v19 offset:7168
    ds_read_b128 v[72:75], v19 offset:8192
    s_waitcnt lgkmcnt(5)
    v_mfma_f32_32x32x16_bf16 v[24:39], v[120:123], v[52:55], v[24:39]
    s_waitcnt lgkmcnt(4)
    v_mfma_f32_32x32x16_bf16 v[24:39], v[124:127], v[56:59], v[24:39]
    s_waitcnt lgkmcnt(3)
    v_mfma_f32_32x32x16_bf16 v[24:39], v[128:131], v[60:63], v[24:39]
    s_waitcnt lgkmcnt(2)
    v_mfma_f32_32x32x16_bf16 v[24:39], v[132:135], v[64:67], v[24:39]
    s_waitcnt lgkmcnt(1)
    v_mfma_f32_32x32x16_bf16 v[24:39], v[136:139], v[68:71], v[24:39]
    s_waitcnt lgkmcnt(0)
    v_mfma_f32_32x32x16_bf16 v[24:39], v[140:143], v[72:75], v[24:39]
    v_lshlrev_b32 v8, 16, v96
    v_and_b32 v9, s50, v96
    v_lshlrev_b32 v10, 16, v97
    v_and_b32 v11, s50, v97
    s_lshl_b32 s20, s13, 12
    s_add_u32 s20, s20, 108544
    v_add_u32 v19, s20, v1
    s_nop 4
    ds_write_b128 v19, v[24:27] offset:0
    ds_write_b128 v19, v[28:31] offset:1024
    ds_write_b128 v19, v[32:35] offset:2048
    ds_write_b128 v19, v[36:39] offset:3072
    s_lshl_b32 s20, s13, 10
    s_add_u32 s20, s20, 108544
    v_add_u32 v19, s20, v1
    s_lshl_b32 s20, s13, 2
    s_add_u32 s20, s20, 163328
    v_mov_b32 v12, s20
    v_mov_b32 v13, 1
    s_waitcnt lgkmcnt(0)
    ds_write_b32 v12, v13
    v_mov_b32 v12, 163328
PS_116:
    ds_read_b128 v[14:17], v12
    s_waitcnt lgkmcnt(0)
    v_and_b32 v14, v14, v15
    v_and_b32 v16, v16, v17
    v_and_b32 v14, v14, v16
    v_cmp_eq_u32 vcc, 0, v14
    s_cbranch_vccnz PS_116
    ds_read_b128 v[24:27], v19 offset:0
    ds_read_b128 v[28:31], v19 offset:4096
    ds_read_b128 v[32:35], v19 offset:8192
    ds_read_b128 v[36:39], v19 offset:12288
    s_waitcnt lgkmcnt(2)
    v_add_f32 v24, v24, v28
    v_add_f32 v25, v25, v29
    v_add_f32 v26, v26, v30
    v_add_f32 v27, v27, v31
    s_waitcnt lgkmcnt(0)
    v_add_f32 v32, v32, v36
    v_add_f32 v33, v33, v37
    v_add_f32 v34, v34, v38
    v_add_f32 v35, v35, v39
    v_add_f32 v24, v24, v32
    v_add_f32 v25, v25, v33
    v_add_f32 v26, v26, v34
    v_add_f32 v27, v27, v35
    v_add_f32 v24, v24, v8
    v_add_f32 v25, v25, v9
    v_add_f32 v26, v26, v10
    v_add_f32 v27, v27, v11
    v_cvt_pk_bf16_f32 v12, v24, v25
    v_cvt_pk_bf16_f32 v13, v26, v27
    s_cmp_eq_u32 s18, 1
    s_cbranch_scc1 OB_SF
    s_add_u32 s30, s30, 0
    s_cmp_eq_u32 s55, 0
    s_cbranch_scc1 LS_117
    buffer_store_dwordx2 v[12:13], v1, s[4:7], s30 offen
    s_branch LD_118
LS_117:
    buffer_store_dwordx2 v[12:13], v1, s[4:7], s30 offen sc1
LD_118:
    v_add_f32 v8, v24, v25
    v_add_f32 v10, v26, v27
    v_mul_f32 v9, v24, v24
    v_add_f32 v8, v8, v10
    v_fmac_f32 v9, v25, v25
    v_fmac_f32 v9, v26, v26
    v_fmac_f32 v9, v27, v27
    s_nop 1
    v_permlane32_swap_b32 v8, v9
    v_add_f32 v8, v8, v9
OB_S3:
    s_cmp_eq_u32 s18, 1
    s_cbranch_scc1 K1_FIN
    s_lshl_b32 s20, s15, 2
    s_add_u32 s20, s20, s13
    s_mul_i32 s20, s20, 36864
    s_add_u32 s20, s20, 28672
    s_add_u32 s20, s20, s97
    s_mov_b32 s21, s20
    buffer_load_dwordx4 v[140:143], v1, s[4:7], s21 offen offset:0
    buffer_load_dwordx4 v[136:139], v1, s[4:7], s21 offen offset:1024
    buffer_load_dwordx4 v[132:135], v1, s[4:7], s21 offen offset:2048
    buffer_load_dwordx4 v[128:131], v1, s[4:7], s21 offen offset:3072
    s_add_u32 s21, s21, 4096
    buffer_load_dwordx4 v[124:127], v1, s[4:7], s21 offen offset:0
    buffer_load_dwordx4 v[120:123], v1, s[4:7], s21 offen offset:1024
    buffer_load_dwordx4 v[116:119], v1, s[4:7], s21 offen offset:2048
    buffer_load_dwordx4 v[112:115], v1, s[4:7], s21 offen offset:3072
    s_setprio 0
    s_branch OB_PUB
OB_SF:
    v_mul_u32_u24 v19, 1152, v2
    v_lshl_add_u32 v19, v3, 3, v19
    s_mul_i32 s20, s14, 36864
    s_add_u32 s21, s15, 16
    s_lshl_b32 s21, s21, 6
    s_add_u32 s20, s20, s21
    s_lshl_b32 s21, s13, 4
    s_add_u32 s20, s20, s21
    buffer_store_dwordx2 v[12:13], v19, s[8:11], s20 offen
    s_branch K1_FIN
OB_FULL:
    v_add_u32 v67, 124928, v1
    v_lshlrev_b32 v24, 16, v96
    v_and_b32 v25, s50, v96
    v_lshlrev_b32 v26, 16, v97
    v_and_b32 v27, s50, v97
    v_lshlrev_b32 v28, 16, v98
    v_and_b32 v29, s50, v98
    v_lshlrev_b32 v30, 16, v99
    v_and_b32 v31, s50, v99
    v_lshlrev_b32 v32, 16, v100
    v_and_b32 v33, s50, v100
    v_lshlrev_b32 v34, 16, v101
    v_and_b32 v35, s50, v101
    v_lshlrev_b32 v36, 16, v102
    v_and_b32 v37, s50, v102
    v_lshlrev_b32 v38, 16, v103
    v_and_b32 v39, s50, v103
    s_barrier
    ds_read_b128 v[40:43], v67 offset:0
    ds_read_b128 v[44:47], v67 offset:9216
    ds_read_b128 v[48:51], v67 offset:18432
    ds_read_b128 v[52:55], v67 offset:27648
    ds_read_b128 v[56:59], v67 offset:1024
    ds_read_b128 v[60:63], v67 offset:10240
    s_waitcnt lgkmcnt(5)
    v_mfma_f32_32x32x16_bf16 v[24:39], v[252:255], v[40:43], v[24:39]
    ds_read_b128 v[40:43], v67 offset:19456
    s_waitcnt lgkmcnt(5)
    v_mfma_f32_32x32x16_bf16 v[24:39], v[216:219], v[44:47], v[24:39]
    ds_read_b128 v[44:47], v67 offset:28672
    s_waitcnt lgkmcnt(5)
    v_mfma_f32_32x32x16_bf16 v[24:39], v[180:183], v[48:51], v[24:39]
    ds_read_b128 v[48:51], v67 offset:2048
    s_waitcnt lgkmcnt(5)
    v_mfma_f32_32x32x16_bf16 v[24:39], v[144:147], v[52:55], v[24:39]
    ds_read_b128 v[52:55], v67 offset:11264
    s_waitcnt lgkmcnt(5)
    v_mfma_f32_32x32x16_bf16 v[24:39], v[248:251], v[56:59], v[24:39]
    ds_read_b128 v[56:59], v67 offset:20480
    s_waitcnt lgkmcnt(5)
    v_mfma_f32_32x32x16_bf16 v[24:39], v[212:215], v[60:63], v[24:39]
    ds_read_b128 v[60:63], v67 offset:29696
    s_waitcnt lgkmcnt(5)
    v_mfma_f32_32x32x16_bf16 v[24:39], v[176:179], v[40:43], v[24:39]
    s_waitcnt lgkmcnt(4)
    v_mfma_f32_32x32x16_bf16 v[24:39], v[140:143], v[44:47], v[24:39]
    s_waitcnt lgkmcnt(3)
    v_mfma_f32_32x32x16_bf16 v[24:39], v[244:247], v[48:51], v[24:39]
    s_waitcnt lgkmcnt(2)
    v_mfma_f32_32x32x16_bf16 v[24:39], v[208:211], v[52:55], v[24:39]
    s_waitcnt lgkmcnt(1)
    v_mfma_f32_32x32x16_bf16 v[24:39], v[172:175], v[56:59], v[24:39]
    s_waitcnt lgkmcnt(0)
    v_mfma_f32_32x32x16_bf16 v[24:39], v[136:139], v[60:63], v[24:39]
    s_barrier
    ds_read_b128 v[40:43], v67 offset:3072
    ds_read_b128 v[44:47], v67 offset:12288
    ds_read_b128 v[48:51], v67 offset:21504
    ds_read_b128 v[52:55], v67 offset:30720
    ds_read_b128 v[56:59], v67 offset:4096
    ds_read_b128 v[60:63], v67 offset:13312
    s_waitcnt lgkmcnt(5)
    v_mfma_f32_32x32x16_bf16 v[24:39], v[240:243], v[40:43], v[24:39]
    s_and_b32 s56, s15, 3
    s_add_u32 s56, s56, 16
    s_lshl_b32 s56, s56, 2
    s_add_u32 s56, s56, s13
    s_mul_i32 s56, s56, 9216
    s_add_u32 s56, s56, 0
    s_add_u32 s56, s56, s97
    ds_read_b128 v[40:43], v67 offset:22528
    s_waitcnt lgkmcnt(5)
    v_mfma_f32_32x32x16_bf16 v[24:39], v[204:207], v[44:47], v[24:39]
    ds_read_b128 v[44:47], v67 offset:31744
    s_waitcnt lgkmcnt(5)
    v_mfma_f32_32x32x16_bf16 v[24:39], v[168:171], v[48:51], v[24:39]
    buffer_load_dwordx4 v[76:79], v1, s[4:7], s56 offen offset:0
    ds_read_b128 v[48:51], v67 offset:5120
    s_waitcnt lgkmcnt(5)
    v_mfma_f32_32x32x16_bf16 v[24:39], v[132:135], v[52:55], v[24:39]
    ds_read_b128 v[52:55], v67 offset:14336
    s_waitcnt lgkmcnt(5)
    v_mfma_f32_32x32x16_bf16 v[24:39], v[236:239], v[56:59], v[24:39]
    buffer_load_dwordx4 v[80:83], v1, s[4:7], s56 offen offset:1024
    ds_read_b128 v[56:59], v67 offset:23552
    s_waitcnt lgkmcnt(5)
    v_mfma_f32_32x32x16_bf16 v[24:39], v[200:203], v[60:63], v[24:39]
    ds_read_b128 v[60:63], v67 offset:32768
    s_waitcnt lgkmcnt(5)
    v_mfma_f32_32x32x16_bf16 v[24:39], v[164:167], v[40:43], v[24:39]
    buffer_load_dwordx4 v[84:87], v1, s[4:7], s56 offen offset:2048
    ds_read_b128 v[40:43], v67 offset:6144
    s_waitcnt lgkmcnt(5)
    v_mfma_f32_32x32x16_bf16 v[24:39], v[128:131], v[44:47], v[24:39]
    ds_read_b128 v[44:47], v67 offset:15360
    s_waitcnt lgkmcnt(5)
    v_mfma_f32_32x32x16_bf16 v[24:39], v[232:235], v[48:51], v[24:39]
    buffer_load_dwordx4 v[88:91], v1, s[4:7], s56 offen offset:3072
    ds_read_b128 v[48:51], v67 offset:24576
    s_waitcnt lgkmcnt(5)
    v_mfma_f32_32x32x16_bf16 v[24:39], v[196:199], v[52:55], v[24:39]
    ds_read_b128 v[52:55], v67 offset:33792
    s_waitcnt lgkmcnt(5)
    v_mfma_f32_32x32x16_bf16 v[24:39], v[160:163], v[56:59], v[24:39]
    s_add_u32 s56, s56, 4096
    buffer_load_dwordx4 v[92:95], v1, s[4:7], s56 offen offset:0
    ds_read_b128 v[56:59], v67 offset:7168
    s_waitcnt lgkmcnt(5)
    v_mfma_f32_32x32x16_bf16 v[24:39], v[124:127], v[60:63], v[24:39]
    ds_read_b128 v[60:63], v67 offset:16384
    s_waitcnt lgkmcnt(5)
    v_mfma_f32_32x32x16_bf16 v[24:39], v[228:231], v[40:43], v[24:39]
    buffer_load_dwordx4 v[96:99], v1, s[4:7], s56 offen offset:1024
    ds_read_b128 v[40:43], v67 offset:25600
    s_waitcnt lgkmcnt(5)
    v_mfma_f32_32x32x16_bf16 v[24:39], v[192:195], v[44:47], v[24:39]
    ds_read_b128 v[44:47], v67 offset:34816
    s_waitcnt lgkmcnt(5)
    v_mfma_f32_32x32x16_bf16 v[24:39], v[156:159], v[48:51], v[24:39]
    buffer_load_dwordx4 v[100:103], v1, s[4:7], s56 offen offset:2048
    ds_read_b128 v[48:51], v67 offset:8192
    s_waitcnt lgkmcnt(5)
    v_mfma_f32_32x32x16_bf16 v[24:39], v[120:123], v[52:55], v[24:39]
    ds_read_b128 v[52:55], v67 offset:17408
    s_waitcnt lgkmcnt(5)
    v_mfma_f32_32x32x16_bf16 v[24:39], v[224:227], v[56:59], v[24:39]
    buffer_load_dwordx4 v[104:107], v1, s[4:7], s56 offen offset:3072
    ds_read_b128 v[56:59], v67 offset:26624
    s_waitcnt lgkmcnt(5)
    v_mfma_f32_32x32x16_bf16 v[24:39], v[188:191], v[60:63], v[24:39]
    ds_read_b128 v[60:63], v67 offset:35840
    s_waitcnt lgkmcnt(5)
    v_mfma_f32_32x32x16_bf16 v[24:39], v[152:155], v[40:43], v[24:39]
    s_add_u32 s56, s56, 4096
    buffer_load_dwordx4 v[108:111], v1, s[4:7], s56 offen offset:0
    s_waitcnt lgkmcnt(4)
    v_mfma_f32_32x32x16_bf16 v[24:39], v[116:119], v[44:47], v[24:39]
    s_waitcnt lgkmcnt(3)
    v_mfma_f32_32x32x16_bf16 v[24:39], v[220:223], v[48:51], v[24:39]
    s_waitcnt lgkmcnt(2)
    v_mfma_f32_32x32x16_bf16 v[24:39], v[184:187], v[52:55], v[24:39]
    s_waitcnt lgkmcnt(1)
    v_mfma_f32_32x32x16_bf16 v[24:39], v[148:151], v[56:59], v[24:39]
    s_waitcnt lgkmcnt(0)
    v_mfma_f32_32x32x16_bf16 v[24:39], v[112:115], v[60:63], v[24:39]
    s_nop 11
    v_cvt_pk_bf16_f32 v16, v24, v25
    v_cvt_pk_bf16_f32 v17, v26, v27
    v_cvt_pk_bf16_f32 v18, v28, v29
    v_cvt_pk_bf16_f32 v19, v30, v31
    v_cvt_pk_bf16_f32 v20, v32, v33
    v_cvt_pk_bf16_f32 v21, v34, v35
    v_cvt_pk_bf16_f32 v22, v36, v37
    v_cvt_pk_bf16_f32 v23, v38, v39
    s_cmp_eq_u32 s18, 1
    s_cbranch_scc1 OB_FF
    s_add_u32 s30, s30, 0
    s_cmp_eq_u32 s55, 0
    s_cbranch_scc1 LS_119
    buffer_store_dwordx4 v[16:19], v1, s[4:7], s30 offen
    buffer_store_dwordx4 v[20:23], v1, s[4:7], s30 offen offset:1024
    s_branch LD_120
LS_119:
    buffer_store_dwordx4 v[16:19], v1, s[4:7], s30 offen sc1
    buffer_store_dwordx4 v[20:23], v1, s[4:7], s30 offen offset:1024 sc1
LD_120:
    v_pk_add_f32 v[8:9], v[24:25], v[26:27]
    v_pk_mul_f32 v[10:11], v[24:25], v[24:25]
    v_pk_fma_f32 v[10:11], v[26:27], v[26:27], v[10:11]
    v_pk_add_f32 v[8:9], v[8:9], v[28:29]
    v_pk_fma_f32 v[10:11], v[28:29], v[28:29], v[10:11]
    v_pk_add_f32 v[8:9], v[8:9], v[30:31]
    v_pk_fma_f32 v[10:11], v[30:31], v[30:31], v[10:11]
    v_pk_add_f32 v[8:9], v[8:9], v[32:33]
    v_pk_fma_f32 v[10:11], v[32:33], v[32:33], v[10:11]
    v_pk_add_f32 v[8:9], v[8:9], v[34:35]
    v_pk_fma_f32 v[10:11], v[34:35], v[34:35], v[10:11]
    v_pk_add_f32 v[8:9], v[8:9], v[36:37]
    v_pk_fma_f32 v[10:11], v[36:37], v[36:37], v[10:11]
    v_pk_add_f32 v[8:9], v[8:9], v[38:39]
    v_pk_fma_f32 v[10:11], v[38:39], v[38:39], v[10:11]
    v_add_f32 v8, v8, v9
    v_add_f32 v9, v10, v11
    s_nop 1
    v_permlane32_swap_b32 v8, v9
    v_add_f32 v8, v8, v9
OB_PUB:
    s_lshl_b32 s20, s13, 8
    s_add_u32 s20, s20, 161792
    s_lshl_b32 s21, s13, 10
    s_add_u32 s21, s21, 108544
    s_cmp_eq_u32 s19, 1
    s_cselect_b32 s20, s20, s21
    v_lshlrev_b32 v10, 2, v0
    v_add_u32 v11, s20, v10
    ds_write_b32 v11, v8
    s_waitcnt lgkmcnt(0)
    s_barrier
    s_cmp_eq_u32 s12, 3
    s_cbranch_scc1 OB_PB
    s_waitcnt vmcnt(0)
    s_barrier
    s_branch OB_DONE
OB_FF:
    v_mul_u32_u24 v8, 1152, v2
    v_lshl_add_u32 v8, v3, 3, v8
    s_mul_i32 s20, s14, 36864
    s_lshl_b32 s21, s15, 2
    s_add_u32 s21, s21, s13
    s_lshl_b32 s21, s21, 6
    s_add_u32 s20, s20, s21
    buffer_store_dwordx2 v[16:17], v8, s[8:11], s20 offen offset:0
    buffer_store_dwordx2 v[18:19], v8, s[8:11], s20 offen offset:16
    buffer_store_dwordx2 v[20:21], v8, s[8:11], s20 offen offset:32
    buffer_store_dwordx2 v[22:23], v8, s[8:11], s20 offen offset:48
    s_branch K1_FIN
OB_PB:
    v_add_u32 v10, 108544, v10
    ds_read_b32 v16, v10 offset:53248
    ds_read_b32 v17, v10 offset:53504
    ds_read_b32 v18, v10 offset:53760
    ds_read_b32 v19, v10 offset:54016
    ds_read_b32 v20, v10 offset:0
    ds_read_b32 v21, v10 offset:1024
    ds_read_b32 v22, v10 offset:2048
    ds_read_b32 v23, v10 offset:3072
    s_lshl_b32 s20, s14, 10
    s_add_u32 s20, s20, s41
    s_add_u32 s20, s20, 131072
    s_lshl_b32 s21, s15, 3
    s_add_u32 s20, s20, s21
    v_lshlrev_b32 v11, 5, v2
    s_waitcnt lgkmcnt(0)
    v_add_f32 v16, v16, v17
    v_add_f32 v18, v18, v19
    v_add_f32 v20, v20, v21
    v_add_f32 v22, v22, v23
    v_add_f32 v16, v16, v18
    v_add_f32 v20, v20, v22
    v_add_f32 v16, v16, v20
    v_mov_b32 v17, v16
    s_nop 1
    v_permlane32_swap_b32 v16, v17
    v_or_b32 v17, 0x80000000, v17
    s_waitcnt vmcnt(0)
    s_barrier
    s_mov_b32 exec_hi, 0
    s_cmp_eq_u32 s55, 0
    s_cbranch_scc1 LS_121
    buffer_store_dwordx2 v[16:17], v11, s[4:7], s20 offen
    s_branch LD_122
LS_121:
    buffer_store_dwordx2 v[16:17], v11, s[4:7], s20 offen sc1
LD_122:
    s_mov_b64 exec, -1
OB_DONE:
    s_cmp_eq_u32 s18, 1
    s_cbranch_scc1 K1_FIN
    s_mov_b32 s18, 1
    s_add_u32 s40, s40, 0
    s_add_u32 s41, s41, 131072
    s_add_u32 s42, s42, 65536
    s_add_u32 s43, s43, 151552
    s_add_u32 s44, s44, 262144
    s_add_u32 s45, s45, 0
    s_add_u32 s46, s46, 0
    s_add_u32 s47, s47, 0
    s_branch K1_LOOP
AA_BAD:
    v_mov_b32 v18, 162304
    v_mov_b32 v20, 1
    ds_write_b32 v18, v20
    s_branch AA_ST
AA_SLOW:
    s_waitcnt vmcnt(0)
    s_barrier
    s_mul_i32 s35, s19, 75776
    s_lshl_b32 s34, s13, 10
    s_add_u32 s35, s35, s34
    s_add_u32 s34, s35, s43
    s_mov_b32 m0, s35
    s_nop 0
    buffer_load_dwordx4 v1, s[4:7], s34 offen sc1 lds
    s_add_u32 s35, s35, 4096
    s_mov_b32 m0, s35
    s_add_u32 s34, s34, 4096
    buffer_load_dwordx4 v1, s[4:7], s34 offen sc1 lds
    s_add_u32 s35, s35, 4096
    s_mov_b32 m0, s35
    s_add_u32 s34, s34, 4096
    buffer_load_dwordx4 v1, s[4:7], s34 offen sc1 lds
    s_add_u32 s35, s35, 4096
    s_mov_b32 m0, s35
    s_add_u32 s34, s34, 4096
    buffer_load_dwordx4 v1, s[4:7], s34 offen sc1 lds
    s_add_u32 s35, s35, 4096
    s_mov_b32 m0, s35
    s_add_u32 s34, s34, 4096
    buffer_load_dwordx4 v1, s[4:7], s34 offen sc1 lds
    s_add_u32 s35, s35, 4096
    s_mov_b32 m0, s35
    s_add_u32 s34, s34, 4096
    buffer_load_dwordx4 v1, s[4:7], s34 offen sc1 lds
    s_add_u32 s35, s35, 4096
    s_mov_b32 m0, s35
    s_add_u32 s34, s34, 4096
    buffer_load_dwordx4 v1, s[4:7], s34 offen sc1 lds
    s_add_u32 s35, s35, 4096
    s_mov_b32 m0, s35
    s_add_u32 s34, s34, 4096
    buffer_load_dwordx4 v1, s[4:7], s34 offen sc1 lds
    s_add_u32 s35, s35, 4096
    s_mov_b32 m0, s35
    s_add_u32 s34, s34, 4096
    buffer_load_dwordx4 v1, s[4:7], s34 offen sc1 lds
    s_add_u32 s35, s35, 4096
    s_mov_b32 m0, s35
    s_add_u32 s34, s34, 4096
    buffer_load_dwordx4 v1, s[4:7], s34 offen sc1 lds
    s_add_u32 s35, s35, 4096
    s_mov_b32 m0, s35
    s_add_u32 s34, s34, 4096
    buffer_load_dwordx4 v1, s[4:7], s34 offen sc1 lds
    s_add_u32 s35, s35, 4096
    s_mov_b32 m0, s35
    s_add_u32 s34, s34, 4096
    buffer_load_dwordx4 v1, s[4:7], s34 offen sc1 lds
    s_add_u32 s35, s35, 4096
    s_mov_b32 m0, s35
    s_add_u32 s34, s34, 4096
    buffer_load_dwordx4 v1, s[4:7], s34 offen sc1 lds
    s_add_u32 s35, s35, 4096
    s_mov_b32 m0, s35
    s_add_u32 s34, s34, 4096
    buffer_load_dwordx4 v1, s[4:7], s34 offen sc1 lds
    s_add_u32 s35, s35, 4096
    s_mov_b32 m0, s35
    s_add_u32 s34, s34, 4096
    buffer_load_dwordx4 v1, s[4:7], s34 offen sc1 lds
    s_add_u32 s35, s35, 4096
    s_mov_b32 m0, s35
    s_add_u32 s34, s34, 4096
    buffer_load_dwordx4 v1, s[4:7], s34 offen sc1 lds
    s_add_u32 s35, s35, 4096
    s_mov_b32 m0, s35
    s_add_u32 s34, s34, 4096
    buffer_load_dwordx4 v1, s[4:7], s34 offen sc1 lds
    s_add_u32 s35, s35, 4096
    s_mov_b32 m0, s35
    s_add_u32 s34, s34, 4096
    buffer_load_dwordx4 v1, s[4:7], s34 offen sc1 lds
    s_cmp_lt_u32 s13, 2
    s_cselect_b32 s36, 4096, 0
    s_add_u32 s35, s35, s36
    s_mov_b32 m0, s35
    s_add_u32 s34, s34, s36
    buffer_load_dwordx4 v1, s[4:7], s34 offen sc1 lds
    v_mov_b32 v20, v6
    s_nop 1
    v_permlane32_swap_b32 v6, v20
    s_cmp_eq_u32 s19, 0
    s_cbranch_scc1 AA_SL1
    v_mov_b32 v6, v20
    v_mov_b32 v8, v12
    v_mov_b32 v9, v13
    v_mov_b32 v10, v14
    v_mov_b32 v11, v15
AA_SL1:
    v_cmp_eq_u32 vcc, 0, v3
    s_nop 1
    v_cndmask_b32 v6, 0, v6, vcc
    s_mov_b32 s32, 64
    s_waitcnt vmcnt(0)
    s_barrier
    v_mov_b32 v75, 0xff7fffff
    v_mov_b32 v76, 0xff7fffff
    v_mov_b32 v61, 0
    s_movk_i32 s39, 304
    v_mov_b32 v80, 0
    v_mov_b32 v81, 0
    v_mov_b32 v82, 0
    v_mov_b32 v83, 0
    v_mov_b32 v84, 0
    v_mov_b32 v85, 0
    v_mov_b32 v86, 0
    v_mov_b32 v87, 0
    v_mov_b32 v88, 0
    v_mov_b32 v89, 0
    v_mov_b32 v90, 0
    v_mov_b32 v91, 0
    v_mov_b32 v92, 0
    v_mov_b32 v93, 0
    v_mov_b32 v94, 0
    v_mov_b32 v95, 0
    s_mov_b32 s26, 0
AA_SL_P0:
    s_mul_i32 s24, s26, 2368
    v_add_u32 v72, s24, v1
    v_lshlrev_b32 v73, 2, v2
    v_add_u32 v73, s24, v73
    v_min_u32 v74, 18, v2
    v_lshlrev_b32 v74, 4, v74
    v_mad_u32_u24 v74, v3, s39, v74
    v_add_u32 v74, s24, v74
    ds_read_b128 v[56:59], v72
    ds_read_b32 v60, v73 offset:1024
    ds_read_b128 v[64:67], v74 offset:1152
    ds_read_b128 v[68:71], v74 offset:1760
    s_waitcnt lgkmcnt(0)
    v_mfma_f32_32x32x8_bf16 v[40:55], v[60:61], v[6:7], 0
    v_mfma_f32_32x32x16_bf16 v[40:55], v[56:59], v[8:11], v[40:55]
    s_nop 15
    v_max_f32 v75, v75, v40
    v_max_f32 v75, v75, v41
    v_max_f32 v75, v75, v42
    v_max_f32 v75, v75, v43
    v_max_f32 v75, v75, v44
    v_max_f32 v75, v75, v45
    v_max_f32 v75, v75, v46
    v_max_f32 v75, v75, v47
    v_max_f32 v75, v75, v48
    v_max_f32 v75, v75, v49
    v_max_f32 v75, v75, v50
    v_max_f32 v75, v75, v51
    v_max_f32 v75, v75, v52
    v_max_f32 v75, v75, v53
    v_max_f32 v75, v75, v54
    v_max_f32 v75, v75, v55
    s_add_u32 s26, s26, 1
    s_cmp_lt_u32 s26, s32
    s_cbranch_scc1 AA_SL_P0
    v_mov_b32 v40, v75
    s_nop 1
    v_permlane32_swap_b32 v75, v40
    v_max_f32 v75, v75, v40
    s_mov_b32 s26, 0
AA_SL_P1:
    s_mul_i32 s24, s26, 2368
    v_add_u32 v72, s24, v1
    v_lshlrev_b32 v73, 2, v2
    v_add_u32 v73, s24, v73
    v_min_u32 v74, 18, v2
    v_lshlrev_b32 v74, 4, v74
    v_mad_u32_u24 v74, v3, s39, v74
    v_add_u32 v74, s24, v74
    ds_read_b128 v[56:59], v72
    ds_read_b32 v60, v73 offset:1024
    ds_read_b128 v[64:67], v74 offset:1152
    ds_read_b128 v[68:71], v74 offset:1760
    s_waitcnt lgkmcnt(0)
    v_mfma_f32_32x32x8_bf16 v[40:55], v[60:61], v[6:7], 0
    v_mfma_f32_32x32x16_bf16 v[40:55], v[56:59], v[8:11], v[40:55]
    s_nop 15
    v_sub_f32 v40, v40, v75
    v_sub_f32 v41, v41, v75
    v_sub_f32 v42, v42, v75
    v_sub_f32 v43, v43, v75
    v_sub_f32 v44, v44, v75
    v_sub_f32 v45, v45, v75
    v_sub_f32 v46, v46, v75
    v_sub_f32 v47, v47, v75
    v_sub_f32 v48, v48, v75
    v_sub_f32 v49, v49, v75
    v_sub_f32 v50, v50, v75
    v_sub_f32 v51, v51, v75
    v_sub_f32 v52, v52, v75
    v_sub_f32 v53, v53, v75
    v_sub_f32 v54, v54, v75
    v_sub_f32 v55, v55, v75
    v_exp_f32 v40, v40
    v_exp_f32 v41, v41
    v_exp_f32 v42, v42
    v_exp_f32 v43, v43
    v_exp_f32 v44, v44
    v_exp_f32 v45, v45
    v_exp_f32 v46, v46
    v_exp_f32 v47, v47
    v_exp_f32 v48, v48
    v_exp_f32 v49, v49
    v_exp_f32 v50, v50
    v_exp_f32 v51, v51
    v_exp_f32 v52, v52
    v_exp_f32 v53, v53
    v_exp_f32 v54, v54
    v_exp_f32 v55, v55
    v_smfmac_f32_32x32x32_bf16 v[80:95], v[64:67], v[40:47], v5
    s_nop 0
    v_smfmac_f32_32x32x32_bf16 v[80:95], v[68:71], v[48:55], v5
    s_nop 15
    s_add_u32 s26, s26, 1
    s_cmp_lt_u32 s26, s32
    s_cbranch_scc1 AA_SL_P1
    v_rcp_f32 v30, v90
    s_nop 0
    v_pk_mul_f32 v[20:21], v[80:81], v[30:31] op_sel_hi:[1,0]
    v_pk_mul_f32 v[22:23], v[82:83], v[30:31] op_sel_hi:[1,0]
    v_pk_mul_f32 v[24:25], v[84:85], v[30:31] op_sel_hi:[1,0]
    v_pk_mul_f32 v[26:27], v[86:87], v[30:31] op_sel_hi:[1,0]
    v_pk_mul_f32 v[28:29], v[88:89], v[30:31] op_sel_hi:[1,0]
    v_cvt_pk_bf16_f32 v20, v20, v21
    v_cvt_pk_bf16_f32 v21, v22, v23
    v_cvt_pk_bf16_f32 v22, v24, v25
    v_cvt_pk_bf16_f32 v23, v26, v27
    v_cvt_pk_bf16_f32 v24, v28, v29
    s_cmp_eq_u32 s55, 0
    s_cbranch_scc1 LS_123
    buffer_store_dwordx4 v[20:23], v1, s[4:7], s27 offen
    s_mov_b32 exec_hi, 0
    buffer_store_dword v24, v1, s[4:7], s28 offen
    s_mov_b64 exec, -1
    s_branch LD_124
LS_123:
    buffer_store_dwordx4 v[20:23], v1, s[4:7], s27 offen sc1
    s_mov_b32 exec_hi, 0
    buffer_store_dword v24, v1, s[4:7], s28 offen sc1
    s_mov_b64 exec, -1
LD_124:
    s_barrier
    s_add_u32 s20, s12, 0
    s_min_u32 s20, s20, 105
    s_lshl_b32 s20, s20, 10
    s_mov_b32 m0, s20
    s_add_u32 s20, s20, s53
    buffer_load_dwordx4 v1, s[4:7], s20 offen lds
    s_add_u32 s20, s12, 8
    s_min_u32 s20, s20, 105
    s_lshl_b32 s20, s20, 10
    s_mov_b32 m0, s20
    s_add_u32 s20, s20, s53
    buffer_load_dwordx4 v1, s[4:7], s20 offen lds
    s_add_u32 s20, s12, 16
    s_min_u32 s20, s20, 105
    s_lshl_b32 s20, s20, 10
    s_mov_b32 m0, s20
    s_add_u32 s20, s20, s53
    buffer_load_dwordx4 v1, s[4:7], s20 offen lds
    s_add_u32 s20, s12, 24
    s_min_u32 s20, s20, 105
    s_lshl_b32 s20, s20, 10
    s_mov_b32 m0, s20
    s_add_u32 s20, s20, s53
    buffer_load_dwordx4 v1, s[4:7], s20 offen lds
    s_add_u32 s20, s12, 32
    s_min_u32 s20, s20, 105
    s_lshl_b32 s20, s20, 10
    s_mov_b32 m0, s20
    s_add_u32 s20, s20, s53
    buffer_load_dwordx4 v1, s[4:7], s20 offen lds
    s_add_u32 s20, s12, 40
    s_min_u32 s20, s20, 105
    s_lshl_b32 s20, s20, 10
    s_mov_b32 m0, s20
    s_add_u32 s20, s20, s53
    buffer_load_dwordx4 v1, s[4:7], s20 offen lds
    s_add_u32 s20, s12, 48
    s_min_u32 s20, s20, 105
    s_lshl_b32 s20, s20, 10
    s_mov_b32 m0, s20
    s_add_u32 s20, s20, s53
    buffer_load_dwordx4 v1, s[4:7], s20 offen lds
    s_add_u32 s20, s12, 56
    s_min_u32 s20, s20, 105
    s_lshl_b32 s20, s20, 10
    s_mov_b32 m0, s20
    s_add_u32 s20, s20, s53
    buffer_load_dwordx4 v1, s[4:7], s20 offen lds
    s_add_u32 s20, s12, 64
    s_min_u32 s20, s20, 105
    s_lshl_b32 s20, s20, 10
    s_mov_b32 m0, s20
    s_add_u32 s20, s20, s53
    buffer_load_dwordx4 v1, s[4:7], s20 offen lds
    s_add_u32 s20, s12, 72
    s_min_u32 s20, s20, 105
    s_lshl_b32 s20, s20, 10
    s_mov_b32 m0, s20
    s_add_u32 s20, s20, s53
    buffer_load_dwordx4 v1, s[4:7], s20 offen lds
    s_add_u32 s20, s12, 80
    s_min_u32 s20, s20, 105
    s_lshl_b32 s20, s20, 10
    s_mov_b32 m0, s20
    s_add_u32 s20, s20, s53
    buffer_load_dwordx4 v1, s[4:7], s20 offen lds
    s_add_u32 s20, s12, 88
    s_min_u32 s20, s20, 105
    s_lshl_b32 s20, s20, 10
    s_mov_b32 m0, s20
    s_add_u32 s20, s20, s53
    buffer_load_dwordx4 v1, s[4:7], s20 offen lds
    s_add_u32 s20, s12, 96
    s_min_u32 s20, s20, 105
    s_lshl_b32 s20, s20, 10
    s_mov_b32 m0, s20
    s_add_u32 s20, s20, s53
    buffer_load_dwordx4 v1, s[4:7], s20 offen lds
    s_add_u32 s20, s12, 104
    s_min_u32 s20, s20, 105
    s_lshl_b32 s20, s20, 10
    s_mov_b32 m0, s20
    s_add_u32 s20, s20, s53
    buffer_load_dwordx4 v1, s[4:7], s20 offen lds
    s_branch AA_DONE
AB_SLOW:
    v_mov_b32 v75, 0xff7fffff
    v_mov_b32 v76, 0xff7fffff
    v_mov_b32 v61, 0
    s_movk_i32 s39, 304
    v_mov_b32 v80, 0
    v_mov_b32 v81, 0
    v_mov_b32 v82, 0
    v_mov_b32 v83, 0
    v_mov_b32 v84, 0
    v_mov_b32 v85, 0
    v_mov_b32 v86, 0
    v_mov_b32 v87, 0
    v_mov_b32 v88, 0
    v_mov_b32 v89, 0
    v_mov_b32 v90, 0
    v_mov_b32 v91, 0
    v_mov_b32 v92, 0
    v_mov_b32 v93, 0
    v_mov_b32 v94, 0
    v_mov_b32 v95, 0
    s_mov_b32 s26, 0
AB_SL_P0:
    s_add_u32 s20, s52, 8
    s_sub_u32 s20, s20, s26
    s_mul_i32 s24, s20, 2368
    s_add_u32 s24, s24, s31
    v_add_u32 v72, s24, v1
    v_lshlrev_b32 v73, 2, v2
    v_add_u32 v73, s24, v73
    v_min_u32 v74, 18, v2
    v_lshlrev_b32 v74, 4, v74
    v_mad_u32_u24 v74, v3, s39, v74
    v_add_u32 v74, s24, v74
    ds_read_b128 v[56:59], v72
    ds_read_b32 v60, v73 offset:1024
    ds_read_b128 v[64:67], v74 offset:1152
    ds_read_b128 v[68:71], v74 offset:1760
    s_waitcnt lgkmcnt(0)
    v_mfma_f32_32x32x8_bf16 v[40:55], v[60:61], v[6:7], 0
    v_mfma_f32_32x32x16_bf16 v[40:55], v[56:59], v[8:11], v[40:55]
    s_nop 15
    s_cmp_eq_u32 s26, 0
    s_cbranch_scc0 AB_SL_P0_M1
    v_cndmask_b32 v40, v76, v40, s[64:65]
    v_cndmask_b32 v41, v76, v41, s[66:67]
    v_cndmask_b32 v42, v76, v42, s[68:69]
    v_cndmask_b32 v43, v76, v43, s[70:71]
    v_cndmask_b32 v44, v76, v44, s[72:73]
    v_cndmask_b32 v45, v76, v45, s[74:75]
    v_cndmask_b32 v46, v76, v46, s[76:77]
    v_cndmask_b32 v47, v76, v47, s[78:79]
    v_cndmask_b32 v48, v76, v48, s[80:81]
    v_cndmask_b32 v49, v76, v49, s[82:83]
    v_cndmask_b32 v50, v76, v50, s[84:85]
    v_cndmask_b32 v51, v76, v51, s[86:87]
    v_cndmask_b32 v52, v76, v52, s[88:89]
    v_cndmask_b32 v53, v76, v53, s[90:91]
    v_cndmask_b32 v54, v76, v54, s[92:93]
    v_cndmask_b32 v55, v76, v55, s[94:95]
AB_SL_P0_M1:
    s_cmp_eq_u32 s26, 8
    s_cbranch_scc0 AB_SL_P0_M2
    v_cndmask_b32 v40, v40, v76, s[64:65]
    v_cndmask_b32 v41, v41, v76, s[66:67]
    v_cndmask_b32 v42, v42, v76, s[68:69]
    v_cndmask_b32 v43, v43, v76, s[70:71]
    v_cndmask_b32 v44, v44, v76, s[72:73]
    v_cndmask_b32 v45, v45, v76, s[74:75]
    v_cndmask_b32 v46, v46, v76, s[76:77]
    v_cndmask_b32 v47, v47, v76, s[78:79]
    v_cndmask_b32 v48, v48, v76, s[80:81]
    v_cndmask_b32 v49, v49, v76, s[82:83]
    v_cndmask_b32 v50, v50, v76, s[84:85]
    v_cndmask_b32 v51, v51, v76, s[86:87]
    v_cndmask_b32 v52, v52, v76, s[88:89]
    v_cndmask_b32 v53, v53, v76, s[90:91]
    v_cndmask_b32 v54, v54, v76, s[92:93]
    v_cndmask_b32 v55, v55, v76, s[94:95]
AB_SL_P0_M2:
    v_max_f32 v75, v75, v40
    v_max_f32 v75, v75, v41
    v_max_f32 v75, v75, v42
    v_max_f32 v75, v75, v43
    v_max_f32 v75, v75, v44
    v_max_f32 v75, v75, v45
    v_max_f32 v75, v75, v46
    v_max_f32 v75, v75, v47
    v_max_f32 v75, v75, v48
    v_max_f32 v75, v75, v49
    v_max_f32 v75, v75, v50
    v_max_f32 v75, v75, v51
    v_max_f32 v75, v75, v52
    v_max_f32 v75, v75, v53
    v_max_f32 v75, v75, v54
    v_max_f32 v75, v75, v55
    s_add_u32 s26, s26, 1
    s_cmp_lt_u32 s26, s32
    s_cbranch_scc1 AB_SL_P0
    v_mov_b32 v40, v75
    s_nop 1
    v_permlane32_swap_b32 v75, v40
    v_max_f32 v75, v75, v40
    s_mov_b32 s26, 0
AB_SL_P1:
    s_add_u32 s20, s52, 8
    s_sub_u32 s20, s20, s26
    s_mul_i32 s24, s20, 2368
    s_add_u32 s24, s24, s31
    v_add_u32 v72, s24, v1
    v_lshlrev_b32 v73, 2, v2
    v_add_u32 v73, s24, v73
    v_min_u32 v74, 18, v2
    v_lshlrev_b32 v74, 4, v74
    v_mad_u32_u24 v74, v3, s39, v74
    v_add_u32 v74, s24, v74
    ds_read_b128 v[56:59], v72
    ds_read_b32 v60, v73 offset:1024
    ds_read_b128 v[64:67], v74 offset:1152
    ds_read_b128 v[68:71], v74 offset:1760
    s_waitcnt lgkmcnt(0)
    v_mfma_f32_32x32x8_bf16 v[40:55], v[60:61], v[6:7], 0
    v_mfma_f32_32x32x16_bf16 v[40:55], v[56:59], v[8:11], v[40:55]
    s_nop 15
    s_cmp_eq_u32 s26, 0
    s_cbranch_scc0 AB_SL_P1_M1
    v_cndmask_b32 v40, v76, v40, s[64:65]
    v_cndmask_b32 v41, v76, v41, s[66:67]
    v_cndmask_b32 v42, v76, v42, s[68:69]
    v_cndmask_b32 v43, v76, v43, s[70:71]
    v_cndmask_b32 v44, v76, v44, s[72:73]
    v_cndmask_b32 v45, v76, v45, s[74:75]
    v_cndmask_b32 v46, v76, v46, s[76:77]
    v_cndmask_b32 v47, v76, v47, s[78:79]
    v_cndmask_b32 v48, v76, v48, s[80:81]
    v_cndmask_b32 v49, v76, v49, s[82:83]
    v_cndmask_b32 v50, v76, v50, s[84:85]
    v_cndmask_b32 v51, v76, v51, s[86:87]
    v_cndmask_b32 v52, v76, v52, s[88:89]
    v_cndmask_b32 v53, v76, v53, s[90:91]
    v_cndmask_b32 v54, v76, v54, s[92:93]
    v_cndmask_b32 v55, v76, v55, s[94:95]
AB_SL_P1_M1:
    s_cmp_eq_u32 s26, 8
    s_cbranch_scc0 AB_SL_P1_M2
    v_cndmask_b32 v40, v40, v76, s[64:65]
    v_cndmask_b32 v41, v41, v76, s[66:67]
    v_cndmask_b32 v42, v42, v76, s[68:69]
    v_cndmask_b32 v43, v43, v76, s[70:71]
    v_cndmask_b32 v44, v44, v76, s[72:73]
    v_cndmask_b32 v45, v45, v76, s[74:75]
    v_cndmask_b32 v46, v46, v76, s[76:77]
    v_cndmask_b32 v47, v47, v76, s[78:79]
    v_cndmask_b32 v48, v48, v76, s[80:81]
    v_cndmask_b32 v49, v49, v76, s[82:83]
    v_cndmask_b32 v50, v50, v76, s[84:85]
    v_cndmask_b32 v51, v51, v76, s[86:87]
    v_cndmask_b32 v52, v52, v76, s[88:89]
    v_cndmask_b32 v53, v53, v76, s[90:91]
    v_cndmask_b32 v54, v54, v76, s[92:93]
    v_cndmask_b32 v55, v55, v76, s[94:95]
AB_SL_P1_M2:
    v_sub_f32 v40, v40, v75
    v_sub_f32 v41, v41, v75
    v_sub_f32 v42, v42, v75
    v_sub_f32 v43, v43, v75
    v_sub_f32 v44, v44, v75
    v_sub_f32 v45, v45, v75
    v_sub_f32 v46, v46, v75
    v_sub_f32 v47, v47, v75
    v_sub_f32 v48, v48, v75
    v_sub_f32 v49, v49, v75
    v_sub_f32 v50, v50, v75
    v_sub_f32 v51, v51, v75
    v_sub_f32 v52, v52, v75
    v_sub_f32 v53, v53, v75
    v_sub_f32 v54, v54, v75
    v_sub_f32 v55, v55, v75
    v_exp_f32 v40, v40
    v_exp_f32 v41, v41
    v_exp_f32 v42, v42
    v_exp_f32 v43, v43
    v_exp_f32 v44, v44
    v_exp_f32 v45, v45
    v_exp_f32 v46, v46
    v_exp_f32 v47, v47
    v_exp_f32 v48, v48
    v_exp_f32 v49, v49
    v_exp_f32 v50, v50
    v_exp_f32 v51, v51
    v_exp_f32 v52, v52
    v_exp_f32 v53, v53
    v_exp_f32 v54, v54
    v_exp_f32 v55, v55
    v_smfmac_f32_32x32x32_bf16 v[80:95], v[64:67], v[40:47], v5
    s_nop 0
    v_smfmac_f32_32x32x32_bf16 v[80:95], v[68:71], v[48:55], v5
    s_nop 15
    s_add_u32 s26, s26, 1
    s_cmp_lt_u32 s26, s32
    s_cbranch_scc1 AB_SL_P1
    s_waitcnt vmcnt(0)
    v_rcp_f32 v30, v90
    s_nop 0
    v_pk_mul_f32 v[20:21], v[80:81], v[30:31] op_sel_hi:[1,0]
    v_pk_mul_f32 v[22:23], v[82:83], v[30:31] op_sel_hi:[1,0]
    v_pk_mul_f32 v[24:25], v[84:85], v[30:31] op_sel_hi:[1,0]
    v_pk_mul_f32 v[26:27], v[86:87], v[30:31] op_sel_hi:[1,0]
    v_pk_mul_f32 v[28:29], v[88:89], v[30:31] op_sel_hi:[1,0]
    v_cvt_pk_bf16_f32 v20, v20, v21
    v_cvt_pk_bf16_f32 v21, v22, v23
    v_cvt_pk_bf16_f32 v22, v24, v25
    v_cvt_pk_bf16_f32 v23, v26, v27
    v_cvt_pk_bf16_f32 v24, v28, v29
    s_cmp_eq_u32 s55, 0
    s_cbranch_scc1 LS_125
    buffer_store_dwordx4 v[20:23], v1, s[4:7], s27 offen
    s_mov_b32 exec_hi, 0
    buffer_store_dword v24, v1, s[4:7], s28 offen
    s_mov_b64 exec, -1
    s_branch LD_126
LS_125:
    buffer_store_dwordx4 v[20:23], v1, s[4:7], s27 offen sc1
    s_mov_b32 exec_hi, 0
    buffer_store_dword v24, v1, s[4:7], s28 offen sc1
    s_mov_b64 exec, -1
LD_126:
    s_branch AB_ST
K1_FIN:
    s_lshl_b32 s20, s12, 10
    s_or_b32 s20, s20, s49
    s_cmp_eq_u32 s20, 0
    s_cbranch_scc0 K1_FIN2
    v_mov_b32 v8, s96
    v_mov_b32 v9, 15023104
    s_mov_b64 exec, 1
    buffer_store_dword v8, v9, s[4:7], 0 offen
    s_mov_b64 exec, -1
K1_FIN2:
K1_END:
    s_endpgm
.section .rodata,"a"
.p2align 6
.amdhsa_kernel interleave_layers__grouped_kv_mqa__sliding_block__prompt_kernel
  .amdhsa_next_free_vgpr 256
  .amdhsa_next_free_sgpr 100
  .amdhsa_accum_offset 256
  .amdhsa_group_segment_fixed_size 0
  .amdhsa_kernarg_size 88
  .amdhsa_user_sgpr_count 2
  .amdhsa_user_sgpr_kernarg_segment_ptr 1
  .amdhsa_system_sgpr_workgroup_id_x 1
.end_amdhsa_kernel
```
